```python
import torch

def _softmax(x, axis=-1):
    return torch.softmax(x, dim=axis)
def _gelu(x):
    return torch.nn.functional.gelu(x, approximate="tanh")
def _silu(x):
    return torch.nn.functional.silu(x)
def _sigmoid(x):
    return torch.sigmoid(x)
def _layernorm(x, axis=-1, eps=1e-5):
    m = x.mean(dim=axis, keepdim=True)
    v = x.var(dim=axis, keepdim=True, unbiased=False)
    return (x - m) / torch.sqrt(v + eps)
def _scatter_add(tgt, idx, src, axis=0):
    return tgt.clone().index_add_(axis, idx, src)
def _segment_sum(src, seg, n):
    out = torch.zeros((n,) + src.shape[1:], dtype=src.dtype)
    return out.index_add_(0, seg, src)
def _pad(x, pw):
    flat = tuple(v for pair in reversed(pw) for v in pair)
    return torch.nn.functional.pad(x, flat)

kernel_name = 'standalone__mha_softmax__near_ridge'

def setup_inputs():

    _w = (lambda a: (lambda t: t.to(torch.bfloat16) if t.is_floating_point() else t)(torch.as_tensor(a)))
    B, H, Sq, Sk, D = 8, 32, 304, 2048, 128
    return {
        "q": _w((lambda *s: torch.randn(*s, dtype=torch.bfloat16) * 0.8)(B, H, Sq, D)),
        "k": _w((lambda *s: torch.randn(*s, dtype=torch.bfloat16) * 0.8)(B, H, Sk, D)),
        "v": _w((lambda *s: torch.randn(*s, dtype=torch.bfloat16) * 0.05)(B, H, Sk, D)),
    }

def reference(q, k, v):
    scale = q.shape[-1] ** -0.5
    scores = torch.einsum("bhqd,bhkd->bhqk", q, k) * scale
    p = _softmax(scores, axis=-1)
    return torch.einsum("bhqk,bhkd->bhqd", p, v)
```

```asm
; @launch grid=(256,1,1) block=(256,1,1) lds=156416
.amdgcn_target "amdgcn-amd-amdhsa--gfx950"
.text
.globl standalone__mha_softmax__near_ridge_kernel
.p2align 8
.type standalone__mha_softmax__near_ridge_kernel,@function
standalone__mha_softmax__near_ridge_kernel:
    s_cmp_ge_u32 s2, 256
    s_cbranch_scc1 L_end
    s_load_dwordx4 s[4:7], s[0:1], 0
    s_load_dwordx4 s[12:15], s[0:1], 16
    s_getpc_b64 s[46:47]
L_pc:
    v_lshlrev_b32 v1, 7, v0
    v_min_u32 v1, 0x7774, v1
    v_mov_b32 v3, s47
    v_add_co_u32 v2, vcc, s46, v1
    s_nop 1
    v_addc_co_u32 v3, vcc, 0, v3, vcc
    global_load_dword v246, v[2:3], off
    v_lshrrev_b32 v1, 6, v0
    v_and_b32 v0, 63, v0
    v_and_b32 v2, 15, v0
    v_readfirstlane_b32 s24, v1
    v_lshrrev_b32 v3, 4, v0
    v_add_u32 v6, 0, v3
    v_xor_b32 v6, v6, v2
    v_lshlrev_b32 v6, 4, v6
    v_lshl_add_u32 v228, v3, 8, v6
    v_add_u32 v6, 4, v3
    v_xor_b32 v6, v6, v2
    v_lshlrev_b32 v6, 4, v6
    v_lshl_add_u32 v229, v3, 8, v6
    v_add_u32 v6, 8, v3
    v_xor_b32 v6, v6, v2
    v_lshlrev_b32 v6, 4, v6
    v_lshl_add_u32 v230, v3, 8, v6
    v_add_u32 v6, 12, v3
    v_xor_b32 v6, v6, v2
    v_lshlrev_b32 v6, 4, v6
    v_lshl_add_u32 v231, v3, 8, v6
    s_lshl_b32 s34, s24, 12
    s_mov_b32 s30, 0
    s_lshl_b32 s31, s2, 19
    s_mul_i32 s32, s2, 77824
    v_mov_b32 v128, 0xff7fffff
    v_mov_b32 v132, 0xff7fffff
    v_mov_b32 v136, 0xff7fffff
    v_mov_b32 v140, 0xff7fffff
    v_mov_b32 v144, 0xff7fffff
    v_mov_b32 v148, 0xff7fffff
    s_waitcnt lgkmcnt(0)
    s_add_u32 s8, s6, s31
    s_addc_u32 s9, s7, 0
    s_mov_b32 s11, 0x20000
    s_add_u32 s16, s4, s32
    s_addc_u32 s17, s5, 0
    s_mov_b32 s18, 77824
    s_mov_b32 s19, 0x20000
    s_add_u32 s20, s14, s32
    s_addc_u32 s21, s15, 0
    s_mov_b32 s22, 77824
    s_mov_b32 s23, 0x20000
    s_add_u32 s12, s12, s31
    s_addc_u32 s13, s13, 0
    s_mov_b32 s15, 0x20000
L_restart:
    s_mov_b32 s10, 524288
    s_mov_b32 s14, 524288
    s_mov_b32 s26, s34
    s_mov_b32 s27, s34
    s_add_u32 s28, s34, 98304
    s_add_u32 s29, s34, 16384
    s_mov_b32 m0, s28
    s_nop 0
    buffer_load_dwordx4 v228, s[8:11], s26 offen offset:0 nt lds
    buffer_load_dwordx4 v229, s[8:11], s26 offen offset:1024 nt lds
    buffer_load_dwordx4 v230, s[8:11], s26 offen offset:2048 nt lds
    buffer_load_dwordx4 v231, s[8:11], s26 offen offset:3072 nt lds
    s_add_u32 s28, s28, 32768
    s_and_b32 s28, s28, 131071
    s_add_u32 s26, s26, 16384
    s_cmp_lt_u32 s26, 524288
    s_cselect_b32 s10, 524288, 0
    s_lshl_b32 s31, s24, 2
    v_add_u32 v6, s31, v3
    v_xor_b32 v6, v6, v2
    v_lshlrev_b32 v6, 4, v6
    v_lshl_add_u32 v4, v3, 8, v6
    s_lshl_b32 s33, s24, 10
    s_add_u32 s31, s33, 114688
    s_mov_b32 m0, s31
    s_add_u32 s32, s33, 65536
    buffer_load_dwordx4 v4, s[16:19], s32 offen nt lds
    s_add_u32 s31, s33, 118784
    s_mov_b32 m0, s31
    s_add_u32 s32, s33, 69632
    buffer_load_dwordx4 v4, s[16:19], s32 offen nt lds
    s_add_u32 s31, s33, 122880
    s_mov_b32 m0, s31
    s_add_u32 s32, s33, 73728
    buffer_load_dwordx4 v4, s[16:19], s32 offen nt lds
    s_add_u32 s31, s34, 32768
    s_mov_b32 m0, s31
    s_lshl_b32 s32, s24, 14
    s_add_u32 s32, s32, 0
    buffer_load_dwordx4 v228, s[16:19], s32 offen offset:0 nt lds
    buffer_load_dwordx4 v229, s[16:19], s32 offen offset:1024 nt lds
    buffer_load_dwordx4 v230, s[16:19], s32 offen offset:2048 nt lds
    buffer_load_dwordx4 v231, s[16:19], s32 offen offset:3072 nt lds
    s_add_u32 s31, s34, 49152
    s_mov_b32 m0, s31
    s_lshl_b32 s32, s24, 14
    s_add_u32 s32, s32, 4096
    buffer_load_dwordx4 v228, s[16:19], s32 offen offset:0 nt lds
    buffer_load_dwordx4 v229, s[16:19], s32 offen offset:1024 nt lds
    buffer_load_dwordx4 v230, s[16:19], s32 offen offset:2048 nt lds
    buffer_load_dwordx4 v231, s[16:19], s32 offen offset:3072 nt lds
    s_mov_b32 s42, 0x3e0293ee
    s_mov_b32 s43, 0x3e0293ee
    v_add_u32 v6, 0, v3
    v_lshlrev_b32 v6, 1, v6
    v_xor_b32 v6, v6, v2
    v_lshlrev_b32 v6, 4, v6
    v_lshl_add_u32 v232, v3, 8, v6
    v_add_u32 v6, 4, v3
    v_lshlrev_b32 v6, 1, v6
    v_xor_b32 v6, v6, v2
    v_lshlrev_b32 v6, 4, v6
    v_lshl_add_u32 v233, v3, 8, v6
    s_add_u32 s31, s34, 32768
    s_and_b32 s32, s34, 4096
    s_add_u32 s32, s32, 114688
    v_add_u32 v6, 0, v3
    v_xor_b32 v6, v6, v2
    v_lshlrev_b32 v6, 4, v6
    v_lshl_add_u32 v6, v2, 8, v6
    v_add_u32 v216, 65536, v6
    v_add_u32 v248, s31, v6
    v_add_u32 v252, s32, v6
    v_add_u32 v6, 4, v3
    v_xor_b32 v6, v6, v2
    v_lshlrev_b32 v6, 4, v6
    v_lshl_add_u32 v6, v2, 8, v6
    v_add_u32 v217, 65536, v6
    v_add_u32 v249, s31, v6
    v_add_u32 v253, s32, v6
    v_add_u32 v6, 8, v3
    v_xor_b32 v6, v6, v2
    v_lshlrev_b32 v6, 4, v6
    v_lshl_add_u32 v6, v2, 8, v6
    v_add_u32 v218, 65536, v6
    v_add_u32 v250, s31, v6
    v_add_u32 v254, s32, v6
    v_add_u32 v6, 12, v3
    v_xor_b32 v6, v6, v2
    v_lshlrev_b32 v6, 4, v6
    v_lshl_add_u32 v6, v2, 8, v6
    v_add_u32 v219, 65536, v6
    v_add_u32 v251, s31, v6
    v_add_u32 v255, s32, v6
    v_lshrrev_b32 v1, 2, v0
    v_lshlrev_b32 v6, 8, v1
    v_and_b32 v7, 3, v0
    v_lshl_add_u32 v6, v7, 3, v6
    v_and_b32 v1, 7, v1
    v_xor_b32 v7, 0, v1
    v_lshl_add_u32 v220, v7, 5, v6
    v_xor_b32 v7, 1, v1
    v_lshl_add_u32 v221, v7, 5, v6
    v_xor_b32 v7, 2, v1
    v_lshl_add_u32 v222, v7, 5, v6
    v_xor_b32 v7, 3, v1
    v_lshl_add_u32 v223, v7, 5, v6
    v_xor_b32 v7, 4, v1
    v_lshl_add_u32 v224, v7, 5, v6
    v_xor_b32 v7, 5, v1
    v_lshl_add_u32 v225, v7, 5, v6
    v_xor_b32 v7, 6, v1
    v_lshl_add_u32 v226, v7, 5, v6
    v_xor_b32 v7, 7, v1
    v_lshl_add_u32 v227, v7, 5, v6
    v_accvgpr_write_b32 a0, 0
    v_accvgpr_write_b32 a1, 0
    v_accvgpr_write_b32 a2, 0
    v_accvgpr_write_b32 a3, 0
    v_accvgpr_write_b32 a4, 0
    v_accvgpr_write_b32 a5, 0
    v_accvgpr_write_b32 a6, 0
    v_accvgpr_write_b32 a7, 0
    v_accvgpr_write_b32 a8, 0
    v_accvgpr_write_b32 a9, 0
    v_accvgpr_write_b32 a10, 0
    v_accvgpr_write_b32 a11, 0
    v_accvgpr_write_b32 a12, 0
    v_accvgpr_write_b32 a13, 0
    v_accvgpr_write_b32 a14, 0
    v_accvgpr_write_b32 a15, 0
    v_accvgpr_write_b32 a16, 0
    v_accvgpr_write_b32 a17, 0
    v_accvgpr_write_b32 a18, 0
    v_accvgpr_write_b32 a19, 0
    v_accvgpr_write_b32 a20, 0
    v_accvgpr_write_b32 a21, 0
    v_accvgpr_write_b32 a22, 0
    v_accvgpr_write_b32 a23, 0
    v_accvgpr_write_b32 a24, 0
    v_accvgpr_write_b32 a25, 0
    v_accvgpr_write_b32 a26, 0
    v_accvgpr_write_b32 a27, 0
    v_accvgpr_write_b32 a28, 0
    v_accvgpr_write_b32 a29, 0
    v_accvgpr_write_b32 a30, 0
    v_accvgpr_write_b32 a31, 0
    v_accvgpr_write_b32 a32, 0
    v_accvgpr_write_b32 a33, 0
    v_accvgpr_write_b32 a34, 0
    v_accvgpr_write_b32 a35, 0
    v_accvgpr_write_b32 a36, 0
    v_accvgpr_write_b32 a37, 0
    v_accvgpr_write_b32 a38, 0
    v_accvgpr_write_b32 a39, 0
    v_accvgpr_write_b32 a40, 0
    v_accvgpr_write_b32 a41, 0
    v_accvgpr_write_b32 a42, 0
    v_accvgpr_write_b32 a43, 0
    v_accvgpr_write_b32 a44, 0
    v_accvgpr_write_b32 a45, 0
    v_accvgpr_write_b32 a46, 0
    v_accvgpr_write_b32 a47, 0
    v_accvgpr_write_b32 a48, 0
    v_accvgpr_write_b32 a49, 0
    v_accvgpr_write_b32 a50, 0
    v_accvgpr_write_b32 a51, 0
    v_accvgpr_write_b32 a52, 0
    v_accvgpr_write_b32 a53, 0
    v_accvgpr_write_b32 a54, 0
    v_accvgpr_write_b32 a55, 0
    v_accvgpr_write_b32 a56, 0
    v_accvgpr_write_b32 a57, 0
    v_accvgpr_write_b32 a58, 0
    v_accvgpr_write_b32 a59, 0
    v_accvgpr_write_b32 a60, 0
    v_accvgpr_write_b32 a61, 0
    v_accvgpr_write_b32 a62, 0
    v_accvgpr_write_b32 a63, 0
    v_accvgpr_write_b32 a64, 0
    v_accvgpr_write_b32 a65, 0
    v_accvgpr_write_b32 a66, 0
    v_accvgpr_write_b32 a67, 0
    v_accvgpr_write_b32 a68, 0
    v_accvgpr_write_b32 a69, 0
    v_accvgpr_write_b32 a70, 0
    v_accvgpr_write_b32 a71, 0
    v_accvgpr_write_b32 a72, 0
    v_accvgpr_write_b32 a73, 0
    v_accvgpr_write_b32 a74, 0
    v_accvgpr_write_b32 a75, 0
    v_accvgpr_write_b32 a76, 0
    v_accvgpr_write_b32 a77, 0
    v_accvgpr_write_b32 a78, 0
    v_accvgpr_write_b32 a79, 0
    v_accvgpr_write_b32 a80, 0
    v_accvgpr_write_b32 a81, 0
    v_accvgpr_write_b32 a82, 0
    v_accvgpr_write_b32 a83, 0
    v_accvgpr_write_b32 a84, 0
    v_accvgpr_write_b32 a85, 0
    v_accvgpr_write_b32 a86, 0
    v_accvgpr_write_b32 a87, 0
    v_accvgpr_write_b32 a88, 0
    v_accvgpr_write_b32 a89, 0
    v_accvgpr_write_b32 a90, 0
    v_accvgpr_write_b32 a91, 0
    v_accvgpr_write_b32 a92, 0
    v_accvgpr_write_b32 a93, 0
    v_accvgpr_write_b32 a94, 0
    v_accvgpr_write_b32 a95, 0
    v_accvgpr_write_b32 a96, 0
    v_accvgpr_write_b32 a97, 0
    v_accvgpr_write_b32 a98, 0
    v_accvgpr_write_b32 a99, 0
    v_accvgpr_write_b32 a100, 0
    v_accvgpr_write_b32 a101, 0
    v_accvgpr_write_b32 a102, 0
    v_accvgpr_write_b32 a103, 0
    v_accvgpr_write_b32 a104, 0
    v_accvgpr_write_b32 a105, 0
    v_accvgpr_write_b32 a106, 0
    v_accvgpr_write_b32 a107, 0
    v_accvgpr_write_b32 a108, 0
    v_accvgpr_write_b32 a109, 0
    v_accvgpr_write_b32 a110, 0
    v_accvgpr_write_b32 a111, 0
    v_accvgpr_write_b32 a112, 0
    v_accvgpr_write_b32 a113, 0
    v_accvgpr_write_b32 a114, 0
    v_accvgpr_write_b32 a115, 0
    v_accvgpr_write_b32 a116, 0
    v_accvgpr_write_b32 a117, 0
    v_accvgpr_write_b32 a118, 0
    v_accvgpr_write_b32 a119, 0
    v_accvgpr_write_b32 a120, 0
    v_accvgpr_write_b32 a121, 0
    v_accvgpr_write_b32 a122, 0
    v_accvgpr_write_b32 a123, 0
    v_accvgpr_write_b32 a124, 0
    v_accvgpr_write_b32 a125, 0
    v_accvgpr_write_b32 a126, 0
    v_accvgpr_write_b32 a127, 0
    v_accvgpr_write_b32 a128, 0
    v_accvgpr_write_b32 a129, 0
    v_accvgpr_write_b32 a130, 0
    v_accvgpr_write_b32 a131, 0
    v_accvgpr_write_b32 a132, 0
    v_accvgpr_write_b32 a133, 0
    v_accvgpr_write_b32 a134, 0
    v_accvgpr_write_b32 a135, 0
    v_accvgpr_write_b32 a136, 0
    v_accvgpr_write_b32 a137, 0
    v_accvgpr_write_b32 a138, 0
    v_accvgpr_write_b32 a139, 0
    v_accvgpr_write_b32 a140, 0
    v_accvgpr_write_b32 a141, 0
    v_accvgpr_write_b32 a142, 0
    v_accvgpr_write_b32 a143, 0
    v_accvgpr_write_b32 a144, 0
    v_accvgpr_write_b32 a145, 0
    v_accvgpr_write_b32 a146, 0
    v_accvgpr_write_b32 a147, 0
    v_accvgpr_write_b32 a148, 0
    v_accvgpr_write_b32 a149, 0
    v_accvgpr_write_b32 a150, 0
    v_accvgpr_write_b32 a151, 0
    v_accvgpr_write_b32 a152, 0
    v_accvgpr_write_b32 a153, 0
    v_accvgpr_write_b32 a154, 0
    v_accvgpr_write_b32 a155, 0
    v_accvgpr_write_b32 a156, 0
    v_accvgpr_write_b32 a157, 0
    v_accvgpr_write_b32 a158, 0
    v_accvgpr_write_b32 a159, 0
    v_accvgpr_write_b32 a160, 0
    v_accvgpr_write_b32 a161, 0
    v_accvgpr_write_b32 a162, 0
    v_accvgpr_write_b32 a163, 0
    v_accvgpr_write_b32 a164, 0
    v_accvgpr_write_b32 a165, 0
    v_accvgpr_write_b32 a166, 0
    v_accvgpr_write_b32 a167, 0
    v_accvgpr_write_b32 a168, 0
    v_accvgpr_write_b32 a169, 0
    v_accvgpr_write_b32 a170, 0
    v_accvgpr_write_b32 a171, 0
    v_accvgpr_write_b32 a172, 0
    v_accvgpr_write_b32 a173, 0
    v_accvgpr_write_b32 a174, 0
    v_accvgpr_write_b32 a175, 0
    v_accvgpr_write_b32 a176, 0
    v_accvgpr_write_b32 a177, 0
    v_accvgpr_write_b32 a178, 0
    v_accvgpr_write_b32 a179, 0
    v_accvgpr_write_b32 a180, 0
    v_accvgpr_write_b32 a181, 0
    v_accvgpr_write_b32 a182, 0
    v_accvgpr_write_b32 a183, 0
    v_accvgpr_write_b32 a184, 0
    v_accvgpr_write_b32 a185, 0
    v_accvgpr_write_b32 a186, 0
    v_accvgpr_write_b32 a187, 0
    v_accvgpr_write_b32 a188, 0
    v_accvgpr_write_b32 a189, 0
    v_accvgpr_write_b32 a190, 0
    v_accvgpr_write_b32 a191, 0
    v_mov_b32 v234, 0
    v_mov_b32 v235, 0
    v_mov_b32 v236, 0
    v_mov_b32 v237, 0
    v_mov_b32 v238, 0
    v_mov_b32 v239, 0
    v_cmp_eq_u32 vcc, 0, v2
    v_mov_b32 v6, 0x3f803f80
    v_mov_b32 v244, 0
    v_mov_b32 v245, 0
    v_mov_b32 v246, 0
    v_mov_b32 v247, 0
    v_cndmask_b32 v240, 0, v6, vcc
    v_cndmask_b32 v241, 0, v6, vcc
    v_cndmask_b32 v242, 0, v6, vcc
    v_cndmask_b32 v243, 0, v6, vcc
    s_mov_b32 s25, 15
    s_waitcnt vmcnt(11)
    s_add_u32 s31, s34, 65536
    s_mov_b32 m0, s31
    s_lshl_b32 s32, s24, 14
    s_add_u32 s32, s32, 8192
    buffer_load_dwordx4 v228, s[16:19], s32 offen offset:0 nt lds
    buffer_load_dwordx4 v229, s[16:19], s32 offen offset:1024 nt lds
    buffer_load_dwordx4 v230, s[16:19], s32 offen offset:2048 nt lds
    buffer_load_dwordx4 v231, s[16:19], s32 offen offset:3072 nt lds
    s_waitcnt vmcnt(12)
    s_add_u32 s31, s34, 81920
    s_mov_b32 m0, s31
    s_lshl_b32 s32, s24, 14
    s_add_u32 s32, s32, 12288
    buffer_load_dwordx4 v228, s[16:19], s32 offen offset:0 nt lds
    buffer_load_dwordx4 v229, s[16:19], s32 offen offset:1024 nt lds
    buffer_load_dwordx4 v230, s[16:19], s32 offen offset:2048 nt lds
    buffer_load_dwordx4 v231, s[16:19], s32 offen offset:3072 nt lds
    s_barrier
    ds_read_b128 v[184:187], v252 offset:0
    ds_read_b128 v[188:191], v253 offset:0
    ds_read_b128 v[192:195], v254 offset:0
    ds_read_b128 v[196:199], v255 offset:0
    ds_read_b128 v[200:203], v216 offset:57344
    ds_read_b128 v[204:207], v217 offset:57344
    ds_read_b128 v[208:211], v218 offset:57344
    ds_read_b128 v[212:215], v219 offset:57344
    v_lshlrev_b32 v1, 4, v0
    s_waitcnt lgkmcnt(0)
    ds_read_b128 v[152:155], v216 offset:32768
    ds_read_b128 v[156:159], v217 offset:32768
    ds_read_b128 v[160:163], v218 offset:32768
    ds_read_b128 v[164:167], v219 offset:32768
    ds_read_b128 v[168:171], v216 offset:36864
    ds_read_b128 v[172:175], v217 offset:36864
    ds_read_b128 v[176:179], v218 offset:36864
    ds_read_b128 v[180:183], v219 offset:36864
    v_lshlrev_b32 v120, 16, v184
    v_and_b32 v121, 0xffff0000, v184
    v_lshlrev_b32 v122, 16, v185
    v_and_b32 v123, 0xffff0000, v185
    v_lshlrev_b32 v124, 16, v186
    v_and_b32 v125, 0xffff0000, v186
    v_lshlrev_b32 v126, 16, v187
    v_and_b32 v127, 0xffff0000, v187
    v_pk_mul_f32 v[120:121], v[120:121], s[42:43]
    v_pk_mul_f32 v[122:123], v[122:123], s[42:43]
    v_pk_mul_f32 v[124:125], v[124:125], s[42:43]
    v_pk_mul_f32 v[126:127], v[126:127], s[42:43]
    v_cvt_pk_bf16_f32 v184, v120, v121
    v_cvt_pk_bf16_f32 v185, v122, v123
    v_cvt_pk_bf16_f32 v186, v124, v125
    v_cvt_pk_bf16_f32 v187, v126, v127
    v_lshlrev_b32 v80, 16, v188
    v_and_b32 v81, 0xffff0000, v188
    v_lshlrev_b32 v82, 16, v189
    v_and_b32 v83, 0xffff0000, v189
    v_lshlrev_b32 v84, 16, v190
    v_and_b32 v85, 0xffff0000, v190
    v_lshlrev_b32 v86, 16, v191
    v_and_b32 v87, 0xffff0000, v191
    v_pk_mul_f32 v[80:81], v[80:81], s[42:43]
    v_pk_mul_f32 v[82:83], v[82:83], s[42:43]
    v_pk_mul_f32 v[84:85], v[84:85], s[42:43]
    v_pk_mul_f32 v[86:87], v[86:87], s[42:43]
    v_cvt_pk_bf16_f32 v188, v80, v81
    v_cvt_pk_bf16_f32 v189, v82, v83
    v_cvt_pk_bf16_f32 v190, v84, v85
    v_cvt_pk_bf16_f32 v191, v86, v87
    v_lshlrev_b32 v120, 16, v192
    v_and_b32 v121, 0xffff0000, v192
    v_lshlrev_b32 v122, 16, v193
    v_and_b32 v123, 0xffff0000, v193
    v_lshlrev_b32 v124, 16, v194
    v_and_b32 v125, 0xffff0000, v194
    v_lshlrev_b32 v126, 16, v195
    v_and_b32 v127, 0xffff0000, v195
    v_pk_mul_f32 v[120:121], v[120:121], s[42:43]
    s_waitcnt lgkmcnt(0)
    v_mfma_f32_16x16x32_bf16 v[24:27], v[152:155], v[184:187], 0
    ds_read_b128 v[88:91], v216 offset:40960
    ds_read_b128 v[92:95], v217 offset:40960
    v_mfma_f32_16x16x32_bf16 v[24:27], v[156:159], v[188:191], v[24:27]
    v_cvt_pk_bf16_f32 v192, v120, v121
    v_lshlrev_b32 v80, 16, v196
    v_mfma_f32_16x16x32_bf16 v[44:47], v[168:171], v[184:187], 0
    v_and_b32 v81, 0xffff0000, v196
    ds_read_b128 v[96:99], v218 offset:40960
    v_mfma_f32_16x16x32_bf16 v[44:47], v[172:175], v[188:191], v[44:47]
    v_lshlrev_b32 v82, 16, v197
    v_and_b32 v83, 0xffff0000, v197
    ds_read_b128 v[100:103], v219 offset:40960
    ds_read_b128 v[104:107], v216 offset:45056
    ds_read_b128 v[108:111], v217 offset:45056
    ds_read_b128 v[112:115], v218 offset:45056
    ds_read_b128 v[116:119], v219 offset:45056
    v_pk_mul_f32 v[122:123], v[122:123], s[42:43]
    v_pk_mul_f32 v[124:125], v[124:125], s[42:43]
    v_pk_mul_f32 v[126:127], v[126:127], s[42:43]
    v_cvt_pk_bf16_f32 v193, v122, v123
    v_cvt_pk_bf16_f32 v194, v124, v125
    v_cvt_pk_bf16_f32 v195, v126, v127
    v_lshlrev_b32 v84, 16, v198
    v_and_b32 v85, 0xffff0000, v198
    v_mfma_f32_16x16x32_bf16 v[24:27], v[160:163], v[192:195], v[24:27]
    v_lshlrev_b32 v86, 16, v199
    v_and_b32 v87, 0xffff0000, v199
    v_mfma_f32_16x16x32_bf16 v[44:47], v[176:179], v[192:195], v[44:47]
    v_lshlrev_b32 v120, 16, v200
    v_and_b32 v121, 0xffff0000, v200
    v_pk_mul_f32 v[80:81], v[80:81], s[42:43]
    v_pk_mul_f32 v[82:83], v[82:83], s[42:43]
    v_pk_mul_f32 v[84:85], v[84:85], s[42:43]
    v_pk_mul_f32 v[86:87], v[86:87], s[42:43]
    v_cvt_pk_bf16_f32 v196, v80, v81
    v_cvt_pk_bf16_f32 v197, v82, v83
    v_cvt_pk_bf16_f32 v198, v84, v85
    v_cvt_pk_bf16_f32 v199, v86, v87
    v_lshlrev_b32 v122, 16, v201
    v_and_b32 v123, 0xffff0000, v201
    v_mfma_f32_16x16x32_bf16 v[24:27], v[164:167], v[196:199], v[24:27]
    v_lshlrev_b32 v124, 16, v202
    v_and_b32 v125, 0xffff0000, v202
    v_mfma_f32_16x16x32_bf16 v[44:47], v[180:183], v[196:199], v[44:47]
    s_waitcnt lgkmcnt(0)
    s_mul_i32 s36, s24, 16896
    s_add_u32 s36, s36, 32768
    s_mul_i32 s38, s24, 8448
    s_add_u32 s38, s38, 131072
    s_cmp_eq_u32 s24, 3
    s_cselect_b32 s38, 103488, s38
    s_lshl_b32 s37, s24, 9
    s_add_u32 s37, s37, 100352
    v_max3_f32 v144, v24, v25, v144
    v_max3_f32 v144, v26, v27, v144
    v_max3_f32 v144, v44, v45, v144
    v_max3_f32 v144, v46, v47, v144
    v_mov_b32 v145, v144
    v_lshlrev_b32 v126, 16, v203
    v_and_b32 v127, 0xffff0000, v203
    v_permlane16_swap_b32 v144, v145
    v_max_f32 v144, v144, v145
    v_mov_b32 v145, v144
    v_pk_mul_f32 v[120:121], v[120:121], s[42:43]
    v_pk_mul_f32 v[122:123], v[122:123], s[42:43]
    v_permlane32_swap_b32 v144, v145
    v_max_f32 v144, v144, v145
    v_sub_f32 v147, 0, v144
    v_sub_f32 v146, 0, v144
    v_sub_f32 v145, 0, v144
    v_sub_f32 v144, 0, v144
    v_pk_mul_f32 v[124:125], v[124:125], s[42:43]
    v_pk_mul_f32 v[126:127], v[126:127], s[42:43]
    v_cvt_pk_bf16_f32 v200, v120, v121
    v_cvt_pk_bf16_f32 v201, v122, v123
    v_cvt_pk_bf16_f32 v202, v124, v125
    v_cvt_pk_bf16_f32 v203, v126, v127
    v_lshlrev_b32 v80, 16, v204
    v_and_b32 v81, 0xffff0000, v204
    v_mfma_f32_16x16x32_bf16 v[24:27], v[152:155], v[200:203], 0
    v_lshlrev_b32 v82, 16, v205
    v_and_b32 v83, 0xffff0000, v205
    v_mfma_f32_16x16x32_bf16 v[44:47], v[168:171], v[200:203], 0
    v_lshlrev_b32 v84, 16, v206
    v_and_b32 v85, 0xffff0000, v206
    v_lshlrev_b32 v86, 16, v207
    v_and_b32 v87, 0xffff0000, v207
    v_pk_mul_f32 v[80:81], v[80:81], s[42:43]
    v_pk_mul_f32 v[82:83], v[82:83], s[42:43]
    v_pk_mul_f32 v[84:85], v[84:85], s[42:43]
    v_pk_mul_f32 v[86:87], v[86:87], s[42:43]
    v_cvt_pk_bf16_f32 v204, v80, v81
    v_cvt_pk_bf16_f32 v205, v82, v83
    v_cvt_pk_bf16_f32 v206, v84, v85
    v_cvt_pk_bf16_f32 v207, v86, v87
    v_lshlrev_b32 v120, 16, v208
    v_and_b32 v121, 0xffff0000, v208
    v_mfma_f32_16x16x32_bf16 v[24:27], v[156:159], v[204:207], v[24:27]
    v_lshlrev_b32 v122, 16, v209
    v_and_b32 v123, 0xffff0000, v209
    v_mfma_f32_16x16x32_bf16 v[44:47], v[172:175], v[204:207], v[44:47]
    v_lshlrev_b32 v124, 16, v210
    v_and_b32 v125, 0xffff0000, v210
    v_lshlrev_b32 v126, 16, v211
    v_and_b32 v127, 0xffff0000, v211
    v_pk_mul_f32 v[120:121], v[120:121], s[42:43]
    v_pk_mul_f32 v[122:123], v[122:123], s[42:43]
    v_pk_mul_f32 v[124:125], v[124:125], s[42:43]
    v_pk_mul_f32 v[126:127], v[126:127], s[42:43]
    v_cvt_pk_bf16_f32 v208, v120, v121
    v_cvt_pk_bf16_f32 v209, v122, v123
    v_cvt_pk_bf16_f32 v210, v124, v125
    v_cvt_pk_bf16_f32 v211, v126, v127
    v_lshlrev_b32 v80, 16, v212
    v_and_b32 v81, 0xffff0000, v212
    v_mfma_f32_16x16x32_bf16 v[24:27], v[160:163], v[208:211], v[24:27]
    v_lshlrev_b32 v82, 16, v213
    v_and_b32 v83, 0xffff0000, v213
    v_mfma_f32_16x16x32_bf16 v[44:47], v[176:179], v[208:211], v[44:47]
    v_lshlrev_b32 v84, 16, v214
    v_and_b32 v85, 0xffff0000, v214
    v_lshlrev_b32 v86, 16, v215
    v_and_b32 v87, 0xffff0000, v215
    v_pk_mul_f32 v[80:81], v[80:81], s[42:43]
    v_pk_mul_f32 v[82:83], v[82:83], s[42:43]
    v_pk_mul_f32 v[84:85], v[84:85], s[42:43]
    v_pk_mul_f32 v[86:87], v[86:87], s[42:43]
    v_cvt_pk_bf16_f32 v212, v80, v81
    v_cvt_pk_bf16_f32 v213, v82, v83
    v_cvt_pk_bf16_f32 v214, v84, v85
    v_cvt_pk_bf16_f32 v215, v86, v87
    v_and_b32 v80, 15, v0
    v_lshrrev_b32 v81, 4, v0
    v_mfma_f32_16x16x32_bf16 v[24:27], v[164:167], v[212:215], v[24:27]
    v_mul_u32_u24 v82, 2112, v81
    v_lshl_add_u32 v82, v80, 2, v82
    v_mfma_f32_16x16x32_bf16 v[44:47], v[180:183], v[212:215], v[44:47]
    v_add_u32 v2, s36, v82
    v_add_u32 v4, s38, v82
    v_mul_u32_u24 v82, 528, v81
    v_lshl_add_u32 v82, v80, 5, v82
    v_add_u32 v5, s38, v82
    v_lshlrev_b32 v82, 2, v0
    v_max3_f32 v148, v24, v25, v148
    v_max3_f32 v148, v26, v27, v148
    v_add_u32 v3, s37, v82
    s_lshl_b32 s37, s24, 8
    s_add_u32 s37, s37, 102464
    s_and_b32 s39, s24, 1
    s_lshr_b32 s40, s24, 1
    s_mul_i32 s36, s39, 16896
    v_max3_f32 v148, v44, v45, v148
    v_max3_f32 v148, v46, v47, v148
    v_mov_b32 v149, v148
    v_lshl_add_u32 v254, v80, 2, s37
    v_lshl_add_u32 v255, v81, 2, s37
    s_mul_i32 s37, s40, 4224
    s_add_u32 s36, s36, s37
    s_add_u32 s36, s36, 32768
    s_mul_i32 s37, s24, 2112
    s_add_u32 s37, s37, 41216
    v_permlane16_swap_b32 v148, v149
    v_max_f32 v148, v148, v149
    v_mov_b32 v149, v148
    v_and_b32 v80, 15, v0
    v_lshrrev_b32 v81, 4, v0
    v_permlane32_swap_b32 v148, v149
    v_max_f32 v148, v148, v149
    v_sub_f32 v151, 0, v148
    v_sub_f32 v150, 0, v148
    v_sub_f32 v149, 0, v148
    v_sub_f32 v148, 0, v148
    v_mul_u32_u24 v82, 528, v81
    v_lshl_add_u32 v82, v80, 5, v82
    v_add_u32 v6, s36, v82
    s_lshl_b32 s36, s39, 9
    v_add_u32 v252, s37, v82
    s_lshl_b32 s37, s40, 5
    s_add_u32 s36, s36, s37
    s_add_u32 s36, s36, 100352
    s_lshl_b32 s37, s24, 4
    s_add_u32 s37, s37, 100608
    s_lshl_b32 s4, s24, 14
    s_add_u32 s5, s4, 4096
    s_add_u32 s6, s4, 8192
    s_add_u32 s7, s4, 12288
    v_lshlrev_b32 v83, 2, v81
    v_add_u32 v7, s36, v83
    s_lshl_b32 s36, s39, 12
    v_add_u32 v253, s37, v83
    s_lshl_b32 s37, s40, 11
    s_add_u32 s36, s36, s37
    s_add_u32 s35, s36, 65536
    s_lshl_b32 s36, s24, 10
    s_add_u32 s41, s36, 73728
    s_waitcnt vmcnt(12)
    s_mov_b32 m0, s28
    s_nop 0
    buffer_load_dwordx4 v228, s[8:11], s26 offen offset:0 nt lds
    buffer_load_dwordx4 v229, s[8:11], s26 offen offset:1024 nt lds
    buffer_load_dwordx4 v230, s[8:11], s26 offen offset:2048 nt lds
    buffer_load_dwordx4 v231, s[8:11], s26 offen offset:3072 nt lds
    s_add_u32 s28, s28, 32768
    s_and_b32 s28, s28, 131071
    s_add_u32 s26, s26, 16384
    s_cmp_lt_u32 s26, 524288
    s_cselect_b32 s10, 524288, 0
    ds_read_b128 v[48:51], v248 offset:0
    ds_read_b128 v[52:55], v249 offset:0
    ds_read_b128 v[8:11], v250 offset:0
    ds_read_b128 v[28:31], v251 offset:0
    s_waitcnt lgkmcnt(0)
    v_lshlrev_b32 v120, 16, v48
    v_and_b32 v121, 0xffff0000, v48
    v_lshlrev_b32 v122, 16, v49
    v_and_b32 v123, 0xffff0000, v49
    v_lshlrev_b32 v124, 16, v50
    v_and_b32 v125, 0xffff0000, v50
    v_lshlrev_b32 v126, 16, v51
    v_and_b32 v127, 0xffff0000, v51
    v_pk_mul_f32 v[120:121], v[120:121], s[42:43]
    v_pk_mul_f32 v[122:123], v[122:123], s[42:43]
    v_pk_mul_f32 v[124:125], v[124:125], s[42:43]
    v_pk_mul_f32 v[126:127], v[126:127], s[42:43]
    v_cvt_pk_bf16_f32 v120, v120, v121
    v_cvt_pk_bf16_f32 v122, v122, v123
    v_cvt_pk_bf16_f32 v124, v124, v125
    v_cvt_pk_bf16_f32 v126, v126, v127
    v_accvgpr_write_b32 a192, v120
    v_accvgpr_write_b32 a193, v122
    v_accvgpr_write_b32 a194, v124
    v_accvgpr_write_b32 a195, v126
    v_lshlrev_b32 v80, 16, v52
    v_and_b32 v81, 0xffff0000, v52
    v_lshlrev_b32 v82, 16, v53
    v_and_b32 v83, 0xffff0000, v53
    v_lshlrev_b32 v84, 16, v54
    v_and_b32 v85, 0xffff0000, v54
    v_lshlrev_b32 v86, 16, v55
    v_and_b32 v87, 0xffff0000, v55
    v_pk_mul_f32 v[80:81], v[80:81], s[42:43]
    v_pk_mul_f32 v[82:83], v[82:83], s[42:43]
    v_pk_mul_f32 v[84:85], v[84:85], s[42:43]
    v_pk_mul_f32 v[86:87], v[86:87], s[42:43]
    v_cvt_pk_bf16_f32 v80, v80, v81
    v_cvt_pk_bf16_f32 v82, v82, v83
    v_cvt_pk_bf16_f32 v84, v84, v85
    v_cvt_pk_bf16_f32 v86, v86, v87
    v_accvgpr_write_b32 a196, v80
    v_accvgpr_write_b32 a197, v82
    v_accvgpr_write_b32 a198, v84
    v_accvgpr_write_b32 a199, v86
    v_lshlrev_b32 v120, 16, v8
    v_and_b32 v121, 0xffff0000, v8
    v_lshlrev_b32 v122, 16, v9
    v_and_b32 v123, 0xffff0000, v9
    v_lshlrev_b32 v124, 16, v10
    v_and_b32 v125, 0xffff0000, v10
    v_lshlrev_b32 v126, 16, v11
    v_and_b32 v127, 0xffff0000, v11
    v_mfma_f32_16x16x32_bf16 v[8:11], v[152:155], a[192:195], 0
    v_lshlrev_b32 v80, 16, v28
    v_and_b32 v81, 0xffff0000, v28
    v_mfma_f32_16x16x32_bf16 v[8:11], v[156:159], a[196:199], v[8:11]
    v_lshlrev_b32 v82, 16, v29
    v_and_b32 v83, 0xffff0000, v29
    v_pk_mul_f32 v[120:121], v[120:121], s[42:43]
    v_pk_mul_f32 v[122:123], v[122:123], s[42:43]
    v_pk_mul_f32 v[124:125], v[124:125], s[42:43]
    v_pk_mul_f32 v[126:127], v[126:127], s[42:43]
    v_cvt_pk_bf16_f32 v120, v120, v121
    v_cvt_pk_bf16_f32 v122, v122, v123
    v_cvt_pk_bf16_f32 v124, v124, v125
    v_cvt_pk_bf16_f32 v126, v126, v127
    v_accvgpr_write_b32 a200, v120
    v_accvgpr_write_b32 a201, v122
    v_accvgpr_write_b32 a202, v124
    v_accvgpr_write_b32 a203, v126
    v_lshlrev_b32 v84, 16, v30
    v_and_b32 v85, 0xffff0000, v30
    v_mfma_f32_16x16x32_bf16 v[8:11], v[160:163], a[200:203], v[8:11]
    v_lshlrev_b32 v86, 16, v31
    v_and_b32 v87, 0xffff0000, v31
    v_mfma_f32_16x16x32_bf16 v[28:31], v[168:171], a[192:195], 0
    v_mfma_f32_16x16x32_bf16 v[28:31], v[172:175], a[196:199], v[28:31]
    v_mfma_f32_16x16x32_bf16 v[28:31], v[176:179], a[200:203], v[28:31]
    v_pk_mul_f32 v[80:81], v[80:81], s[42:43]
    v_pk_mul_f32 v[82:83], v[82:83], s[42:43]
    v_pk_mul_f32 v[84:85], v[84:85], s[42:43]
    v_pk_mul_f32 v[86:87], v[86:87], s[42:43]
    v_cvt_pk_bf16_f32 v80, v80, v81
    v_cvt_pk_bf16_f32 v82, v82, v83
    v_cvt_pk_bf16_f32 v84, v84, v85
    v_cvt_pk_bf16_f32 v86, v86, v87
    v_accvgpr_write_b32 a204, v80
    v_accvgpr_write_b32 a205, v82
    v_accvgpr_write_b32 a206, v84
    v_accvgpr_write_b32 a207, v86
    s_nop 1
    v_mfma_f32_16x16x32_bf16 v[8:11], v[164:167], a[204:207], v[8:11]
    v_mfma_f32_16x16x32_bf16 v[28:31], v[180:183], a[204:207], v[28:31]
    s_nop 6
    v_max3_f32 v128, v8, v9, v128
    v_max3_f32 v128, v10, v11, v128
    v_max3_f32 v128, v28, v29, v128
    v_max3_f32 v128, v30, v31, v128
    v_mov_b32 v129, v128
    s_nop 1
    v_permlane16_swap_b32 v128, v129
    v_max_f32 v128, v128, v129
    v_mov_b32 v129, v128
    s_nop 1
    v_permlane32_swap_b32 v128, v129
    v_max_f32 v128, v128, v129
    v_sub_f32 v131, 0, v128
    v_sub_f32 v130, 0, v128
    v_sub_f32 v129, 0, v128
    s_waitcnt vmcnt(12)
    s_mov_b32 m0, s29
    s_nop 0
    buffer_load_dwordx4 v232, s[12:15], s27 offen offset:0 nt lds
    buffer_load_dwordx4 v233, s[12:15], s27 offen offset:1024 nt lds
    buffer_load_dwordx4 v232, s[12:15], s27 offen offset:2048 nt lds
    buffer_load_dwordx4 v233, s[12:15], s27 offen offset:3072 nt lds
    s_add_u32 s29, s29, 32768
    s_and_b32 s29, s29, 131071
    s_add_u32 s27, s27, 16384
    s_cmp_lt_u32 s27, 524288
    s_cselect_b32 s14, 524288, 0
    ds_read_b128 v[56:59], v248 offset:16384
    ds_read_b128 v[60:63], v249 offset:16384
    ds_read_b128 v[12:15], v250 offset:16384
    ds_read_b128 v[32:35], v251 offset:16384
    v_sub_f32 v128, 0, v128
    v_add_f32 v8, v8, v131
    v_add_f32 v9, v9, v131
    v_add_f32 v10, v10, v131
    v_add_f32 v11, v11, v131
    v_add_f32 v28, v28, v131
    v_add_f32 v29, v29, v131
    v_add_f32 v30, v30, v131
    v_add_f32 v31, v31, v131
    v_exp_f32 v8, v8
    v_exp_f32 v9, v9
    v_exp_f32 v10, v10
    v_exp_f32 v11, v11
    v_cvt_pk_bf16_f32 v48, v8, v9
    v_cvt_pk_bf16_f32 v49, v10, v11
    v_mfma_f32_16x16x32_bf16 v[8:11], v[88:91], a[192:195], v[128:131]
    v_exp_f32 v28, v28
    v_mfma_f32_16x16x32_bf16 v[8:11], v[92:95], a[196:199], v[8:11]
    v_exp_f32 v29, v29
    v_mfma_f32_16x16x32_bf16 v[8:11], v[96:99], a[200:203], v[8:11]
    v_exp_f32 v30, v30
    v_mfma_f32_16x16x32_bf16 v[8:11], v[100:103], a[204:207], v[8:11]
    s_waitcnt lgkmcnt(0)
    v_exp_f32 v31, v31
    v_cvt_pk_bf16_f32 v50, v28, v29
    v_cvt_pk_bf16_f32 v51, v30, v31
    v_mfma_f32_16x16x32_bf16 v[28:31], v[104:107], a[192:195], v[128:131]
    v_lshlrev_b32 v120, 16, v56
    v_and_b32 v121, 0xffff0000, v56
    v_mfma_f32_16x16x32_bf16 v[28:31], v[108:111], a[196:199], v[28:31]
    v_lshlrev_b32 v122, 16, v57
    v_and_b32 v123, 0xffff0000, v57
    v_mfma_f32_16x16x32_bf16 v[28:31], v[112:115], a[200:203], v[28:31]
    v_lshlrev_b32 v124, 16, v58
    v_and_b32 v125, 0xffff0000, v58
    v_mfma_f32_16x16x32_bf16 v[28:31], v[116:119], a[204:207], v[28:31]
    v_lshlrev_b32 v126, 16, v59
    v_and_b32 v127, 0xffff0000, v59
    v_pk_mul_f32 v[120:121], v[120:121], s[42:43]
    v_pk_mul_f32 v[122:123], v[122:123], s[42:43]
    v_pk_mul_f32 v[124:125], v[124:125], s[42:43]
    v_pk_mul_f32 v[126:127], v[126:127], s[42:43]
    v_cvt_pk_bf16_f32 v120, v120, v121
    v_cvt_pk_bf16_f32 v122, v122, v123
    v_cvt_pk_bf16_f32 v124, v124, v125
    v_cvt_pk_bf16_f32 v126, v126, v127
    v_accvgpr_write_b32 a208, v120
    v_accvgpr_write_b32 a209, v122
    v_accvgpr_write_b32 a210, v124
    v_accvgpr_write_b32 a211, v126
    v_lshlrev_b32 v80, 16, v60
    v_and_b32 v81, 0xffff0000, v60
    v_lshlrev_b32 v82, 16, v61
    v_and_b32 v83, 0xffff0000, v61
    v_lshlrev_b32 v84, 16, v62
    v_and_b32 v85, 0xffff0000, v62
    v_lshlrev_b32 v86, 16, v63
    v_and_b32 v87, 0xffff0000, v63
    v_pk_mul_f32 v[80:81], v[80:81], s[42:43]
    v_pk_mul_f32 v[82:83], v[82:83], s[42:43]
    v_pk_mul_f32 v[84:85], v[84:85], s[42:43]
    v_pk_mul_f32 v[86:87], v[86:87], s[42:43]
    v_cvt_pk_bf16_f32 v80, v80, v81
    v_cvt_pk_bf16_f32 v82, v82, v83
    v_cvt_pk_bf16_f32 v84, v84, v85
    v_cvt_pk_bf16_f32 v86, v86, v87
    v_accvgpr_write_b32 a212, v80
    v_accvgpr_write_b32 a213, v82
    v_accvgpr_write_b32 a214, v84
    v_accvgpr_write_b32 a215, v86
    v_lshlrev_b32 v120, 16, v12
    v_and_b32 v121, 0xffff0000, v12
    v_lshlrev_b32 v122, 16, v13
    v_and_b32 v123, 0xffff0000, v13
    v_lshlrev_b32 v124, 16, v14
    v_and_b32 v125, 0xffff0000, v14
    v_lshlrev_b32 v126, 16, v15
    v_and_b32 v127, 0xffff0000, v15
    v_mfma_f32_16x16x32_bf16 v[12:15], v[152:155], a[208:211], 0
    v_lshlrev_b32 v80, 16, v32
    v_and_b32 v81, 0xffff0000, v32
    v_mfma_f32_16x16x32_bf16 v[12:15], v[156:159], a[212:215], v[12:15]
    v_lshlrev_b32 v82, 16, v33
    v_and_b32 v83, 0xffff0000, v33
    v_pk_mul_f32 v[120:121], v[120:121], s[42:43]
    v_pk_mul_f32 v[122:123], v[122:123], s[42:43]
    v_pk_mul_f32 v[124:125], v[124:125], s[42:43]
    v_pk_mul_f32 v[126:127], v[126:127], s[42:43]
    v_cvt_pk_bf16_f32 v120, v120, v121
    v_cvt_pk_bf16_f32 v122, v122, v123
    v_cvt_pk_bf16_f32 v124, v124, v125
    v_cvt_pk_bf16_f32 v126, v126, v127
    v_accvgpr_write_b32 a216, v120
    v_accvgpr_write_b32 a217, v122
    v_accvgpr_write_b32 a218, v124
    v_accvgpr_write_b32 a219, v126
    v_lshlrev_b32 v84, 16, v34
    v_and_b32 v85, 0xffff0000, v34
    v_mfma_f32_16x16x32_bf16 v[12:15], v[160:163], a[216:219], v[12:15]
    v_lshlrev_b32 v86, 16, v35
    v_and_b32 v87, 0xffff0000, v35
    v_mfma_f32_16x16x32_bf16 v[32:35], v[168:171], a[208:211], 0
    v_xor_b32 v216, 0x10000, v216
    v_xor_b32 v217, 0x10000, v217
    v_mfma_f32_16x16x32_bf16 v[32:35], v[172:175], a[212:215], v[32:35]
    v_xor_b32 v218, 0x10000, v218
    v_xor_b32 v219, 0x10000, v219
    v_mfma_f32_16x16x32_bf16 v[32:35], v[176:179], a[216:219], v[32:35]
    v_pk_mul_f32 v[80:81], v[80:81], s[42:43]
    v_pk_mul_f32 v[82:83], v[82:83], s[42:43]
    v_pk_mul_f32 v[84:85], v[84:85], s[42:43]
    v_pk_mul_f32 v[86:87], v[86:87], s[42:43]
    v_cvt_pk_bf16_f32 v80, v80, v81
    v_cvt_pk_bf16_f32 v82, v82, v83
    v_cvt_pk_bf16_f32 v84, v84, v85
    v_cvt_pk_bf16_f32 v86, v86, v87
    v_accvgpr_write_b32 a220, v80
    v_accvgpr_write_b32 a221, v82
    v_accvgpr_write_b32 a222, v84
    v_accvgpr_write_b32 a223, v86
    s_nop 1
    v_mfma_f32_16x16x32_bf16 v[12:15], v[164:167], a[220:223], v[12:15]
    v_mfma_f32_16x16x32_bf16 v[32:35], v[180:183], a[220:223], v[32:35]
    s_nop 6
    v_max3_f32 v132, v12, v13, v132
    v_max3_f32 v132, v14, v15, v132
    v_max3_f32 v132, v32, v33, v132
    v_max3_f32 v132, v34, v35, v132
    v_mov_b32 v133, v132
    s_nop 1
    v_permlane16_swap_b32 v132, v133
    v_max_f32 v132, v132, v133
    v_mov_b32 v133, v132
    s_nop 1
    v_permlane32_swap_b32 v132, v133
    v_max_f32 v132, v132, v133
    v_sub_f32 v135, 0, v132
    v_sub_f32 v134, 0, v132
    v_sub_f32 v133, 0, v132
    v_sub_f32 v132, 0, v132
    v_add_f32 v12, v12, v135
    v_add_f32 v13, v13, v135
    v_add_f32 v14, v14, v135
    v_add_f32 v15, v15, v135
    v_add_f32 v32, v32, v135
    v_add_f32 v33, v33, v135
    v_add_f32 v34, v34, v135
    v_add_f32 v35, v35, v135
    v_exp_f32 v12, v12
    v_exp_f32 v13, v13
    v_exp_f32 v14, v14
    v_exp_f32 v15, v15
    v_cvt_pk_bf16_f32 v56, v12, v13
    v_cvt_pk_bf16_f32 v57, v14, v15
    v_mfma_f32_16x16x32_bf16 v[12:15], v[88:91], a[208:211], v[132:135]
    v_exp_f32 v32, v32
    v_mfma_f32_16x16x32_bf16 v[12:15], v[92:95], a[212:215], v[12:15]
    v_exp_f32 v33, v33
    v_mfma_f32_16x16x32_bf16 v[12:15], v[96:99], a[216:219], v[12:15]
    v_exp_f32 v34, v34
    v_mfma_f32_16x16x32_bf16 v[12:15], v[100:103], a[220:223], v[12:15]
    v_exp_f32 v35, v35
    v_cvt_pk_bf16_f32 v58, v32, v33
    v_cvt_pk_bf16_f32 v59, v34, v35
    v_mfma_f32_16x16x32_bf16 v[32:35], v[104:107], a[208:211], v[132:135]
    v_mfma_f32_16x16x32_bf16 v[32:35], v[108:111], a[212:215], v[32:35]
    v_mfma_f32_16x16x32_bf16 v[32:35], v[112:115], a[216:219], v[32:35]
    v_mfma_f32_16x16x32_bf16 v[32:35], v[116:119], a[220:223], v[32:35]
    s_waitcnt vmcnt(12)
    s_mov_b32 m0, s28
    s_nop 0
    buffer_load_dwordx4 v228, s[8:11], s26 offen offset:0 nt lds
    buffer_load_dwordx4 v229, s[8:11], s26 offen offset:1024 nt lds
    buffer_load_dwordx4 v230, s[8:11], s26 offen offset:2048 nt lds
    buffer_load_dwordx4 v231, s[8:11], s26 offen offset:3072 nt lds
    s_add_u32 s28, s28, 32768
    s_and_b32 s28, s28, 131071
    s_add_u32 s26, s26, 16384
    s_cmp_lt_u32 s26, 524288
    s_cselect_b32 s10, 524288, 0
    ds_read_b128 v[64:67], v248 offset:32768
    ds_read_b128 v[68:71], v249 offset:32768
    ds_read_b128 v[16:19], v250 offset:32768
    ds_read_b128 v[36:39], v251 offset:32768
    s_waitcnt lgkmcnt(0)
    v_lshlrev_b32 v120, 16, v64
    v_and_b32 v121, 0xffff0000, v64
    v_lshlrev_b32 v122, 16, v65
    v_and_b32 v123, 0xffff0000, v65
    v_lshlrev_b32 v124, 16, v66
    v_and_b32 v125, 0xffff0000, v66
    v_lshlrev_b32 v126, 16, v67
    v_and_b32 v127, 0xffff0000, v67
    v_pk_mul_f32 v[120:121], v[120:121], s[42:43]
    v_pk_mul_f32 v[122:123], v[122:123], s[42:43]
    v_pk_mul_f32 v[124:125], v[124:125], s[42:43]
    v_pk_mul_f32 v[126:127], v[126:127], s[42:43]
    v_cvt_pk_bf16_f32 v120, v120, v121
    v_cvt_pk_bf16_f32 v122, v122, v123
    v_cvt_pk_bf16_f32 v124, v124, v125
    v_cvt_pk_bf16_f32 v126, v126, v127
    v_accvgpr_write_b32 a224, v120
    v_accvgpr_write_b32 a225, v122
    v_accvgpr_write_b32 a226, v124
    v_accvgpr_write_b32 a227, v126
    v_lshlrev_b32 v80, 16, v68
    v_and_b32 v81, 0xffff0000, v68
    v_lshlrev_b32 v82, 16, v69
    v_and_b32 v83, 0xffff0000, v69
    v_lshlrev_b32 v84, 16, v70
    v_and_b32 v85, 0xffff0000, v70
    v_lshlrev_b32 v86, 16, v71
    v_and_b32 v87, 0xffff0000, v71
    v_pk_mul_f32 v[80:81], v[80:81], s[42:43]
    v_pk_mul_f32 v[82:83], v[82:83], s[42:43]
    v_pk_mul_f32 v[84:85], v[84:85], s[42:43]
    v_pk_mul_f32 v[86:87], v[86:87], s[42:43]
    v_cvt_pk_bf16_f32 v80, v80, v81
    v_cvt_pk_bf16_f32 v82, v82, v83
    v_cvt_pk_bf16_f32 v84, v84, v85
    v_cvt_pk_bf16_f32 v86, v86, v87
    v_accvgpr_write_b32 a228, v80
    v_accvgpr_write_b32 a229, v82
    v_accvgpr_write_b32 a230, v84
    v_accvgpr_write_b32 a231, v86
    v_lshlrev_b32 v120, 16, v16
    v_and_b32 v121, 0xffff0000, v16
    v_lshlrev_b32 v122, 16, v17
    v_and_b32 v123, 0xffff0000, v17
    v_lshlrev_b32 v124, 16, v18
    v_and_b32 v125, 0xffff0000, v18
    v_lshlrev_b32 v126, 16, v19
    v_and_b32 v127, 0xffff0000, v19
    v_mfma_f32_16x16x32_bf16 v[16:19], v[152:155], a[224:227], 0
    v_lshlrev_b32 v80, 16, v36
    v_and_b32 v81, 0xffff0000, v36
    v_mfma_f32_16x16x32_bf16 v[16:19], v[156:159], a[228:231], v[16:19]
    v_lshlrev_b32 v82, 16, v37
    v_and_b32 v83, 0xffff0000, v37
    v_pk_mul_f32 v[120:121], v[120:121], s[42:43]
    v_pk_mul_f32 v[122:123], v[122:123], s[42:43]
    v_pk_mul_f32 v[124:125], v[124:125], s[42:43]
    v_pk_mul_f32 v[126:127], v[126:127], s[42:43]
    v_cvt_pk_bf16_f32 v120, v120, v121
    v_cvt_pk_bf16_f32 v122, v122, v123
    v_cvt_pk_bf16_f32 v124, v124, v125
    v_cvt_pk_bf16_f32 v126, v126, v127
    v_accvgpr_write_b32 a232, v120
    v_accvgpr_write_b32 a233, v122
    v_accvgpr_write_b32 a234, v124
    v_accvgpr_write_b32 a235, v126
    v_lshlrev_b32 v84, 16, v38
    v_and_b32 v85, 0xffff0000, v38
    v_mfma_f32_16x16x32_bf16 v[16:19], v[160:163], a[232:235], v[16:19]
    v_lshlrev_b32 v86, 16, v39
    v_and_b32 v87, 0xffff0000, v39
    v_mfma_f32_16x16x32_bf16 v[36:39], v[168:171], a[224:227], 0
    v_mfma_f32_16x16x32_bf16 v[36:39], v[172:175], a[228:231], v[36:39]
    v_mfma_f32_16x16x32_bf16 v[36:39], v[176:179], a[232:235], v[36:39]
    v_pk_mul_f32 v[80:81], v[80:81], s[42:43]
    v_pk_mul_f32 v[82:83], v[82:83], s[42:43]
    v_pk_mul_f32 v[84:85], v[84:85], s[42:43]
    v_pk_mul_f32 v[86:87], v[86:87], s[42:43]
    v_cvt_pk_bf16_f32 v80, v80, v81
    v_cvt_pk_bf16_f32 v82, v82, v83
    v_cvt_pk_bf16_f32 v84, v84, v85
    v_cvt_pk_bf16_f32 v86, v86, v87
    v_accvgpr_write_b32 a236, v80
    v_accvgpr_write_b32 a237, v82
    v_accvgpr_write_b32 a238, v84
    v_accvgpr_write_b32 a239, v86
    s_nop 1
    v_mfma_f32_16x16x32_bf16 v[16:19], v[164:167], a[236:239], v[16:19]
    v_mfma_f32_16x16x32_bf16 v[36:39], v[180:183], a[236:239], v[36:39]
    s_nop 6
    v_max3_f32 v136, v16, v17, v136
    v_max3_f32 v136, v18, v19, v136
    v_max3_f32 v136, v36, v37, v136
    v_max3_f32 v136, v38, v39, v136
    v_mov_b32 v137, v136
    s_nop 1
    v_permlane16_swap_b32 v136, v137
    v_max_f32 v136, v136, v137
    v_mov_b32 v137, v136
    s_nop 1
    v_permlane32_swap_b32 v136, v137
    v_max_f32 v136, v136, v137
    v_sub_f32 v139, 0, v136
    v_sub_f32 v138, 0, v136
    v_sub_f32 v137, 0, v136
    v_sub_f32 v136, 0, v136
    v_add_f32 v16, v16, v139
    v_add_f32 v17, v17, v139
    v_add_f32 v18, v18, v139
    v_add_f32 v19, v19, v139
    v_add_f32 v36, v36, v139
    v_add_f32 v37, v37, v139
    v_add_f32 v38, v38, v139
    v_add_f32 v39, v39, v139
    v_exp_f32 v16, v16
    v_exp_f32 v17, v17
    v_exp_f32 v18, v18
    v_exp_f32 v19, v19
    v_add_f32 v236, v16, v236
    v_add_f32 v236, v17, v236
    v_cvt_pk_bf16_f32 v64, v16, v17
    v_add_f32 v236, v18, v236
    v_add_f32 v236, v19, v236
    v_cvt_pk_bf16_f32 v65, v18, v19
    v_mfma_f32_16x16x32_bf16 v[16:19], v[88:91], a[224:227], v[136:139]
    v_exp_f32 v36, v36
    v_mfma_f32_16x16x32_bf16 v[16:19], v[92:95], a[228:231], v[16:19]
    v_exp_f32 v37, v37
    v_mfma_f32_16x16x32_bf16 v[16:19], v[96:99], a[232:235], v[16:19]
    v_exp_f32 v38, v38
    v_mfma_f32_16x16x32_bf16 v[16:19], v[100:103], a[236:239], v[16:19]
    v_exp_f32 v39, v39
    v_add_f32 v236, v36, v236
    v_add_f32 v236, v37, v236
    v_cvt_pk_bf16_f32 v66, v36, v37
    v_add_f32 v236, v38, v236
    v_add_f32 v236, v39, v236
    v_cvt_pk_bf16_f32 v67, v38, v39
    v_mfma_f32_16x16x32_bf16 v[36:39], v[104:107], a[224:227], v[136:139]
    v_mfma_f32_16x16x32_bf16 v[36:39], v[108:111], a[228:231], v[36:39]
    v_mfma_f32_16x16x32_bf16 v[36:39], v[112:115], a[232:235], v[36:39]
    v_mfma_f32_16x16x32_bf16 v[36:39], v[116:119], a[236:239], v[36:39]
    s_waitcnt vmcnt(12)
    s_mov_b32 m0, s29
    s_nop 0
    buffer_load_dwordx4 v232, s[12:15], s27 offen offset:0 nt lds
    buffer_load_dwordx4 v233, s[12:15], s27 offen offset:1024 nt lds
    buffer_load_dwordx4 v232, s[12:15], s27 offen offset:2048 nt lds
    buffer_load_dwordx4 v233, s[12:15], s27 offen offset:3072 nt lds
    s_add_u32 s29, s29, 32768
    s_and_b32 s29, s29, 131071
    s_add_u32 s27, s27, 16384
    s_cmp_lt_u32 s27, 524288
    s_cselect_b32 s14, 524288, 0
    ds_read_b128 v[72:75], v248 offset:49152
    ds_read_b128 v[76:79], v249 offset:49152
    ds_read_b128 v[20:23], v250 offset:49152
    ds_read_b128 v[40:43], v251 offset:49152
    s_waitcnt lgkmcnt(0)
    v_lshlrev_b32 v120, 16, v72
    v_and_b32 v121, 0xffff0000, v72
    v_lshlrev_b32 v122, 16, v73
    v_and_b32 v123, 0xffff0000, v73
    v_lshlrev_b32 v124, 16, v74
    v_and_b32 v125, 0xffff0000, v74
    v_lshlrev_b32 v126, 16, v75
    v_and_b32 v127, 0xffff0000, v75
    v_pk_mul_f32 v[120:121], v[120:121], s[42:43]
    v_pk_mul_f32 v[122:123], v[122:123], s[42:43]
    v_pk_mul_f32 v[124:125], v[124:125], s[42:43]
    v_pk_mul_f32 v[126:127], v[126:127], s[42:43]
    v_cvt_pk_bf16_f32 v120, v120, v121
    v_cvt_pk_bf16_f32 v122, v122, v123
    v_cvt_pk_bf16_f32 v124, v124, v125
    v_cvt_pk_bf16_f32 v126, v126, v127
    v_accvgpr_write_b32 a240, v120
    v_accvgpr_write_b32 a241, v122
    v_accvgpr_write_b32 a242, v124
    v_accvgpr_write_b32 a243, v126
    v_lshlrev_b32 v80, 16, v76
    v_and_b32 v81, 0xffff0000, v76
    v_lshlrev_b32 v82, 16, v77
    v_and_b32 v83, 0xffff0000, v77
    v_lshlrev_b32 v84, 16, v78
    v_and_b32 v85, 0xffff0000, v78
    v_lshlrev_b32 v86, 16, v79
    v_and_b32 v87, 0xffff0000, v79
    v_pk_mul_f32 v[80:81], v[80:81], s[42:43]
    v_pk_mul_f32 v[82:83], v[82:83], s[42:43]
    v_pk_mul_f32 v[84:85], v[84:85], s[42:43]
    v_pk_mul_f32 v[86:87], v[86:87], s[42:43]
    v_cvt_pk_bf16_f32 v80, v80, v81
    v_cvt_pk_bf16_f32 v82, v82, v83
    v_cvt_pk_bf16_f32 v84, v84, v85
    v_cvt_pk_bf16_f32 v86, v86, v87
    v_accvgpr_write_b32 a244, v80
    v_accvgpr_write_b32 a245, v82
    v_accvgpr_write_b32 a246, v84
    v_accvgpr_write_b32 a247, v86
    v_lshlrev_b32 v120, 16, v20
    v_and_b32 v121, 0xffff0000, v20
    v_lshlrev_b32 v122, 16, v21
    v_and_b32 v123, 0xffff0000, v21
    v_lshlrev_b32 v124, 16, v22
    v_and_b32 v125, 0xffff0000, v22
    v_lshlrev_b32 v126, 16, v23
    v_and_b32 v127, 0xffff0000, v23
    v_mfma_f32_16x16x32_bf16 v[20:23], v[152:155], a[240:243], 0
    v_lshlrev_b32 v80, 16, v40
    v_and_b32 v81, 0xffff0000, v40
    v_mfma_f32_16x16x32_bf16 v[20:23], v[156:159], a[244:247], v[20:23]
    v_lshlrev_b32 v82, 16, v41
    v_and_b32 v83, 0xffff0000, v41
    v_pk_mul_f32 v[120:121], v[120:121], s[42:43]
    v_pk_mul_f32 v[122:123], v[122:123], s[42:43]
    v_pk_mul_f32 v[124:125], v[124:125], s[42:43]
    v_pk_mul_f32 v[126:127], v[126:127], s[42:43]
    v_cvt_pk_bf16_f32 v120, v120, v121
    v_cvt_pk_bf16_f32 v122, v122, v123
    v_cvt_pk_bf16_f32 v124, v124, v125
    v_cvt_pk_bf16_f32 v126, v126, v127
    v_accvgpr_write_b32 a248, v120
    v_accvgpr_write_b32 a249, v122
    v_accvgpr_write_b32 a250, v124
    v_accvgpr_write_b32 a251, v126
    v_lshlrev_b32 v84, 16, v42
    v_and_b32 v85, 0xffff0000, v42
    v_mfma_f32_16x16x32_bf16 v[20:23], v[160:163], a[248:251], v[20:23]
    v_lshlrev_b32 v86, 16, v43
    v_and_b32 v87, 0xffff0000, v43
    v_mfma_f32_16x16x32_bf16 v[40:43], v[168:171], a[240:243], 0
    v_mfma_f32_16x16x32_bf16 v[40:43], v[172:175], a[244:247], v[40:43]
    v_mfma_f32_16x16x32_bf16 v[40:43], v[176:179], a[248:251], v[40:43]
    v_pk_mul_f32 v[80:81], v[80:81], s[42:43]
    v_pk_mul_f32 v[82:83], v[82:83], s[42:43]
    v_pk_mul_f32 v[84:85], v[84:85], s[42:43]
    v_pk_mul_f32 v[86:87], v[86:87], s[42:43]
    v_cvt_pk_bf16_f32 v80, v80, v81
    v_cvt_pk_bf16_f32 v82, v82, v83
    v_cvt_pk_bf16_f32 v84, v84, v85
    v_cvt_pk_bf16_f32 v86, v86, v87
    v_accvgpr_write_b32 a252, v80
    v_accvgpr_write_b32 a253, v82
    v_accvgpr_write_b32 a254, v84
    v_accvgpr_write_b32 a255, v86
    s_nop 1
    v_mfma_f32_16x16x32_bf16 v[20:23], v[164:167], a[252:255], v[20:23]
    v_mfma_f32_16x16x32_bf16 v[40:43], v[180:183], a[252:255], v[40:43]
    s_nop 6
    v_max3_f32 v140, v20, v21, v140
    v_max3_f32 v140, v22, v23, v140
    v_max3_f32 v140, v40, v41, v140
    v_max3_f32 v140, v42, v43, v140
    v_mov_b32 v141, v140
    s_nop 1
    v_permlane16_swap_b32 v140, v141
    v_max_f32 v140, v140, v141
    v_mov_b32 v141, v140
    s_nop 1
    v_permlane32_swap_b32 v140, v141
    v_max_f32 v140, v140, v141
    v_sub_f32 v143, 0, v140
    v_sub_f32 v142, 0, v140
    v_sub_f32 v141, 0, v140
    v_sub_f32 v140, 0, v140
    v_add_f32 v20, v20, v143
    v_add_f32 v21, v21, v143
    v_add_f32 v22, v22, v143
    v_add_f32 v23, v23, v143
    v_add_f32 v40, v40, v143
    v_add_f32 v41, v41, v143
    v_add_f32 v42, v42, v143
    v_add_f32 v43, v43, v143
    v_exp_f32 v20, v20
    v_exp_f32 v21, v21
    v_exp_f32 v22, v22
    v_exp_f32 v23, v23
    v_add_f32 v237, v20, v237
    v_add_f32 v237, v21, v237
    v_cvt_pk_bf16_f32 v72, v20, v21
    v_add_f32 v237, v22, v237
    v_add_f32 v237, v23, v237
    v_cvt_pk_bf16_f32 v73, v22, v23
    v_mfma_f32_16x16x32_bf16 v[20:23], v[88:91], a[240:243], v[140:143]
    v_exp_f32 v40, v40
    v_mfma_f32_16x16x32_bf16 v[20:23], v[92:95], a[244:247], v[20:23]
    v_exp_f32 v41, v41
    v_mfma_f32_16x16x32_bf16 v[20:23], v[96:99], a[248:251], v[20:23]
    v_exp_f32 v42, v42
    v_mfma_f32_16x16x32_bf16 v[20:23], v[100:103], a[252:255], v[20:23]
    v_exp_f32 v43, v43
    v_add_f32 v237, v40, v237
    v_add_f32 v237, v41, v237
    v_cvt_pk_bf16_f32 v74, v40, v41
    v_add_f32 v237, v42, v237
    v_add_f32 v237, v43, v237
    v_cvt_pk_bf16_f32 v75, v42, v43
    v_mfma_f32_16x16x32_bf16 v[40:43], v[104:107], a[240:243], v[140:143]
    v_mfma_f32_16x16x32_bf16 v[40:43], v[108:111], a[244:247], v[40:43]
    v_mfma_f32_16x16x32_bf16 v[40:43], v[112:115], a[248:251], v[40:43]
    v_mfma_f32_16x16x32_bf16 v[40:43], v[116:119], a[252:255], v[40:43]
    s_cmp_eq_u32 s24, 1
    s_cbranch_scc1 L_pre1
    s_cmp_eq_u32 s24, 2
    s_cbranch_scc1 L_pre2
    s_cmp_eq_u32 s24, 3
    s_cbranch_scc1 L_pre3
L_pre0:
    s_nop 7
    v_mfma_f32_16x16x32_bf16 v[24:27], v[152:155], v[184:187], v[144:147]
    v_mov_b32 v248, 0
    v_mov_b32 v249, 0
    v_mfma_f32_16x16x32_bf16 v[24:27], v[156:159], v[188:191], v[24:27]
    v_mov_b32 v250, 0
    v_mov_b32 v251, 0
    v_mfma_f32_16x16x32_bf16 v[24:27], v[160:163], v[192:195], v[24:27]
    v_exp_f32 v8, v8
    v_mfma_f32_16x16x32_bf16 v[24:27], v[164:167], v[196:199], v[24:27]
    v_exp_f32 v9, v9
    v_mfma_f32_16x16x32_bf16 v[44:47], v[168:171], v[184:187], v[144:147]
    v_exp_f32 v10, v10
    v_mfma_f32_16x16x32_bf16 v[44:47], v[172:175], v[188:191], v[44:47]
    v_exp_f32 v11, v11
    v_mfma_f32_16x16x32_bf16 v[44:47], v[176:179], v[192:195], v[44:47]
    s_nop 1
    v_exp_f32 v24, v24
    v_mfma_f32_16x16x32_bf16 v[44:47], v[180:183], v[196:199], v[44:47]
    v_exp_f32 v25, v25
    v_exp_f32 v26, v26
    v_exp_f32 v27, v27
    v_add_f32 v238, v24, v238
    v_add_f32 v238, v25, v238
    v_cvt_pk_bf16_f32 v80, v24, v25
    v_add_f32 v238, v26, v238
    v_add_f32 v238, v27, v238
    v_cvt_pk_bf16_f32 v81, v26, v27
    v_mfma_f32_16x16x32_bf16 v[24:27], v[88:91], v[184:187], v[144:147]
    v_exp_f32 v44, v44
    v_mfma_f32_16x16x32_bf16 v[24:27], v[92:95], v[188:191], v[24:27]
    v_exp_f32 v45, v45
    v_mfma_f32_16x16x32_bf16 v[24:27], v[96:99], v[192:195], v[24:27]
    v_exp_f32 v46, v46
    v_mfma_f32_16x16x32_bf16 v[24:27], v[100:103], v[196:199], v[24:27]
    v_exp_f32 v47, v47
    v_add_f32 v238, v44, v238
    v_add_f32 v238, v45, v238
    v_cvt_pk_bf16_f32 v82, v44, v45
    v_add_f32 v238, v46, v238
    v_add_f32 v238, v47, v238
    v_cvt_pk_bf16_f32 v83, v46, v47
    v_mfma_f32_16x16x32_bf16 v[44:47], v[104:107], v[184:187], v[144:147]
    v_cvt_pk_bf16_f32 v52, v8, v9
    v_cvt_pk_bf16_f32 v53, v10, v11
    v_mfma_f32_16x16x32_bf16 v[44:47], v[108:111], v[188:191], v[44:47]
    v_exp_f32 v12, v12
    v_mfma_f32_16x16x32_bf16 v[44:47], v[112:115], v[192:195], v[44:47]
    v_exp_f32 v13, v13
    v_mfma_f32_16x16x32_bf16 v[44:47], v[116:119], v[196:199], v[44:47]
    v_exp_f32 v14, v14
    v_cvt_pk_bf16_f32 v60, v12, v13
    v_exp_f32 v15, v15
    s_nop 0
    v_cvt_pk_bf16_f32 v61, v14, v15
    v_exp_f32 v16, v16
    s_nop 0
    v_add_f32 v236, v16, v236
    v_exp_f32 v17, v17
    s_nop 0
    v_add_f32 v236, v17, v236
    v_exp_f32 v18, v18
    v_cvt_pk_bf16_f32 v68, v16, v17
    v_exp_f32 v19, v19
    v_exp_f32 v20, v20
    v_add_f32 v236, v18, v236
    v_add_f32 v236, v19, v236
    v_exp_f32 v21, v21
    v_cvt_pk_bf16_f32 v69, v18, v19
    v_exp_f32 v22, v22
    v_add_f32 v237, v20, v237
    v_add_f32 v237, v21, v237
    v_cvt_pk_bf16_f32 v76, v20, v21
    v_add_f32 v237, v22, v237
    v_exp_f32 v23, v23
    s_nop 0
    v_add_f32 v237, v23, v237
    v_exp_f32 v24, v24
    v_cvt_pk_bf16_f32 v77, v22, v23
    v_exp_f32 v25, v25
    v_add_f32 v238, v24, v238
    v_exp_f32 v26, v26
    v_add_f32 v238, v25, v238
    v_exp_f32 v27, v27
    v_cvt_pk_bf16_f32 v84, v24, v25
    v_exp_f32 v28, v28
    v_exp_f32 v29, v29
    v_exp_f32 v30, v30
    v_exp_f32 v31, v31
    v_exp_f32 v32, v32
    v_add_f32 v238, v26, v238
    v_add_f32 v238, v27, v238
    v_exp_f32 v33, v33
    v_exp_f32 v34, v34
    v_cvt_pk_bf16_f32 v85, v26, v27
    v_exp_f32 v35, v35
    v_cvt_pk_bf16_f32 v54, v28, v29
    v_exp_f32 v36, v36
    v_cvt_pk_bf16_f32 v55, v30, v31
    v_exp_f32 v37, v37
    v_cvt_pk_bf16_f32 v62, v32, v33
    v_exp_f32 v38, v38
    v_cvt_pk_bf16_f32 v63, v34, v35
    v_add_f32 v236, v36, v236
    v_exp_f32 v39, v39
    v_add_f32 v236, v37, v236
    v_cvt_pk_bf16_f32 v70, v36, v37
    v_exp_f32 v40, v40
    v_add_f32 v236, v38, v236
    v_add_f32 v236, v39, v236
    v_exp_f32 v41, v41
    v_cvt_pk_bf16_f32 v71, v38, v39
    v_add_f32 v237, v40, v237
    s_waitcnt vmcnt(8)
    s_barrier
    ds_read_b128 v[152:155], v216 offset:0
    ds_read_b128 v[156:159], v217 offset:0
    ds_read_b128 v[160:163], v218 offset:0
    ds_read_b128 v[164:167], v219 offset:0
    s_waitcnt lgkmcnt(0)
    s_branch L_loop0
L_tail0:
    s_nop 7
    v_mfma_f32_16x16x32_bf16 v[244:247], v[240:243], v[88:91], v[244:247]
    ds_read_b64_tr_b16 v[152:153], v220 offset:49152
    ds_read_b64_tr_b16 v[154:155], v220 offset:53248
    v_mfma_f32_16x16x32_bf16 v[244:247], v[240:243], v[92:95], v[244:247]
    v_add_u32 v218, 1056, v4
    ds_read_b64_tr_b16 v[156:157], v220 offset:57344
    ds_read_b64_tr_b16 v[158:159], v220 offset:61440
    ds_read_b64_tr_b16 v[160:161], v221 offset:49152
    ds_read_b64_tr_b16 v[162:163], v221 offset:53248
    ds_read_b64_tr_b16 v[164:165], v221 offset:57344
    ds_read_b64_tr_b16 v[166:167], v221 offset:61440
    ds_read_b64_tr_b16 v[168:169], v222 offset:49152
    ds_read_b64_tr_b16 v[170:171], v222 offset:53248
    ds_read_b64_tr_b16 v[172:173], v222 offset:57344
    ds_read_b64_tr_b16 v[174:175], v222 offset:61440
    ds_read_b64_tr_b16 v[176:177], v223 offset:49152
    ds_read_b64_tr_b16 v[178:179], v223 offset:53248
    ds_read_b64_tr_b16 v[180:181], v223 offset:57344
    ds_read_b64_tr_b16 v[182:183], v223 offset:61440
    ds_read_b64_tr_b16 v[48:49], v224 offset:49152
    ds_read_b64_tr_b16 v[50:51], v224 offset:53248
    ds_read_b64_tr_b16 v[52:53], v224 offset:57344
    ds_read_b64_tr_b16 v[54:55], v224 offset:61440
    ds_read_b64_tr_b16 v[56:57], v225 offset:49152
    ds_read_b64_tr_b16 v[58:59], v225 offset:53248
    ds_read_b64_tr_b16 v[60:61], v225 offset:57344
    ds_read_b64_tr_b16 v[62:63], v225 offset:61440
    ds_read_b64_tr_b16 v[64:65], v226 offset:49152
    ds_read_b64_tr_b16 v[66:67], v226 offset:53248
    ds_read_b64_tr_b16 v[68:69], v226 offset:57344
    ds_read_b64_tr_b16 v[70:71], v226 offset:61440
    ds_read_b64_tr_b16 v[72:73], v227 offset:49152
    ds_read_b64_tr_b16 v[74:75], v227 offset:53248
    ds_read_b64_tr_b16 v[76:77], v227 offset:57344
    ds_read_b64_tr_b16 v[78:79], v227 offset:61440
    v_add_u32 v219, 1056, v2
    v_add_u32 v232, 8448, v2
    v_add_u32 v233, 9504, v2
    v_mov_b32 v8, v244
    v_mov_b32 v14, v8
    v_mfma_f32_16x16x32_bf16 v[248:251], v[240:243], v[96:99], v[248:251]
    s_nop 0
    v_permlane16_swap_b32 v8, v14
    s_waitcnt lgkmcnt(15)
    v_mfma_f32_16x16x32_bf16 a[0:3], v[88:91], v[152:155], a[0:3]
    v_add_f32 v8, v8, v14
    v_mov_b32 v14, v8
    v_mfma_f32_16x16x32_bf16 a[0:3], v[92:95], v[156:159], a[0:3]
    s_nop 0
    v_permlane32_swap_b32 v8, v14
    v_mfma_f32_16x16x32_bf16 a[4:7], v[88:91], v[160:163], a[4:7]
    v_add_f32 v8, v8, v14
    v_rcp_f32 v20, v8
    v_mfma_f32_16x16x32_bf16 a[4:7], v[92:95], v[164:167], a[4:7]
    s_waitcnt lgkmcnt(15)
    v_exp_f32 v42, v42
    v_mfma_f32_16x16x32_bf16 a[8:11], v[88:91], v[168:171], a[8:11]
    v_exp_f32 v43, v43
    v_mfma_f32_16x16x32_bf16 a[8:11], v[92:95], v[172:175], a[8:11]
    ds_write_b32 v254, v20 offset:0
    ds_write2_b32 v4, a0, a1 offset0:0 offset1:132
    v_mfma_f32_16x16x32_bf16 a[12:15], v[88:91], v[176:179], a[12:15]
    s_waitcnt lgkmcnt(10)
    v_add_f32 v237, v42, v237
    v_mfma_f32_16x16x32_bf16 a[12:15], v[92:95], v[180:183], a[12:15]
    ds_write2_b32 v218, a2, a3 offset0:0 offset1:132
    v_mfma_f32_16x16x32_bf16 a[16:19], v[88:91], v[48:51], a[16:19]
    v_add_f32 v237, v43, v237
    v_cvt_pk_bf16_f32 v119, v42, v43
    v_mfma_f32_16x16x32_bf16 a[16:19], v[92:95], v[52:55], a[16:19]
    ds_write2_b32 v4, a4, a5 offset0:16 offset1:148
    v_mfma_f32_16x16x32_bf16 a[20:23], v[88:91], v[56:59], a[20:23]
    s_waitcnt lgkmcnt(4)
    v_mov_b32 v216, 0
    v_mfma_f32_16x16x32_bf16 a[20:23], v[92:95], v[60:63], a[20:23]
    ds_write2_b32 v218, a6, a7 offset0:16 offset1:148
    v_mfma_f32_16x16x32_bf16 a[24:27], v[88:91], v[64:67], a[24:27]
    v_mov_b32 v10, v236
    v_mov_b32 v11, v237
    v_mfma_f32_16x16x32_bf16 a[24:27], v[92:95], v[68:71], a[24:27]
    ds_write2_b32 v4, a8, a9 offset0:32 offset1:164
    v_mfma_f32_16x16x32_bf16 a[28:31], v[88:91], v[72:75], a[28:31]
    v_mov_b32 v12, v238
    v_mov_b32 v13, v239
    v_mfma_f32_16x16x32_bf16 a[28:31], v[92:95], v[76:79], a[28:31]
    ds_write2_b32 v218, a10, a11 offset0:32 offset1:164
    ds_write2_b32 v4, a12, a13 offset0:48 offset1:180
    ds_write2_b32 v218, a14, a15 offset0:48 offset1:180
    ds_write2_b32 v4, a16, a17 offset0:64 offset1:196
    ds_write2_b32 v218, a18, a19 offset0:64 offset1:196
    ds_write2_b32 v4, a20, a21 offset0:80 offset1:212
    ds_write2_b32 v218, a22, a23 offset0:80 offset1:212
    ds_write2_b32 v4, a24, a25 offset0:96 offset1:228
    ds_write2_b32 v218, a26, a27 offset0:96 offset1:228
    ds_write2_b32 v4, a28, a29 offset0:112 offset1:244
    ds_write2_b32 v218, a30, a31 offset0:112 offset1:244
    ds_read_b32 v28, v255 offset:0
    ds_read_b128 v[184:187], v5 offset:0
    ds_read_b128 v[188:191], v5 offset:16
    ds_read_b32 v29, v255 offset:16
    ds_read_b128 v[192:195], v5 offset:2112
    ds_read_b128 v[196:199], v5 offset:2128
    ds_read_b32 v30, v255 offset:32
    ds_read_b128 v[200:203], v5 offset:4224
    ds_read_b128 v[204:207], v5 offset:4240
    ds_read_b32 v31, v255 offset:48
    ds_read_b128 v[208:211], v5 offset:6336
    ds_read_b128 v[212:215], v5 offset:6352
    v_mfma_f32_16x16x32_bf16 v[248:251], v[240:243], v[100:103], v[248:251]
    v_mov_b32 v16, v10
    v_mov_b32 v17, v11
    v_mfma_f32_16x16x32_bf16 a[32:35], v[96:99], v[152:155], a[32:35]
    v_mov_b32 v18, v12
    v_mov_b32 v19, v13
    v_mfma_f32_16x16x32_bf16 a[32:35], v[100:103], v[156:159], a[32:35]
    v_permlane16_swap_b32 v10, v16
    v_mfma_f32_16x16x32_bf16 a[36:39], v[96:99], v[160:163], a[36:39]
    v_mov_b32 v9, v248
    v_mov_b32 v15, v9
    v_mfma_f32_16x16x32_bf16 a[36:39], v[100:103], v[164:167], a[36:39]
    s_nop 0
    v_permlane16_swap_b32 v9, v15
    v_mfma_f32_16x16x32_bf16 a[40:43], v[96:99], v[168:171], a[40:43]
    v_permlane16_swap_b32 v11, v17
    v_mfma_f32_16x16x32_bf16 a[40:43], v[100:103], v[172:175], a[40:43]
    v_permlane16_swap_b32 v12, v18
    v_mfma_f32_16x16x32_bf16 a[44:47], v[96:99], v[176:179], a[44:47]
    v_permlane16_swap_b32 v13, v19
    v_mfma_f32_16x16x32_bf16 a[44:47], v[100:103], v[180:183], a[44:47]
    v_add_f32 v9, v9, v15
    v_add_f32 v10, v10, v16
    v_mfma_f32_16x16x32_bf16 a[48:51], v[96:99], v[48:51], a[48:51]
    v_add_f32 v11, v11, v17
    v_add_f32 v12, v12, v18
    v_mfma_f32_16x16x32_bf16 a[48:51], v[100:103], v[52:55], a[48:51]
    v_add_f32 v13, v13, v19
    v_mov_b32 v15, v9
    v_mfma_f32_16x16x32_bf16 a[52:55], v[96:99], v[56:59], a[52:55]
    v_mov_b32 v16, v10
    v_mov_b32 v17, v11
    v_mfma_f32_16x16x32_bf16 a[52:55], v[100:103], v[60:63], a[52:55]
    v_mov_b32 v18, v12
    v_mov_b32 v19, v13
    v_mfma_f32_16x16x32_bf16 a[56:59], v[96:99], v[64:67], a[56:59]
    v_permlane32_swap_b32 v9, v15
    v_mfma_f32_16x16x32_bf16 a[56:59], v[100:103], v[68:71], a[56:59]
    v_permlane32_swap_b32 v10, v16
    v_mfma_f32_16x16x32_bf16 a[60:63], v[96:99], v[72:75], a[60:63]
    v_permlane32_swap_b32 v11, v17
    v_mfma_f32_16x16x32_bf16 a[60:63], v[100:103], v[76:79], a[60:63]
    ds_write2_b32 v2, a128, a129 offset0:0 offset1:132
    s_waitcnt lgkmcnt(7)
    v_pk_mul_f32 v[184:185], v[184:185], v[28:29] op_sel_hi:[1,0]
    v_pk_mul_f32 v[186:187], v[186:187], v[28:29] op_sel_hi:[1,0]
    v_pk_mul_f32 v[188:189], v[188:189], v[28:29] op_sel_hi:[1,0]
    v_pk_mul_f32 v[190:191], v[190:191], v[28:29] op_sel_hi:[1,0]
    v_cvt_pk_bf16_f32 v184, v184, v185
    v_cvt_pk_bf16_f32 v185, v186, v187
    v_cvt_pk_bf16_f32 v186, v188, v189
    v_cvt_pk_bf16_f32 v187, v190, v191
    buffer_store_dwordx4 v[184:187], v1, s[20:23], s4 offen offset:0 sc0 sc1
    v_pk_maximum3_f16 v216, v184, v185, v216
    v_pk_maximum3_f16 v216, v186, v187, v216
    v_pk_mul_f32 v[192:193], v[192:193], v[28:29] op_sel:[0,1] op_sel_hi:[1,1]
    v_pk_mul_f32 v[194:195], v[194:195], v[28:29] op_sel:[0,1] op_sel_hi:[1,1]
    s_waitcnt lgkmcnt(1)
    v_pk_mul_f32 v[196:197], v[196:197], v[28:29] op_sel:[0,1] op_sel_hi:[1,1]
    v_pk_mul_f32 v[198:199], v[198:199], v[28:29] op_sel:[0,1] op_sel_hi:[1,1]
    v_cvt_pk_bf16_f32 v192, v192, v193
    v_cvt_pk_bf16_f32 v193, v194, v195
    v_cvt_pk_bf16_f32 v194, v196, v197
    v_cvt_pk_bf16_f32 v195, v198, v199
    v_pk_maximum3_f16 v216, v192, v193, v216
    v_pk_maximum3_f16 v216, v194, v195, v216
    v_pk_mul_f32 v[200:201], v[200:201], v[30:31] op_sel_hi:[1,0]
    v_pk_mul_f32 v[202:203], v[202:203], v[30:31] op_sel_hi:[1,0]
    v_pk_mul_f32 v[204:205], v[204:205], v[30:31] op_sel_hi:[1,0]
    v_pk_mul_f32 v[206:207], v[206:207], v[30:31] op_sel_hi:[1,0]
    buffer_store_dwordx4 v[192:195], v1, s[20:23], s4 offen offset:1024 sc0 sc1
    v_cvt_pk_bf16_f32 v200, v200, v201
    v_cvt_pk_bf16_f32 v201, v202, v203
    v_cvt_pk_bf16_f32 v202, v204, v205
    v_cvt_pk_bf16_f32 v203, v206, v207
    v_pk_maximum3_f16 v216, v200, v201, v216
    v_pk_maximum3_f16 v216, v202, v203, v216
    v_pk_mul_f32 v[208:209], v[208:209], v[30:31] op_sel:[0,1] op_sel_hi:[1,1]
    v_pk_mul_f32 v[210:211], v[210:211], v[30:31] op_sel:[0,1] op_sel_hi:[1,1]
    v_pk_mul_f32 v[212:213], v[212:213], v[30:31] op_sel:[0,1] op_sel_hi:[1,1]
    v_pk_mul_f32 v[214:215], v[214:215], v[30:31] op_sel:[0,1] op_sel_hi:[1,1]
    v_cvt_pk_bf16_f32 v208, v208, v209
    v_cvt_pk_bf16_f32 v209, v210, v211
    v_cvt_pk_bf16_f32 v210, v212, v213
    v_cvt_pk_bf16_f32 v211, v214, v215
    v_pk_maximum3_f16 v216, v208, v209, v216
    v_pk_maximum3_f16 v216, v210, v211, v216
    v_mfma_f32_16x16x32_bf16 a[160:163], v[120:123], v[152:155], a[160:163]
    buffer_store_dwordx4 v[200:203], v1, s[20:23], s4 offen offset:2048 sc0 sc1
    v_mfma_f32_16x16x32_bf16 a[164:167], v[120:123], v[160:163], a[164:167]
    ds_write2_b32 v219, a130, a131 offset0:0 offset1:132
    v_mfma_f32_16x16x32_bf16 a[168:171], v[120:123], v[168:171], a[168:171]
    v_permlane32_swap_b32 v12, v18
    v_mfma_f32_16x16x32_bf16 a[172:175], v[120:123], v[176:179], a[172:175]
    ds_write2_b32 v2, a132, a133 offset0:16 offset1:148
    v_mfma_f32_16x16x32_bf16 a[176:179], v[120:123], v[48:51], a[176:179]
    v_permlane32_swap_b32 v13, v19
    buffer_store_dwordx4 v[208:211], v1, s[20:23], s4 offen offset:3072 sc0 sc1
    v_mfma_f32_16x16x32_bf16 a[180:183], v[120:123], v[56:59], a[180:183]
    ds_write2_b32 v219, a134, a135 offset0:16 offset1:148
    v_mfma_f32_16x16x32_bf16 a[184:187], v[120:123], v[64:67], a[184:187]
    v_add_f32 v9, v9, v15
    v_add_f32 v10, v10, v16
    v_mfma_f32_16x16x32_bf16 a[188:191], v[120:123], v[72:75], a[188:191]
    ds_write2_b32 v2, a136, a137 offset0:32 offset1:164
    v_mfma_f32_16x16x32_bf16 a[64:67], v[104:107], v[152:155], a[64:67]
    v_add_f32 v11, v11, v17
    v_add_f32 v12, v12, v18
    v_mfma_f32_16x16x32_bf16 a[64:67], v[108:111], v[156:159], a[64:67]
    ds_write2_b32 v219, a138, a139 offset0:32 offset1:164
    v_mfma_f32_16x16x32_bf16 a[68:71], v[104:107], v[160:163], a[68:71]
    v_add_f32 v13, v13, v19
    v_rcp_f32 v21, v9
    v_mfma_f32_16x16x32_bf16 a[68:71], v[108:111], v[164:167], a[68:71]
    ds_write2_b32 v2, a140, a141 offset0:48 offset1:180
    v_mfma_f32_16x16x32_bf16 a[72:75], v[104:107], v[168:171], a[72:75]
    v_rcp_f32 v22, v10
    v_mfma_f32_16x16x32_bf16 a[72:75], v[108:111], v[172:175], a[72:75]
    ds_write2_b32 v219, a142, a143 offset0:48 offset1:180
    v_mfma_f32_16x16x32_bf16 a[76:79], v[104:107], v[176:179], a[76:79]
    v_rcp_f32 v23, v11
    v_mfma_f32_16x16x32_bf16 a[76:79], v[108:111], v[180:183], a[76:79]
    ds_write2_b32 v2, a144, a145 offset0:64 offset1:196
    v_mfma_f32_16x16x32_bf16 a[80:83], v[104:107], v[48:51], a[80:83]
    v_mfma_f32_16x16x32_bf16 a[80:83], v[108:111], v[52:55], a[80:83]
    ds_write2_b32 v219, a146, a147 offset0:64 offset1:196
    v_mfma_f32_16x16x32_bf16 a[84:87], v[104:107], v[56:59], a[84:87]
    v_mfma_f32_16x16x32_bf16 a[84:87], v[108:111], v[60:63], a[84:87]
    ds_write2_b32 v2, a148, a149 offset0:80 offset1:212
    v_mfma_f32_16x16x32_bf16 a[88:91], v[104:107], v[64:67], a[88:91]
    v_mfma_f32_16x16x32_bf16 a[88:91], v[108:111], v[68:71], a[88:91]
    ds_write2_b32 v219, a150, a151 offset0:80 offset1:212
    v_mfma_f32_16x16x32_bf16 a[92:95], v[104:107], v[72:75], a[92:95]
    v_mfma_f32_16x16x32_bf16 a[92:95], v[108:111], v[76:79], a[92:95]
    ds_write2_b32 v2, a152, a153 offset0:96 offset1:228
    v_mfma_f32_16x16x32_bf16 a[96:99], v[112:115], v[152:155], a[96:99]
    v_mfma_f32_16x16x32_bf16 a[96:99], v[116:119], v[156:159], a[96:99]
    ds_write2_b32 v219, a154, a155 offset0:96 offset1:228
    v_mfma_f32_16x16x32_bf16 a[100:103], v[112:115], v[160:163], a[100:103]
    v_mfma_f32_16x16x32_bf16 a[100:103], v[116:119], v[164:167], a[100:103]
    ds_write2_b32 v2, a156, a157 offset0:112 offset1:244
    v_mfma_f32_16x16x32_bf16 a[104:107], v[112:115], v[168:171], a[104:107]
    v_mfma_f32_16x16x32_bf16 a[104:107], v[116:119], v[172:175], a[104:107]
    ds_write2_b32 v219, a158, a159 offset0:112 offset1:244
    v_mfma_f32_16x16x32_bf16 a[108:111], v[112:115], v[176:179], a[108:111]
    v_mfma_f32_16x16x32_bf16 a[108:111], v[116:119], v[180:183], a[108:111]
    ds_write_b32 v254, v21 offset:64
    ds_write2_b32 v4, a32, a33 offset0:0 offset1:132
    v_mfma_f32_16x16x32_bf16 a[112:115], v[112:115], v[48:51], a[112:115]
    v_mfma_f32_16x16x32_bf16 a[112:115], v[116:119], v[52:55], a[112:115]
    ds_write2_b32 v218, a34, a35 offset0:0 offset1:132
    v_mfma_f32_16x16x32_bf16 a[116:119], v[112:115], v[56:59], a[116:119]
    v_mfma_f32_16x16x32_bf16 a[116:119], v[116:119], v[60:63], a[116:119]
    ds_write2_b32 v4, a36, a37 offset0:16 offset1:148
    v_mfma_f32_16x16x32_bf16 a[120:123], v[112:115], v[64:67], a[120:123]
    v_mfma_f32_16x16x32_bf16 a[120:123], v[116:119], v[68:71], a[120:123]
    ds_write2_b32 v218, a38, a39 offset0:16 offset1:148
    v_mfma_f32_16x16x32_bf16 a[124:127], v[112:115], v[72:75], a[124:127]
    v_mfma_f32_16x16x32_bf16 a[124:127], v[116:119], v[76:79], a[124:127]
    ds_write2_b32 v4, a40, a41 offset0:32 offset1:164
    ds_write2_b32 v218, a42, a43 offset0:32 offset1:164
    ds_write2_b32 v4, a44, a45 offset0:48 offset1:180
    ds_write2_b32 v218, a46, a47 offset0:48 offset1:180
    ds_write2_b32 v4, a48, a49 offset0:64 offset1:196
    ds_write2_b32 v218, a50, a51 offset0:64 offset1:196
    ds_write2_b32 v4, a52, a53 offset0:80 offset1:212
    ds_write2_b32 v218, a54, a55 offset0:80 offset1:212
    ds_write2_b32 v4, a56, a57 offset0:96 offset1:228
    ds_write2_b32 v218, a58, a59 offset0:96 offset1:228
    ds_write2_b32 v4, a60, a61 offset0:112 offset1:244
    ds_write2_b32 v218, a62, a63 offset0:112 offset1:244
    ds_read_b32 v32, v255 offset:64
    ds_read_b128 v[120:123], v5 offset:0
    ds_read_b128 v[124:127], v5 offset:16
    ds_read_b32 v33, v255 offset:80
    ds_read_b128 v[128:131], v5 offset:2112
    ds_read_b128 v[132:135], v5 offset:2128
    ds_read_b32 v34, v255 offset:96
    ds_read_b128 v[136:139], v5 offset:4224
    ds_read_b128 v[140:143], v5 offset:4240
    ds_read_b32 v35, v255 offset:112
    ds_read_b128 v[144:147], v5 offset:6336
    ds_read_b128 v[148:151], v5 offset:6352
    ds_write2_b32 v232, a160, a161 offset0:0 offset1:132
    ds_write2_b32 v233, a162, a163 offset0:0 offset1:132
    ds_write2_b32 v232, a164, a165 offset0:16 offset1:148
    ds_write2_b32 v233, a166, a167 offset0:16 offset1:148
    ds_write2_b32 v232, a168, a169 offset0:32 offset1:164
    ds_write2_b32 v233, a170, a171 offset0:32 offset1:164
    ds_write2_b32 v232, a172, a173 offset0:48 offset1:180
    ds_write2_b32 v233, a174, a175 offset0:48 offset1:180
    ds_write2_b32 v232, a176, a177 offset0:64 offset1:196
    ds_write2_b32 v233, a178, a179 offset0:64 offset1:196
    ds_write2_b32 v232, a180, a181 offset0:80 offset1:212
    ds_write2_b32 v233, a182, a183 offset0:80 offset1:212
    ds_write2_b32 v232, a184, a185 offset0:96 offset1:228
    ds_write2_b32 v233, a186, a187 offset0:96 offset1:228
    ds_write2_b32 v232, a188, a189 offset0:112 offset1:244
    s_waitcnt lgkmcnt(15)
    v_mul_f32 v120, v120, v32
    v_mul_f32 v121, v121, v32
    v_mul_f32 v122, v122, v32
    v_mul_f32 v123, v123, v32
    v_mul_f32 v124, v124, v32
    v_mul_f32 v125, v125, v32
    v_mul_f32 v126, v126, v32
    v_mul_f32 v127, v127, v32
    v_cvt_pk_bf16_f32 v120, v120, v121
    v_cvt_pk_bf16_f32 v121, v122, v123
    v_cvt_pk_bf16_f32 v122, v124, v125
    v_cvt_pk_bf16_f32 v123, v126, v127
    buffer_store_dwordx4 v[120:123], v1, s[20:23], s5 offen offset:0 sc0 sc1
    s_waitcnt lgkmcnt(15)
    v_pk_maximum3_f16 v216, v120, v121, v216
    v_pk_maximum3_f16 v216, v122, v123, v216
    v_mul_f32 v128, v128, v33
    v_mul_f32 v129, v129, v33
    v_mul_f32 v130, v130, v33
    v_mul_f32 v131, v131, v33
    v_mul_f32 v132, v132, v33
    v_mul_f32 v133, v133, v33
    v_mul_f32 v134, v134, v33
    v_mul_f32 v135, v135, v33
    v_cvt_pk_bf16_f32 v128, v128, v129
    v_cvt_pk_bf16_f32 v129, v130, v131
    v_cvt_pk_bf16_f32 v130, v132, v133
    v_cvt_pk_bf16_f32 v131, v134, v135
    v_pk_maximum3_f16 v216, v128, v129, v216
    v_pk_maximum3_f16 v216, v130, v131, v216
    buffer_store_dwordx4 v[128:131], v1, s[20:23], s5 offen offset:1024 sc0 sc1
    v_mul_f32 v136, v136, v34
    v_mul_f32 v137, v137, v34
    v_mul_f32 v138, v138, v34
    v_mul_f32 v139, v139, v34
    v_mul_f32 v140, v140, v34
    v_mul_f32 v141, v141, v34
    v_mul_f32 v142, v142, v34
    v_mul_f32 v143, v143, v34
    v_cvt_pk_bf16_f32 v136, v136, v137
    v_cvt_pk_bf16_f32 v137, v138, v139
    v_cvt_pk_bf16_f32 v138, v140, v141
    v_cvt_pk_bf16_f32 v139, v142, v143
    v_pk_maximum3_f16 v216, v136, v137, v216
    v_pk_maximum3_f16 v216, v138, v139, v216
    v_mul_f32 v144, v144, v35
    v_mul_f32 v145, v145, v35
    v_mul_f32 v146, v146, v35
    buffer_store_dwordx4 v[136:139], v1, s[20:23], s5 offen offset:2048 sc0 sc1
    v_mul_f32 v147, v147, v35
    v_mul_f32 v148, v148, v35
    v_mul_f32 v149, v149, v35
    v_mul_f32 v150, v150, v35
    v_mul_f32 v151, v151, v35
    v_cvt_pk_bf16_f32 v144, v144, v145
    v_cvt_pk_bf16_f32 v145, v146, v147
    v_cvt_pk_bf16_f32 v146, v148, v149
    v_cvt_pk_bf16_f32 v147, v150, v151
    v_pk_maximum3_f16 v216, v144, v145, v216
    v_pk_maximum3_f16 v216, v146, v147, v216
    ds_write2_b32 v233, a190, a191 offset0:112 offset1:244
    buffer_store_dwordx4 v[144:147], v1, s[20:23], s5 offen offset:3072 sc0 sc1
    ds_write_b32 v3, v12 offset:0
    ds_write_b32 v3, v13 offset:256
    ds_write_b32 v254, v22 offset:128
    ds_write2_b32 v4, a64, a65 offset0:0 offset1:132
    ds_write2_b32 v218, a66, a67 offset0:0 offset1:132
    ds_write2_b32 v4, a68, a69 offset0:16 offset1:148
    ds_write2_b32 v218, a70, a71 offset0:16 offset1:148
    ds_write2_b32 v4, a72, a73 offset0:32 offset1:164
    ds_write2_b32 v218, a74, a75 offset0:32 offset1:164
    ds_write2_b32 v4, a76, a77 offset0:48 offset1:180
    ds_write2_b32 v218, a78, a79 offset0:48 offset1:180
    ds_write2_b32 v4, a80, a81 offset0:64 offset1:196
    ds_write2_b32 v218, a82, a83 offset0:64 offset1:196
    ds_write2_b32 v4, a84, a85 offset0:80 offset1:212
    ds_write2_b32 v218, a86, a87 offset0:80 offset1:212
    ds_write2_b32 v4, a88, a89 offset0:96 offset1:228
    ds_write2_b32 v218, a90, a91 offset0:96 offset1:228
    ds_write2_b32 v4, a92, a93 offset0:112 offset1:244
    ds_write2_b32 v218, a94, a95 offset0:112 offset1:244
    ds_read_b32 v36, v255 offset:128
    ds_read_b128 v[184:187], v5 offset:0
    ds_read_b128 v[188:191], v5 offset:16
    ds_read_b32 v37, v255 offset:144
    ds_read_b128 v[192:195], v5 offset:2112
    ds_read_b128 v[196:199], v5 offset:2128
    ds_read_b32 v38, v255 offset:160
    ds_read_b128 v[200:203], v5 offset:4224
    ds_read_b128 v[204:207], v5 offset:4240
    ds_read_b32 v39, v255 offset:176
    ds_read_b128 v[208:211], v5 offset:6336
    ds_read_b128 v[212:215], v5 offset:6352
    ds_write_b32 v254, v23 offset:192
    ds_write2_b32 v4, a96, a97 offset0:0 offset1:132
    ds_write2_b32 v218, a98, a99 offset0:0 offset1:132
    ds_write2_b32 v4, a100, a101 offset0:16 offset1:148
    ds_write2_b32 v218, a102, a103 offset0:16 offset1:148
    ds_write2_b32 v4, a104, a105 offset0:32 offset1:164
    ds_write2_b32 v218, a106, a107 offset0:32 offset1:164
    ds_write2_b32 v4, a108, a109 offset0:48 offset1:180
    ds_write2_b32 v218, a110, a111 offset0:48 offset1:180
    ds_write2_b32 v4, a112, a113 offset0:64 offset1:196
    ds_write2_b32 v218, a114, a115 offset0:64 offset1:196
    ds_write2_b32 v4, a116, a117 offset0:80 offset1:212
    ds_write2_b32 v218, a118, a119 offset0:80 offset1:212
    ds_write2_b32 v4, a120, a121 offset0:96 offset1:228
    ds_write2_b32 v218, a122, a123 offset0:96 offset1:228
    s_waitcnt lgkmcnt(15)
    v_pk_mul_f32 v[184:185], v[184:185], v[36:37] op_sel_hi:[1,0]
    v_pk_mul_f32 v[186:187], v[186:187], v[36:37] op_sel_hi:[1,0]
    v_pk_mul_f32 v[188:189], v[188:189], v[36:37] op_sel_hi:[1,0]
    v_pk_mul_f32 v[190:191], v[190:191], v[36:37] op_sel_hi:[1,0]
    v_cvt_pk_bf16_f32 v184, v184, v185
    v_cvt_pk_bf16_f32 v185, v186, v187
    v_cvt_pk_bf16_f32 v186, v188, v189
    v_cvt_pk_bf16_f32 v187, v190, v191
    buffer_store_dwordx4 v[184:187], v1, s[20:23], s6 offen offset:0 sc0 sc1
    v_pk_maximum3_f16 v216, v184, v185, v216
    v_pk_maximum3_f16 v216, v186, v187, v216
    v_pk_mul_f32 v[192:193], v[192:193], v[36:37] op_sel:[0,1] op_sel_hi:[1,1]
    v_pk_mul_f32 v[194:195], v[194:195], v[36:37] op_sel:[0,1] op_sel_hi:[1,1]
    s_waitcnt lgkmcnt(15)
    v_pk_mul_f32 v[196:197], v[196:197], v[36:37] op_sel:[0,1] op_sel_hi:[1,1]
    v_pk_mul_f32 v[198:199], v[198:199], v[36:37] op_sel:[0,1] op_sel_hi:[1,1]
    v_cvt_pk_bf16_f32 v192, v192, v193
    v_cvt_pk_bf16_f32 v193, v194, v195
    v_cvt_pk_bf16_f32 v194, v196, v197
    v_cvt_pk_bf16_f32 v195, v198, v199
    v_pk_maximum3_f16 v216, v192, v193, v216
    v_pk_maximum3_f16 v216, v194, v195, v216
    v_pk_mul_f32 v[200:201], v[200:201], v[38:39] op_sel_hi:[1,0]
    v_pk_mul_f32 v[202:203], v[202:203], v[38:39] op_sel_hi:[1,0]
    v_pk_mul_f32 v[204:205], v[204:205], v[38:39] op_sel_hi:[1,0]
    v_pk_mul_f32 v[206:207], v[206:207], v[38:39] op_sel_hi:[1,0]
    buffer_store_dwordx4 v[192:195], v1, s[20:23], s6 offen offset:1024 sc0 sc1
    v_cvt_pk_bf16_f32 v200, v200, v201
    v_cvt_pk_bf16_f32 v201, v202, v203
    v_cvt_pk_bf16_f32 v202, v204, v205
    v_cvt_pk_bf16_f32 v203, v206, v207
    v_pk_maximum3_f16 v216, v200, v201, v216
    v_pk_maximum3_f16 v216, v202, v203, v216
    v_pk_mul_f32 v[208:209], v[208:209], v[38:39] op_sel:[0,1] op_sel_hi:[1,1]
    v_pk_mul_f32 v[210:211], v[210:211], v[38:39] op_sel:[0,1] op_sel_hi:[1,1]
    v_pk_mul_f32 v[212:213], v[212:213], v[38:39] op_sel:[0,1] op_sel_hi:[1,1]
    v_pk_mul_f32 v[214:215], v[214:215], v[38:39] op_sel:[0,1] op_sel_hi:[1,1]
    v_cvt_pk_bf16_f32 v208, v208, v209
    v_cvt_pk_bf16_f32 v209, v210, v211
    v_cvt_pk_bf16_f32 v210, v212, v213
    v_cvt_pk_bf16_f32 v211, v214, v215
    v_pk_maximum3_f16 v216, v208, v209, v216
    v_pk_maximum3_f16 v216, v210, v211, v216
    buffer_store_dwordx4 v[200:203], v1, s[20:23], s6 offen offset:2048 sc0 sc1
    ds_write2_b32 v4, a124, a125 offset0:112 offset1:244
    buffer_store_dwordx4 v[208:211], v1, s[20:23], s6 offen offset:3072 sc0 sc1
    ds_write2_b32 v218, a126, a127 offset0:112 offset1:244
    ds_read_b32 v40, v255 offset:192
    ds_read_b128 v[120:123], v5 offset:0
    ds_read_b128 v[124:127], v5 offset:16
    ds_read_b32 v41, v255 offset:208
    ds_read_b128 v[128:131], v5 offset:2112
    ds_read_b128 v[132:135], v5 offset:2128
    ds_read_b32 v42, v255 offset:224
    ds_read_b128 v[136:139], v5 offset:4224
    ds_read_b128 v[140:143], v5 offset:4240
    ds_read_b32 v43, v255 offset:240
    ds_read_b128 v[144:147], v5 offset:6336
    ds_read_b128 v[148:151], v5 offset:6352
    s_waitcnt lgkmcnt(6)
    v_pk_mul_f32 v[120:121], v[120:121], v[40:41] op_sel_hi:[1,0]
    v_pk_mul_f32 v[122:123], v[122:123], v[40:41] op_sel_hi:[1,0]
    v_pk_mul_f32 v[124:125], v[124:125], v[40:41] op_sel_hi:[1,0]
    v_pk_mul_f32 v[126:127], v[126:127], v[40:41] op_sel_hi:[1,0]
    v_cvt_pk_bf16_f32 v120, v120, v121
    v_cvt_pk_bf16_f32 v121, v122, v123
    v_cvt_pk_bf16_f32 v122, v124, v125
    v_cvt_pk_bf16_f32 v123, v126, v127
    buffer_store_dwordx4 v[120:123], v1, s[20:23], s7 offen offset:0 sc0 sc1
    v_pk_maximum3_f16 v216, v120, v121, v216
    v_pk_maximum3_f16 v216, v122, v123, v216
    v_pk_mul_f32 v[128:129], v[128:129], v[40:41] op_sel:[0,1] op_sel_hi:[1,1]
    v_pk_mul_f32 v[130:131], v[130:131], v[40:41] op_sel:[0,1] op_sel_hi:[1,1]
    s_waitcnt lgkmcnt(0)
    s_barrier
    ds_read_b128 v[152:155], v6 offset:0
    ds_read_b128 v[156:159], v6 offset:16
    ds_read_b32 v14, v7 offset:0
    ds_read_b128 v[160:163], v6 offset:33792
    ds_read_b128 v[164:167], v6 offset:33808
    ds_read_b32 v15, v7 offset:1024
    ds_read_b128 v[168:171], v6 offset:2112
    ds_read_b128 v[172:175], v6 offset:2128
    ds_read_b32 v16, v7 offset:16
    ds_read_b128 v[176:179], v6 offset:35904
    ds_read_b128 v[180:183], v6 offset:35920
    ds_read_b32 v17, v7 offset:1040
    ds_read_b128 v[48:51], v252 offset:0
    ds_read_b128 v[52:55], v252 offset:16
    ds_read_b32 v24, v253 offset:0
    ds_read_b128 v[56:59], v252 offset:16896
    ds_read_b128 v[60:63], v252 offset:16912
    ds_read_b32 v25, v253 offset:512
    ds_read_b128 v[64:67], v252 offset:33792
    ds_read_b128 v[68:71], v252 offset:33808
    ds_read_b32 v26, v253 offset:1024
    ds_read_b128 v[72:75], v252 offset:50688
    ds_read_b128 v[76:79], v252 offset:50704
    ds_read_b32 v27, v253 offset:1536
    v_pk_mul_f32 v[132:133], v[132:133], v[40:41] op_sel:[0,1] op_sel_hi:[1,1]
    v_pk_mul_f32 v[134:135], v[134:135], v[40:41] op_sel:[0,1] op_sel_hi:[1,1]
    v_cvt_pk_bf16_f32 v128, v128, v129
    v_cvt_pk_bf16_f32 v129, v130, v131
    v_cvt_pk_bf16_f32 v130, v132, v133
    v_cvt_pk_bf16_f32 v131, v134, v135
    buffer_store_dwordx4 v[128:131], v1, s[20:23], s7 offen offset:1024 sc0 sc1
    v_pk_maximum3_f16 v216, v128, v129, v216
    v_pk_maximum3_f16 v216, v130, v131, v216
    v_pk_mul_f32 v[136:137], v[136:137], v[42:43] op_sel_hi:[1,0]
    v_pk_mul_f32 v[138:139], v[138:139], v[42:43] op_sel_hi:[1,0]
    v_pk_mul_f32 v[140:141], v[140:141], v[42:43] op_sel_hi:[1,0]
    v_pk_mul_f32 v[142:143], v[142:143], v[42:43] op_sel_hi:[1,0]
    v_cvt_pk_bf16_f32 v136, v136, v137
    v_cvt_pk_bf16_f32 v137, v138, v139
    v_cvt_pk_bf16_f32 v138, v140, v141
    v_cvt_pk_bf16_f32 v139, v142, v143
    v_pk_maximum3_f16 v216, v136, v137, v216
    v_pk_maximum3_f16 v216, v138, v139, v216
    v_pk_mul_f32 v[144:145], v[144:145], v[42:43] op_sel:[0,1] op_sel_hi:[1,1]
    v_pk_mul_f32 v[146:147], v[146:147], v[42:43] op_sel:[0,1] op_sel_hi:[1,1]
    v_pk_mul_f32 v[148:149], v[148:149], v[42:43] op_sel:[0,1] op_sel_hi:[1,1]
    v_pk_mul_f32 v[150:151], v[150:151], v[42:43] op_sel:[0,1] op_sel_hi:[1,1]
    v_cvt_pk_bf16_f32 v144, v144, v145
    buffer_store_dwordx4 v[136:139], v1, s[20:23], s7 offen offset:2048 sc0 sc1
    v_cvt_pk_bf16_f32 v145, v146, v147
    v_cvt_pk_bf16_f32 v146, v148, v149
    v_cvt_pk_bf16_f32 v147, v150, v151
    v_pk_maximum3_f16 v216, v144, v145, v216
    s_waitcnt lgkmcnt(12)
    v_pk_maximum3_f16 v216, v146, v147, v216
    v_add_f32 v14, v14, v15
    v_rcp_f32 v80, v14
    v_pk_add_f32 v[152:153], v[152:153], v[160:161]
    v_pk_add_f32 v[154:155], v[154:155], v[162:163]
    v_pk_add_f32 v[156:157], v[156:157], v[164:165]
    v_pk_add_f32 v[158:159], v[158:159], v[166:167]
    v_pk_mul_f32 v[152:153], v[152:153], v[80:81] op_sel_hi:[1,0]
    v_pk_mul_f32 v[154:155], v[154:155], v[80:81] op_sel_hi:[1,0]
    v_pk_mul_f32 v[156:157], v[156:157], v[80:81] op_sel_hi:[1,0]
    v_pk_mul_f32 v[158:159], v[158:159], v[80:81] op_sel_hi:[1,0]
    buffer_store_dwordx4 v[144:147], v1, s[20:23], s7 offen offset:3072 sc0 sc1
    v_cvt_pk_bf16_f32 v160, v152, v153
    v_cvt_pk_bf16_f32 v161, v154, v155
    v_cvt_pk_bf16_f32 v162, v156, v157
    v_cvt_pk_bf16_f32 v163, v158, v159
    v_pk_maximum3_f16 v216, v160, v161, v216
    v_pk_maximum3_f16 v216, v162, v163, v216
    v_add_f32 v16, v16, v17
    v_rcp_f32 v82, v16
    v_pk_add_f32 v[168:169], v[168:169], v[176:177]
    v_pk_add_f32 v[170:171], v[170:171], v[178:179]
    v_pk_add_f32 v[172:173], v[172:173], v[180:181]
    v_pk_add_f32 v[174:175], v[174:175], v[182:183]
    v_pk_mul_f32 v[168:169], v[168:169], v[82:83] op_sel_hi:[1,0]
    v_pk_mul_f32 v[170:171], v[170:171], v[82:83] op_sel_hi:[1,0]
    v_pk_mul_f32 v[172:173], v[172:173], v[82:83] op_sel_hi:[1,0]
    v_pk_mul_f32 v[174:175], v[174:175], v[82:83] op_sel_hi:[1,0]
    buffer_store_dwordx4 v[160:163], v1, s[20:23], s35 offen offset:0 sc0 sc1
    s_waitcnt lgkmcnt(0)
    v_cvt_pk_bf16_f32 v176, v168, v169
    v_cvt_pk_bf16_f32 v177, v170, v171
    v_cvt_pk_bf16_f32 v178, v172, v173
    v_cvt_pk_bf16_f32 v179, v174, v175
    v_pk_maximum3_f16 v216, v176, v177, v216
    v_pk_maximum3_f16 v216, v178, v179, v216
    v_add_f32 v24, v24, v25
    v_add_f32 v26, v26, v27
    v_add_f32 v24, v24, v26
    v_rcp_f32 v84, v24
    v_pk_add_f32 v[48:49], v[48:49], v[56:57]
    v_pk_add_f32 v[50:51], v[50:51], v[58:59]
    v_pk_add_f32 v[52:53], v[52:53], v[60:61]
    v_pk_add_f32 v[54:55], v[54:55], v[62:63]
    v_pk_add_f32 v[64:65], v[64:65], v[72:73]
    buffer_store_dwordx4 v[176:179], v1, s[20:23], s35 offen offset:1024 sc0 sc1
    v_pk_add_f32 v[66:67], v[66:67], v[74:75]
    v_pk_add_f32 v[68:69], v[68:69], v[76:77]
    v_pk_add_f32 v[70:71], v[70:71], v[78:79]
    v_pk_add_f32 v[48:49], v[48:49], v[64:65]
    v_pk_add_f32 v[50:51], v[50:51], v[66:67]
    v_pk_add_f32 v[52:53], v[52:53], v[68:69]
    v_pk_add_f32 v[54:55], v[54:55], v[70:71]
    v_pk_mul_f32 v[48:49], v[48:49], v[84:85] op_sel_hi:[1,0]
    v_pk_mul_f32 v[50:51], v[50:51], v[84:85] op_sel_hi:[1,0]
    v_pk_mul_f32 v[52:53], v[52:53], v[84:85] op_sel_hi:[1,0]
    v_pk_mul_f32 v[54:55], v[54:55], v[84:85] op_sel_hi:[1,0]
    v_cvt_pk_bf16_f32 v56, v48, v49
    v_cvt_pk_bf16_f32 v57, v50, v51
    v_cvt_pk_bf16_f32 v58, v52, v53
    v_cvt_pk_bf16_f32 v59, v54, v55
    v_pk_maximum3_f16 v216, v56, v57, v216
    v_pk_maximum3_f16 v216, v58, v59, v216
    buffer_store_dwordx4 v[56:59], v1, s[20:23], s41 offen offset:0 sc0 sc1
    s_branch L_guard
L_pre1:
    s_nop 7
    v_mfma_f32_16x16x32_bf16 v[24:27], v[152:155], v[184:187], v[144:147]
    v_mov_b32 v248, 0
    v_mov_b32 v249, 0
    v_mfma_f32_16x16x32_bf16 v[24:27], v[156:159], v[188:191], v[24:27]
    v_mov_b32 v250, 0
    v_mov_b32 v251, 0
    v_mfma_f32_16x16x32_bf16 v[24:27], v[160:163], v[192:195], v[24:27]
    v_exp_f32 v8, v8
    v_mfma_f32_16x16x32_bf16 v[24:27], v[164:167], v[196:199], v[24:27]
    v_exp_f32 v9, v9
    v_mfma_f32_16x16x32_bf16 v[44:47], v[168:171], v[184:187], v[144:147]
    v_exp_f32 v10, v10
    v_mfma_f32_16x16x32_bf16 v[44:47], v[172:175], v[188:191], v[44:47]
    v_cvt_pk_bf16_f32 v52, v8, v9
    v_exp_f32 v11, v11
    v_mfma_f32_16x16x32_bf16 v[44:47], v[176:179], v[192:195], v[44:47]
    s_nop 0
    v_exp_f32 v24, v24
    v_mfma_f32_16x16x32_bf16 v[44:47], v[180:183], v[196:199], v[44:47]
    v_exp_f32 v25, v25
    v_exp_f32 v26, v26
    v_exp_f32 v27, v27
    v_add_f32 v238, v24, v238
    v_add_f32 v238, v25, v238
    v_cvt_pk_bf16_f32 v80, v24, v25
    v_add_f32 v238, v26, v238
    v_add_f32 v238, v27, v238
    v_cvt_pk_bf16_f32 v81, v26, v27
    v_mfma_f32_16x16x32_bf16 v[24:27], v[88:91], v[184:187], v[144:147]
    v_exp_f32 v44, v44
    v_mfma_f32_16x16x32_bf16 v[24:27], v[92:95], v[188:191], v[24:27]
    v_exp_f32 v45, v45
    v_mfma_f32_16x16x32_bf16 v[24:27], v[96:99], v[192:195], v[24:27]
    v_exp_f32 v46, v46
    v_mfma_f32_16x16x32_bf16 v[24:27], v[100:103], v[196:199], v[24:27]
    v_exp_f32 v47, v47
    v_add_f32 v238, v44, v238
    v_add_f32 v238, v45, v238
    v_cvt_pk_bf16_f32 v82, v44, v45
    v_add_f32 v238, v46, v238
    v_add_f32 v238, v47, v238
    v_cvt_pk_bf16_f32 v83, v46, v47
    v_mfma_f32_16x16x32_bf16 v[44:47], v[104:107], v[184:187], v[144:147]
    v_cvt_pk_bf16_f32 v53, v10, v11
    v_exp_f32 v12, v12
    v_mfma_f32_16x16x32_bf16 v[44:47], v[108:111], v[188:191], v[44:47]
    v_exp_f32 v13, v13
    v_mfma_f32_16x16x32_bf16 v[44:47], v[112:115], v[192:195], v[44:47]
    v_exp_f32 v14, v14
    v_mfma_f32_16x16x32_bf16 v[44:47], v[116:119], v[196:199], v[44:47]
    v_cvt_pk_bf16_f32 v60, v12, v13
    v_exp_f32 v15, v15
    s_nop 0
    v_cvt_pk_bf16_f32 v61, v14, v15
    v_exp_f32 v16, v16
    s_nop 0
    v_add_f32 v236, v16, v236
    v_exp_f32 v17, v17
    s_nop 0
    v_add_f32 v236, v17, v236
    v_exp_f32 v18, v18
    v_cvt_pk_bf16_f32 v68, v16, v17
    v_add_f32 v236, v18, v236
    v_exp_f32 v19, v19
    s_nop 0
    v_add_f32 v236, v19, v236
    v_exp_f32 v20, v20
    v_cvt_pk_bf16_f32 v69, v18, v19
    v_add_f32 v237, v20, v237
    v_exp_f32 v21, v21
    s_nop 0
    v_add_f32 v237, v21, v237
    v_cvt_pk_bf16_f32 v76, v20, v21
    v_exp_f32 v22, v22
    s_nop 0
    v_add_f32 v237, v22, v237
    v_exp_f32 v23, v23
    s_nop 0
    v_add_f32 v237, v23, v237
    v_exp_f32 v24, v24
    v_cvt_pk_bf16_f32 v77, v22, v23
    v_exp_f32 v25, v25
    v_add_f32 v238, v24, v238
    v_exp_f32 v26, v26
    v_exp_f32 v27, v27
    v_exp_f32 v28, v28
    v_exp_f32 v29, v29
    v_exp_f32 v30, v30
    v_exp_f32 v31, v31
    v_add_f32 v238, v25, v238
    v_cvt_pk_bf16_f32 v84, v24, v25
    v_exp_f32 v32, v32
    v_add_f32 v238, v26, v238
    v_exp_f32 v33, v33
    v_add_f32 v238, v27, v238
    v_exp_f32 v34, v34
    v_cvt_pk_bf16_f32 v85, v26, v27
    v_exp_f32 v35, v35
    v_cvt_pk_bf16_f32 v54, v28, v29
    v_exp_f32 v36, v36
    v_exp_f32 v37, v37
    v_cvt_pk_bf16_f32 v55, v30, v31
    v_cvt_pk_bf16_f32 v62, v32, v33
    v_exp_f32 v38, v38
    v_cvt_pk_bf16_f32 v63, v34, v35
    v_add_f32 v236, v36, v236
    v_exp_f32 v39, v39
    v_add_f32 v236, v37, v236
    v_cvt_pk_bf16_f32 v70, v36, v37
    v_exp_f32 v40, v40
    s_waitcnt vmcnt(8)
    s_barrier
    ds_read_b128 v[152:155], v216 offset:0
    ds_read_b128 v[156:159], v217 offset:0
    ds_read_b128 v[160:163], v218 offset:0
    ds_read_b128 v[164:167], v219 offset:0
    s_waitcnt lgkmcnt(0)
    s_branch L_loop1
L_tail1:
    s_nop 7
    v_mfma_f32_16x16x32_bf16 v[244:247], v[240:243], v[88:91], v[244:247]
    ds_read_b64_tr_b16 v[152:153], v220 offset:49152
    ds_read_b64_tr_b16 v[154:155], v220 offset:53248
    v_mfma_f32_16x16x32_bf16 v[244:247], v[240:243], v[92:95], v[244:247]
    v_add_u32 v218, 1056, v4
    ds_read_b64_tr_b16 v[156:157], v220 offset:57344
    ds_read_b64_tr_b16 v[158:159], v220 offset:61440
    ds_read_b64_tr_b16 v[160:161], v221 offset:49152
    ds_read_b64_tr_b16 v[162:163], v221 offset:53248
    ds_read_b64_tr_b16 v[164:165], v221 offset:57344
    ds_read_b64_tr_b16 v[166:167], v221 offset:61440
    ds_read_b64_tr_b16 v[168:169], v222 offset:49152
    ds_read_b64_tr_b16 v[170:171], v222 offset:53248
    ds_read_b64_tr_b16 v[172:173], v222 offset:57344
    ds_read_b64_tr_b16 v[174:175], v222 offset:61440
    ds_read_b64_tr_b16 v[176:177], v223 offset:49152
    ds_read_b64_tr_b16 v[178:179], v223 offset:53248
    ds_read_b64_tr_b16 v[180:181], v223 offset:57344
    ds_read_b64_tr_b16 v[182:183], v223 offset:61440
    ds_read_b64_tr_b16 v[48:49], v224 offset:49152
    ds_read_b64_tr_b16 v[50:51], v224 offset:53248
    ds_read_b64_tr_b16 v[52:53], v224 offset:57344
    ds_read_b64_tr_b16 v[54:55], v224 offset:61440
    ds_read_b64_tr_b16 v[56:57], v225 offset:49152
    ds_read_b64_tr_b16 v[58:59], v225 offset:53248
    ds_read_b64_tr_b16 v[60:61], v225 offset:57344
    ds_read_b64_tr_b16 v[62:63], v225 offset:61440
    ds_read_b64_tr_b16 v[64:65], v226 offset:49152
    ds_read_b64_tr_b16 v[66:67], v226 offset:53248
    ds_read_b64_tr_b16 v[68:69], v226 offset:57344
    ds_read_b64_tr_b16 v[70:71], v226 offset:61440
    ds_read_b64_tr_b16 v[72:73], v227 offset:49152
    ds_read_b64_tr_b16 v[74:75], v227 offset:53248
    ds_read_b64_tr_b16 v[76:77], v227 offset:57344
    ds_read_b64_tr_b16 v[78:79], v227 offset:61440
    v_add_u32 v219, 1056, v2
    v_add_u32 v232, 8448, v2
    v_add_u32 v233, 9504, v2
    v_mov_b32 v8, v244
    v_mov_b32 v14, v8
    v_mfma_f32_16x16x32_bf16 v[248:251], v[240:243], v[96:99], v[248:251]
    s_nop 0
    v_permlane16_swap_b32 v8, v14
    s_waitcnt lgkmcnt(15)
    v_mfma_f32_16x16x32_bf16 a[0:3], v[88:91], v[152:155], a[0:3]
    v_add_f32 v8, v8, v14
    v_mov_b32 v14, v8
    v_mfma_f32_16x16x32_bf16 a[0:3], v[92:95], v[156:159], a[0:3]
    s_nop 0
    v_permlane32_swap_b32 v8, v14
    v_mfma_f32_16x16x32_bf16 a[4:7], v[88:91], v[160:163], a[4:7]
    v_add_f32 v8, v8, v14
    v_rcp_f32 v20, v8
    v_mfma_f32_16x16x32_bf16 a[4:7], v[92:95], v[164:167], a[4:7]
    s_waitcnt lgkmcnt(15)
    v_exp_f32 v45, v45
    v_mfma_f32_16x16x32_bf16 a[8:11], v[88:91], v[168:171], a[8:11]
    v_add_f32 v237, v43, v237
    ds_write_b32 v254, v20 offset:0
    v_mfma_f32_16x16x32_bf16 a[8:11], v[92:95], v[172:175], a[8:11]
    ds_write2_b32 v4, a0, a1 offset0:0 offset1:132
    v_mfma_f32_16x16x32_bf16 a[12:15], v[88:91], v[176:179], a[12:15]
    s_waitcnt lgkmcnt(10)
    v_cvt_pk_bf16_f32 v119, v42, v43
    v_mfma_f32_16x16x32_bf16 a[12:15], v[92:95], v[180:183], a[12:15]
    ds_write2_b32 v218, a2, a3 offset0:0 offset1:132
    v_mfma_f32_16x16x32_bf16 a[16:19], v[88:91], v[48:51], a[16:19]
    v_exp_f32 v46, v46
    v_mfma_f32_16x16x32_bf16 a[16:19], v[92:95], v[52:55], a[16:19]
    ds_write2_b32 v4, a4, a5 offset0:16 offset1:148
    v_mfma_f32_16x16x32_bf16 a[20:23], v[88:91], v[56:59], a[20:23]
    s_waitcnt lgkmcnt(4)
    v_add_f32 v239, v44, v239
    v_mfma_f32_16x16x32_bf16 a[20:23], v[92:95], v[60:63], a[20:23]
    ds_write2_b32 v218, a6, a7 offset0:16 offset1:148
    v_mfma_f32_16x16x32_bf16 a[24:27], v[88:91], v[64:67], a[24:27]
    v_add_f32 v239, v45, v239
    v_cvt_pk_bf16_f32 v126, v44, v45
    v_mfma_f32_16x16x32_bf16 a[24:27], v[92:95], v[68:71], a[24:27]
    ds_write2_b32 v4, a8, a9 offset0:32 offset1:164
    v_mfma_f32_16x16x32_bf16 a[28:31], v[88:91], v[72:75], a[28:31]
    v_exp_f32 v47, v47
    v_mfma_f32_16x16x32_bf16 a[28:31], v[92:95], v[76:79], a[28:31]
    ds_write2_b32 v218, a10, a11 offset0:32 offset1:164
    ds_write2_b32 v4, a12, a13 offset0:48 offset1:180
    ds_write2_b32 v218, a14, a15 offset0:48 offset1:180
    ds_write2_b32 v4, a16, a17 offset0:64 offset1:196
    ds_write2_b32 v218, a18, a19 offset0:64 offset1:196
    ds_write2_b32 v4, a20, a21 offset0:80 offset1:212
    ds_write2_b32 v218, a22, a23 offset0:80 offset1:212
    ds_write2_b32 v4, a24, a25 offset0:96 offset1:228
    ds_write2_b32 v218, a26, a27 offset0:96 offset1:228
    ds_write2_b32 v4, a28, a29 offset0:112 offset1:244
    ds_write2_b32 v218, a30, a31 offset0:112 offset1:244
    ds_read_b32 v28, v255 offset:0
    ds_read_b128 v[184:187], v5 offset:0
    ds_read_b128 v[188:191], v5 offset:16
    ds_read_b32 v29, v255 offset:16
    ds_read_b128 v[192:195], v5 offset:2112
    ds_read_b128 v[196:199], v5 offset:2128
    ds_read_b32 v30, v255 offset:32
    ds_read_b128 v[200:203], v5 offset:4224
    ds_read_b128 v[204:207], v5 offset:4240
    ds_read_b32 v31, v255 offset:48
    ds_read_b128 v[208:211], v5 offset:6336
    ds_read_b128 v[212:215], v5 offset:6352
    v_mfma_f32_16x16x32_bf16 v[248:251], v[240:243], v[100:103], v[248:251]
    v_add_f32 v239, v46, v239
    v_add_f32 v239, v47, v239
    v_mfma_f32_16x16x32_bf16 a[32:35], v[96:99], v[152:155], a[32:35]
    v_cvt_pk_bf16_f32 v127, v46, v47
    v_mov_b32 v216, 0
    v_mfma_f32_16x16x32_bf16 a[32:35], v[100:103], v[156:159], a[32:35]
    v_mov_b32 v10, v236
    v_mov_b32 v11, v237
    v_mfma_f32_16x16x32_bf16 a[36:39], v[96:99], v[160:163], a[36:39]
    v_mov_b32 v9, v248
    v_mov_b32 v12, v238
    v_mfma_f32_16x16x32_bf16 a[36:39], v[100:103], v[164:167], a[36:39]
    v_mov_b32 v13, v239
    v_mov_b32 v15, v9
    v_mfma_f32_16x16x32_bf16 a[40:43], v[96:99], v[168:171], a[40:43]
    v_mov_b32 v16, v10
    v_mov_b32 v17, v11
    v_mfma_f32_16x16x32_bf16 a[40:43], v[100:103], v[172:175], a[40:43]
    v_mov_b32 v18, v12
    v_mov_b32 v19, v13
    v_mfma_f32_16x16x32_bf16 a[44:47], v[96:99], v[176:179], a[44:47]
    v_permlane16_swap_b32 v9, v15
    v_mfma_f32_16x16x32_bf16 a[44:47], v[100:103], v[180:183], a[44:47]
    v_permlane16_swap_b32 v10, v16
    v_mfma_f32_16x16x32_bf16 a[48:51], v[96:99], v[48:51], a[48:51]
    v_permlane16_swap_b32 v11, v17
    v_mfma_f32_16x16x32_bf16 a[48:51], v[100:103], v[52:55], a[48:51]
    v_permlane16_swap_b32 v12, v18
    v_mfma_f32_16x16x32_bf16 a[52:55], v[96:99], v[56:59], a[52:55]
    v_permlane16_swap_b32 v13, v19
    v_mfma_f32_16x16x32_bf16 a[52:55], v[100:103], v[60:63], a[52:55]
    v_add_f32 v9, v9, v15
    v_add_f32 v10, v10, v16
    v_mfma_f32_16x16x32_bf16 a[56:59], v[96:99], v[64:67], a[56:59]
    v_add_f32 v11, v11, v17
    v_add_f32 v12, v12, v18
    v_mfma_f32_16x16x32_bf16 a[56:59], v[100:103], v[68:71], a[56:59]
    v_add_f32 v13, v13, v19
    v_mov_b32 v15, v9
    v_mfma_f32_16x16x32_bf16 a[60:63], v[96:99], v[72:75], a[60:63]
    v_mov_b32 v16, v10
    v_mov_b32 v17, v11
    v_mfma_f32_16x16x32_bf16 a[60:63], v[100:103], v[76:79], a[60:63]
    ds_write2_b32 v2, a128, a129 offset0:0 offset1:132
    s_waitcnt lgkmcnt(7)
    v_pk_mul_f32 v[184:185], v[184:185], v[28:29] op_sel_hi:[1,0]
    v_pk_mul_f32 v[186:187], v[186:187], v[28:29] op_sel_hi:[1,0]
    v_pk_mul_f32 v[188:189], v[188:189], v[28:29] op_sel_hi:[1,0]
    v_pk_mul_f32 v[190:191], v[190:191], v[28:29] op_sel_hi:[1,0]
    v_cvt_pk_bf16_f32 v184, v184, v185
    v_cvt_pk_bf16_f32 v185, v186, v187
    v_cvt_pk_bf16_f32 v186, v188, v189
    v_cvt_pk_bf16_f32 v187, v190, v191
    buffer_store_dwordx4 v[184:187], v1, s[20:23], s4 offen offset:0 sc0 sc1
    v_pk_maximum3_f16 v216, v184, v185, v216
    v_pk_maximum3_f16 v216, v186, v187, v216
    v_pk_mul_f32 v[192:193], v[192:193], v[28:29] op_sel:[0,1] op_sel_hi:[1,1]
    v_pk_mul_f32 v[194:195], v[194:195], v[28:29] op_sel:[0,1] op_sel_hi:[1,1]
    s_waitcnt lgkmcnt(1)
    v_pk_mul_f32 v[196:197], v[196:197], v[28:29] op_sel:[0,1] op_sel_hi:[1,1]
    v_pk_mul_f32 v[198:199], v[198:199], v[28:29] op_sel:[0,1] op_sel_hi:[1,1]
    v_cvt_pk_bf16_f32 v192, v192, v193
    v_cvt_pk_bf16_f32 v193, v194, v195
    v_cvt_pk_bf16_f32 v194, v196, v197
    v_cvt_pk_bf16_f32 v195, v198, v199
    v_pk_maximum3_f16 v216, v192, v193, v216
    v_pk_maximum3_f16 v216, v194, v195, v216
    v_pk_mul_f32 v[200:201], v[200:201], v[30:31] op_sel_hi:[1,0]
    v_pk_mul_f32 v[202:203], v[202:203], v[30:31] op_sel_hi:[1,0]
    v_pk_mul_f32 v[204:205], v[204:205], v[30:31] op_sel_hi:[1,0]
    v_pk_mul_f32 v[206:207], v[206:207], v[30:31] op_sel_hi:[1,0]
    buffer_store_dwordx4 v[192:195], v1, s[20:23], s4 offen offset:1024 sc0 sc1
    v_cvt_pk_bf16_f32 v200, v200, v201
    v_cvt_pk_bf16_f32 v201, v202, v203
    v_cvt_pk_bf16_f32 v202, v204, v205
    v_cvt_pk_bf16_f32 v203, v206, v207
    v_pk_maximum3_f16 v216, v200, v201, v216
    v_pk_maximum3_f16 v216, v202, v203, v216
    v_pk_mul_f32 v[208:209], v[208:209], v[30:31] op_sel:[0,1] op_sel_hi:[1,1]
    v_pk_mul_f32 v[210:211], v[210:211], v[30:31] op_sel:[0,1] op_sel_hi:[1,1]
    v_pk_mul_f32 v[212:213], v[212:213], v[30:31] op_sel:[0,1] op_sel_hi:[1,1]
    v_pk_mul_f32 v[214:215], v[214:215], v[30:31] op_sel:[0,1] op_sel_hi:[1,1]
    v_cvt_pk_bf16_f32 v208, v208, v209
    v_cvt_pk_bf16_f32 v209, v210, v211
    v_cvt_pk_bf16_f32 v210, v212, v213
    v_cvt_pk_bf16_f32 v211, v214, v215
    v_pk_maximum3_f16 v216, v208, v209, v216
    v_pk_maximum3_f16 v216, v210, v211, v216
    v_mfma_f32_16x16x32_bf16 a[160:163], v[124:127], v[156:159], a[160:163]
    buffer_store_dwordx4 v[200:203], v1, s[20:23], s4 offen offset:2048 sc0 sc1
    v_mfma_f32_16x16x32_bf16 a[164:167], v[124:127], v[164:167], a[164:167]
    ds_write2_b32 v219, a130, a131 offset0:0 offset1:132
    v_mfma_f32_16x16x32_bf16 a[168:171], v[124:127], v[172:175], a[168:171]
    v_mov_b32 v18, v12
    v_mov_b32 v19, v13
    v_mfma_f32_16x16x32_bf16 a[172:175], v[124:127], v[180:183], a[172:175]
    ds_write2_b32 v2, a132, a133 offset0:16 offset1:148
    v_mfma_f32_16x16x32_bf16 a[176:179], v[124:127], v[52:55], a[176:179]
    v_permlane32_swap_b32 v9, v15
    buffer_store_dwordx4 v[208:211], v1, s[20:23], s4 offen offset:3072 sc0 sc1
    v_mfma_f32_16x16x32_bf16 a[180:183], v[124:127], v[60:63], a[180:183]
    ds_write2_b32 v219, a134, a135 offset0:16 offset1:148
    v_mfma_f32_16x16x32_bf16 a[184:187], v[124:127], v[68:71], a[184:187]
    v_permlane32_swap_b32 v10, v16
    v_mfma_f32_16x16x32_bf16 a[188:191], v[124:127], v[76:79], a[188:191]
    ds_write2_b32 v2, a136, a137 offset0:32 offset1:164
    v_mfma_f32_16x16x32_bf16 a[64:67], v[104:107], v[152:155], a[64:67]
    v_permlane32_swap_b32 v11, v17
    v_mfma_f32_16x16x32_bf16 a[64:67], v[108:111], v[156:159], a[64:67]
    ds_write2_b32 v219, a138, a139 offset0:32 offset1:164
    v_mfma_f32_16x16x32_bf16 a[68:71], v[104:107], v[160:163], a[68:71]
    v_permlane32_swap_b32 v12, v18
    v_mfma_f32_16x16x32_bf16 a[68:71], v[108:111], v[164:167], a[68:71]
    ds_write2_b32 v2, a140, a141 offset0:48 offset1:180
    v_mfma_f32_16x16x32_bf16 a[72:75], v[104:107], v[168:171], a[72:75]
    v_permlane32_swap_b32 v13, v19
    v_mfma_f32_16x16x32_bf16 a[72:75], v[108:111], v[172:175], a[72:75]
    ds_write2_b32 v219, a142, a143 offset0:48 offset1:180
    v_mfma_f32_16x16x32_bf16 a[76:79], v[104:107], v[176:179], a[76:79]
    v_add_f32 v9, v9, v15
    v_add_f32 v10, v10, v16
    v_mfma_f32_16x16x32_bf16 a[76:79], v[108:111], v[180:183], a[76:79]
    ds_write2_b32 v2, a144, a145 offset0:64 offset1:196
    v_mfma_f32_16x16x32_bf16 a[80:83], v[104:107], v[48:51], a[80:83]
    v_add_f32 v11, v11, v17
    v_add_f32 v12, v12, v18
    v_mfma_f32_16x16x32_bf16 a[80:83], v[108:111], v[52:55], a[80:83]
    ds_write2_b32 v219, a146, a147 offset0:64 offset1:196
    v_mfma_f32_16x16x32_bf16 a[84:87], v[104:107], v[56:59], a[84:87]
    v_add_f32 v13, v13, v19
    v_rcp_f32 v21, v9
    v_mfma_f32_16x16x32_bf16 a[84:87], v[108:111], v[60:63], a[84:87]
    ds_write2_b32 v2, a148, a149 offset0:80 offset1:212
    v_mfma_f32_16x16x32_bf16 a[88:91], v[104:107], v[64:67], a[88:91]
    v_rcp_f32 v22, v10
    v_mfma_f32_16x16x32_bf16 a[88:91], v[108:111], v[68:71], a[88:91]
    ds_write2_b32 v219, a150, a151 offset0:80 offset1:212
    v_mfma_f32_16x16x32_bf16 a[92:95], v[104:107], v[72:75], a[92:95]
    v_rcp_f32 v23, v11
    v_mfma_f32_16x16x32_bf16 a[92:95], v[108:111], v[76:79], a[92:95]
    ds_write2_b32 v2, a152, a153 offset0:96 offset1:228
    v_mfma_f32_16x16x32_bf16 a[96:99], v[112:115], v[152:155], a[96:99]
    v_mfma_f32_16x16x32_bf16 a[96:99], v[116:119], v[156:159], a[96:99]
    ds_write2_b32 v219, a154, a155 offset0:96 offset1:228
    v_mfma_f32_16x16x32_bf16 a[100:103], v[112:115], v[160:163], a[100:103]
    v_mfma_f32_16x16x32_bf16 a[100:103], v[116:119], v[164:167], a[100:103]
    ds_write2_b32 v2, a156, a157 offset0:112 offset1:244
    v_mfma_f32_16x16x32_bf16 a[104:107], v[112:115], v[168:171], a[104:107]
    v_mfma_f32_16x16x32_bf16 a[104:107], v[116:119], v[172:175], a[104:107]
    ds_write2_b32 v219, a158, a159 offset0:112 offset1:244
    v_mfma_f32_16x16x32_bf16 a[108:111], v[112:115], v[176:179], a[108:111]
    v_mfma_f32_16x16x32_bf16 a[108:111], v[116:119], v[180:183], a[108:111]
    ds_write_b32 v254, v21 offset:64
    ds_write2_b32 v4, a32, a33 offset0:0 offset1:132
    v_mfma_f32_16x16x32_bf16 a[112:115], v[112:115], v[48:51], a[112:115]
    v_mfma_f32_16x16x32_bf16 a[112:115], v[116:119], v[52:55], a[112:115]
    ds_write2_b32 v218, a34, a35 offset0:0 offset1:132
    v_mfma_f32_16x16x32_bf16 a[116:119], v[112:115], v[56:59], a[116:119]
    v_mfma_f32_16x16x32_bf16 a[116:119], v[116:119], v[60:63], a[116:119]
    ds_write2_b32 v4, a36, a37 offset0:16 offset1:148
    v_mfma_f32_16x16x32_bf16 a[120:123], v[112:115], v[64:67], a[120:123]
    v_mfma_f32_16x16x32_bf16 a[120:123], v[116:119], v[68:71], a[120:123]
    ds_write2_b32 v218, a38, a39 offset0:16 offset1:148
    v_mfma_f32_16x16x32_bf16 a[124:127], v[112:115], v[72:75], a[124:127]
    v_mfma_f32_16x16x32_bf16 a[124:127], v[116:119], v[76:79], a[124:127]
    ds_write2_b32 v4, a40, a41 offset0:32 offset1:164
    ds_write2_b32 v218, a42, a43 offset0:32 offset1:164
    ds_write2_b32 v4, a44, a45 offset0:48 offset1:180
    ds_write2_b32 v218, a46, a47 offset0:48 offset1:180
    ds_write2_b32 v4, a48, a49 offset0:64 offset1:196
    ds_write2_b32 v218, a50, a51 offset0:64 offset1:196
    ds_write2_b32 v4, a52, a53 offset0:80 offset1:212
    ds_write2_b32 v218, a54, a55 offset0:80 offset1:212
    ds_write2_b32 v4, a56, a57 offset0:96 offset1:228
    ds_write2_b32 v218, a58, a59 offset0:96 offset1:228
    ds_write2_b32 v4, a60, a61 offset0:112 offset1:244
    ds_write2_b32 v218, a62, a63 offset0:112 offset1:244
    ds_read_b32 v32, v255 offset:64
    ds_read_b128 v[120:123], v5 offset:0
    ds_read_b128 v[124:127], v5 offset:16
    ds_read_b32 v33, v255 offset:80
    ds_read_b128 v[128:131], v5 offset:2112
    ds_read_b128 v[132:135], v5 offset:2128
    ds_read_b32 v34, v255 offset:96
    ds_read_b128 v[136:139], v5 offset:4224
    ds_read_b128 v[140:143], v5 offset:4240
    ds_read_b32 v35, v255 offset:112
    ds_read_b128 v[144:147], v5 offset:6336
    ds_read_b128 v[148:151], v5 offset:6352
    ds_write2_b32 v232, a160, a161 offset0:0 offset1:132
    ds_write2_b32 v233, a162, a163 offset0:0 offset1:132
    ds_write2_b32 v232, a164, a165 offset0:16 offset1:148
    ds_write2_b32 v233, a166, a167 offset0:16 offset1:148
    ds_write2_b32 v232, a168, a169 offset0:32 offset1:164
    ds_write2_b32 v233, a170, a171 offset0:32 offset1:164
    ds_write2_b32 v232, a172, a173 offset0:48 offset1:180
    ds_write2_b32 v233, a174, a175 offset0:48 offset1:180
    ds_write2_b32 v232, a176, a177 offset0:64 offset1:196
    ds_write2_b32 v233, a178, a179 offset0:64 offset1:196
    ds_write2_b32 v232, a180, a181 offset0:80 offset1:212
    ds_write2_b32 v233, a182, a183 offset0:80 offset1:212
    ds_write2_b32 v232, a184, a185 offset0:96 offset1:228
    ds_write2_b32 v233, a186, a187 offset0:96 offset1:228
    ds_write2_b32 v232, a188, a189 offset0:112 offset1:244
    s_waitcnt lgkmcnt(15)
    v_mul_f32 v120, v120, v32
    v_mul_f32 v121, v121, v32
    v_mul_f32 v122, v122, v32
    v_mul_f32 v123, v123, v32
    v_mul_f32 v124, v124, v32
    v_mul_f32 v125, v125, v32
    v_mul_f32 v126, v126, v32
    v_mul_f32 v127, v127, v32
    v_cvt_pk_bf16_f32 v120, v120, v121
    v_cvt_pk_bf16_f32 v121, v122, v123
    v_cvt_pk_bf16_f32 v122, v124, v125
    v_cvt_pk_bf16_f32 v123, v126, v127
    buffer_store_dwordx4 v[120:123], v1, s[20:23], s5 offen offset:0 sc0 sc1
    s_waitcnt lgkmcnt(15)
    v_pk_maximum3_f16 v216, v120, v121, v216
    v_pk_maximum3_f16 v216, v122, v123, v216
    v_mul_f32 v128, v128, v33
    v_mul_f32 v129, v129, v33
    v_mul_f32 v130, v130, v33
    v_mul_f32 v131, v131, v33
    v_mul_f32 v132, v132, v33
    v_mul_f32 v133, v133, v33
    v_mul_f32 v134, v134, v33
    v_mul_f32 v135, v135, v33
    v_cvt_pk_bf16_f32 v128, v128, v129
    v_cvt_pk_bf16_f32 v129, v130, v131
    v_cvt_pk_bf16_f32 v130, v132, v133
    v_cvt_pk_bf16_f32 v131, v134, v135
    v_pk_maximum3_f16 v216, v128, v129, v216
    v_pk_maximum3_f16 v216, v130, v131, v216
    buffer_store_dwordx4 v[128:131], v1, s[20:23], s5 offen offset:1024 sc0 sc1
    v_mul_f32 v136, v136, v34
    v_mul_f32 v137, v137, v34
    v_mul_f32 v138, v138, v34
    v_mul_f32 v139, v139, v34
    v_mul_f32 v140, v140, v34
    v_mul_f32 v141, v141, v34
    v_mul_f32 v142, v142, v34
    v_mul_f32 v143, v143, v34
    v_cvt_pk_bf16_f32 v136, v136, v137
    v_cvt_pk_bf16_f32 v137, v138, v139
    v_cvt_pk_bf16_f32 v138, v140, v141
    v_cvt_pk_bf16_f32 v139, v142, v143
    v_pk_maximum3_f16 v216, v136, v137, v216
    v_pk_maximum3_f16 v216, v138, v139, v216
    v_mul_f32 v144, v144, v35
    v_mul_f32 v145, v145, v35
    v_mul_f32 v146, v146, v35
    buffer_store_dwordx4 v[136:139], v1, s[20:23], s5 offen offset:2048 sc0 sc1
    v_mul_f32 v147, v147, v35
    v_mul_f32 v148, v148, v35
    v_mul_f32 v149, v149, v35
    v_mul_f32 v150, v150, v35
    v_mul_f32 v151, v151, v35
    v_cvt_pk_bf16_f32 v144, v144, v145
    v_cvt_pk_bf16_f32 v145, v146, v147
    v_cvt_pk_bf16_f32 v146, v148, v149
    v_cvt_pk_bf16_f32 v147, v150, v151
    v_pk_maximum3_f16 v216, v144, v145, v216
    v_pk_maximum3_f16 v216, v146, v147, v216
    ds_write2_b32 v233, a190, a191 offset0:112 offset1:244
    buffer_store_dwordx4 v[144:147], v1, s[20:23], s5 offen offset:3072 sc0 sc1
    ds_write_b32 v3, v12 offset:0
    ds_write_b32 v3, v13 offset:256
    ds_write_b32 v254, v22 offset:128
    ds_write2_b32 v4, a64, a65 offset0:0 offset1:132
    ds_write2_b32 v218, a66, a67 offset0:0 offset1:132
    ds_write2_b32 v4, a68, a69 offset0:16 offset1:148
    ds_write2_b32 v218, a70, a71 offset0:16 offset1:148
    ds_write2_b32 v4, a72, a73 offset0:32 offset1:164
    ds_write2_b32 v218, a74, a75 offset0:32 offset1:164
    ds_write2_b32 v4, a76, a77 offset0:48 offset1:180
    ds_write2_b32 v218, a78, a79 offset0:48 offset1:180
    ds_write2_b32 v4, a80, a81 offset0:64 offset1:196
    ds_write2_b32 v218, a82, a83 offset0:64 offset1:196
    ds_write2_b32 v4, a84, a85 offset0:80 offset1:212
    ds_write2_b32 v218, a86, a87 offset0:80 offset1:212
    ds_write2_b32 v4, a88, a89 offset0:96 offset1:228
    ds_write2_b32 v218, a90, a91 offset0:96 offset1:228
    ds_write2_b32 v4, a92, a93 offset0:112 offset1:244
    ds_write2_b32 v218, a94, a95 offset0:112 offset1:244
    ds_read_b32 v36, v255 offset:128
    ds_read_b128 v[184:187], v5 offset:0
    ds_read_b128 v[188:191], v5 offset:16
    ds_read_b32 v37, v255 offset:144
    ds_read_b128 v[192:195], v5 offset:2112
    ds_read_b128 v[196:199], v5 offset:2128
    ds_read_b32 v38, v255 offset:160
    ds_read_b128 v[200:203], v5 offset:4224
    ds_read_b128 v[204:207], v5 offset:4240
    ds_read_b32 v39, v255 offset:176
    ds_read_b128 v[208:211], v5 offset:6336
    ds_read_b128 v[212:215], v5 offset:6352
    ds_write_b32 v254, v23 offset:192
    ds_write2_b32 v4, a96, a97 offset0:0 offset1:132
    ds_write2_b32 v218, a98, a99 offset0:0 offset1:132
    ds_write2_b32 v4, a100, a101 offset0:16 offset1:148
    ds_write2_b32 v218, a102, a103 offset0:16 offset1:148
    ds_write2_b32 v4, a104, a105 offset0:32 offset1:164
    ds_write2_b32 v218, a106, a107 offset0:32 offset1:164
    ds_write2_b32 v4, a108, a109 offset0:48 offset1:180
    ds_write2_b32 v218, a110, a111 offset0:48 offset1:180
    ds_write2_b32 v4, a112, a113 offset0:64 offset1:196
    ds_write2_b32 v218, a114, a115 offset0:64 offset1:196
    ds_write2_b32 v4, a116, a117 offset0:80 offset1:212
    ds_write2_b32 v218, a118, a119 offset0:80 offset1:212
    ds_write2_b32 v4, a120, a121 offset0:96 offset1:228
    ds_write2_b32 v218, a122, a123 offset0:96 offset1:228
    s_waitcnt lgkmcnt(15)
    v_pk_mul_f32 v[184:185], v[184:185], v[36:37] op_sel_hi:[1,0]
    v_pk_mul_f32 v[186:187], v[186:187], v[36:37] op_sel_hi:[1,0]
    v_pk_mul_f32 v[188:189], v[188:189], v[36:37] op_sel_hi:[1,0]
    v_pk_mul_f32 v[190:191], v[190:191], v[36:37] op_sel_hi:[1,0]
    v_cvt_pk_bf16_f32 v184, v184, v185
    v_cvt_pk_bf16_f32 v185, v186, v187
    v_cvt_pk_bf16_f32 v186, v188, v189
    v_cvt_pk_bf16_f32 v187, v190, v191
    buffer_store_dwordx4 v[184:187], v1, s[20:23], s6 offen offset:0 sc0 sc1
    v_pk_maximum3_f16 v216, v184, v185, v216
    v_pk_maximum3_f16 v216, v186, v187, v216
    v_pk_mul_f32 v[192:193], v[192:193], v[36:37] op_sel:[0,1] op_sel_hi:[1,1]
    v_pk_mul_f32 v[194:195], v[194:195], v[36:37] op_sel:[0,1] op_sel_hi:[1,1]
    s_waitcnt lgkmcnt(15)
    v_pk_mul_f32 v[196:197], v[196:197], v[36:37] op_sel:[0,1] op_sel_hi:[1,1]
    v_pk_mul_f32 v[198:199], v[198:199], v[36:37] op_sel:[0,1] op_sel_hi:[1,1]
    v_cvt_pk_bf16_f32 v192, v192, v193
    v_cvt_pk_bf16_f32 v193, v194, v195
    v_cvt_pk_bf16_f32 v194, v196, v197
    v_cvt_pk_bf16_f32 v195, v198, v199
    v_pk_maximum3_f16 v216, v192, v193, v216
    v_pk_maximum3_f16 v216, v194, v195, v216
    v_pk_mul_f32 v[200:201], v[200:201], v[38:39] op_sel_hi:[1,0]
    v_pk_mul_f32 v[202:203], v[202:203], v[38:39] op_sel_hi:[1,0]
    v_pk_mul_f32 v[204:205], v[204:205], v[38:39] op_sel_hi:[1,0]
    v_pk_mul_f32 v[206:207], v[206:207], v[38:39] op_sel_hi:[1,0]
    buffer_store_dwordx4 v[192:195], v1, s[20:23], s6 offen offset:1024 sc0 sc1
    v_cvt_pk_bf16_f32 v200, v200, v201
    v_cvt_pk_bf16_f32 v201, v202, v203
    v_cvt_pk_bf16_f32 v202, v204, v205
    v_cvt_pk_bf16_f32 v203, v206, v207
    v_pk_maximum3_f16 v216, v200, v201, v216
    v_pk_maximum3_f16 v216, v202, v203, v216
    v_pk_mul_f32 v[208:209], v[208:209], v[38:39] op_sel:[0,1] op_sel_hi:[1,1]
    v_pk_mul_f32 v[210:211], v[210:211], v[38:39] op_sel:[0,1] op_sel_hi:[1,1]
    v_pk_mul_f32 v[212:213], v[212:213], v[38:39] op_sel:[0,1] op_sel_hi:[1,1]
    v_pk_mul_f32 v[214:215], v[214:215], v[38:39] op_sel:[0,1] op_sel_hi:[1,1]
    v_cvt_pk_bf16_f32 v208, v208, v209
    v_cvt_pk_bf16_f32 v209, v210, v211
    v_cvt_pk_bf16_f32 v210, v212, v213
    v_cvt_pk_bf16_f32 v211, v214, v215
    v_pk_maximum3_f16 v216, v208, v209, v216
    v_pk_maximum3_f16 v216, v210, v211, v216
    buffer_store_dwordx4 v[200:203], v1, s[20:23], s6 offen offset:2048 sc0 sc1
    ds_write2_b32 v4, a124, a125 offset0:112 offset1:244
    buffer_store_dwordx4 v[208:211], v1, s[20:23], s6 offen offset:3072 sc0 sc1
    ds_write2_b32 v218, a126, a127 offset0:112 offset1:244
    ds_read_b32 v40, v255 offset:192
    ds_read_b128 v[120:123], v5 offset:0
    ds_read_b128 v[124:127], v5 offset:16
    ds_read_b32 v41, v255 offset:208
    ds_read_b128 v[128:131], v5 offset:2112
    ds_read_b128 v[132:135], v5 offset:2128
    ds_read_b32 v42, v255 offset:224
    ds_read_b128 v[136:139], v5 offset:4224
    ds_read_b128 v[140:143], v5 offset:4240
    ds_read_b32 v43, v255 offset:240
    ds_read_b128 v[144:147], v5 offset:6336
    ds_read_b128 v[148:151], v5 offset:6352
    s_waitcnt lgkmcnt(6)
    v_pk_mul_f32 v[120:121], v[120:121], v[40:41] op_sel_hi:[1,0]
    v_pk_mul_f32 v[122:123], v[122:123], v[40:41] op_sel_hi:[1,0]
    v_pk_mul_f32 v[124:125], v[124:125], v[40:41] op_sel_hi:[1,0]
    v_pk_mul_f32 v[126:127], v[126:127], v[40:41] op_sel_hi:[1,0]
    v_cvt_pk_bf16_f32 v120, v120, v121
    v_cvt_pk_bf16_f32 v121, v122, v123
    v_cvt_pk_bf16_f32 v122, v124, v125
    v_cvt_pk_bf16_f32 v123, v126, v127
    buffer_store_dwordx4 v[120:123], v1, s[20:23], s7 offen offset:0 sc0 sc1
    v_pk_maximum3_f16 v216, v120, v121, v216
    v_pk_maximum3_f16 v216, v122, v123, v216
    v_pk_mul_f32 v[128:129], v[128:129], v[40:41] op_sel:[0,1] op_sel_hi:[1,1]
    v_pk_mul_f32 v[130:131], v[130:131], v[40:41] op_sel:[0,1] op_sel_hi:[1,1]
    s_waitcnt lgkmcnt(0)
    s_barrier
    ds_read_b128 v[152:155], v6 offset:0
    ds_read_b128 v[156:159], v6 offset:16
    ds_read_b32 v14, v7 offset:0
    ds_read_b128 v[160:163], v6 offset:33792
    ds_read_b128 v[164:167], v6 offset:33808
    ds_read_b32 v15, v7 offset:1024
    ds_read_b128 v[168:171], v6 offset:2112
    ds_read_b128 v[172:175], v6 offset:2128
    ds_read_b32 v16, v7 offset:16
    ds_read_b128 v[176:179], v6 offset:35904
    ds_read_b128 v[180:183], v6 offset:35920
    ds_read_b32 v17, v7 offset:1040
    ds_read_b128 v[48:51], v252 offset:0
    ds_read_b128 v[52:55], v252 offset:16
    ds_read_b32 v24, v253 offset:0
    ds_read_b128 v[56:59], v252 offset:16896
    ds_read_b128 v[60:63], v252 offset:16912
    ds_read_b32 v25, v253 offset:512
    ds_read_b128 v[64:67], v252 offset:33792
    ds_read_b128 v[68:71], v252 offset:33808
    ds_read_b32 v26, v253 offset:1024
    ds_read_b128 v[72:75], v252 offset:50688
    ds_read_b128 v[76:79], v252 offset:50704
    ds_read_b32 v27, v253 offset:1536
    v_pk_mul_f32 v[132:133], v[132:133], v[40:41] op_sel:[0,1] op_sel_hi:[1,1]
    v_pk_mul_f32 v[134:135], v[134:135], v[40:41] op_sel:[0,1] op_sel_hi:[1,1]
    v_cvt_pk_bf16_f32 v128, v128, v129
    v_cvt_pk_bf16_f32 v129, v130, v131
    v_cvt_pk_bf16_f32 v130, v132, v133
    v_cvt_pk_bf16_f32 v131, v134, v135
    buffer_store_dwordx4 v[128:131], v1, s[20:23], s7 offen offset:1024 sc0 sc1
    v_pk_maximum3_f16 v216, v128, v129, v216
    v_pk_maximum3_f16 v216, v130, v131, v216
    v_pk_mul_f32 v[136:137], v[136:137], v[42:43] op_sel_hi:[1,0]
    v_pk_mul_f32 v[138:139], v[138:139], v[42:43] op_sel_hi:[1,0]
    v_pk_mul_f32 v[140:141], v[140:141], v[42:43] op_sel_hi:[1,0]
    v_pk_mul_f32 v[142:143], v[142:143], v[42:43] op_sel_hi:[1,0]
    v_cvt_pk_bf16_f32 v136, v136, v137
    v_cvt_pk_bf16_f32 v137, v138, v139
    v_cvt_pk_bf16_f32 v138, v140, v141
    v_cvt_pk_bf16_f32 v139, v142, v143
    v_pk_maximum3_f16 v216, v136, v137, v216
    v_pk_maximum3_f16 v216, v138, v139, v216
    v_pk_mul_f32 v[144:145], v[144:145], v[42:43] op_sel:[0,1] op_sel_hi:[1,1]
    v_pk_mul_f32 v[146:147], v[146:147], v[42:43] op_sel:[0,1] op_sel_hi:[1,1]
    v_pk_mul_f32 v[148:149], v[148:149], v[42:43] op_sel:[0,1] op_sel_hi:[1,1]
    v_pk_mul_f32 v[150:151], v[150:151], v[42:43] op_sel:[0,1] op_sel_hi:[1,1]
    v_cvt_pk_bf16_f32 v144, v144, v145
    buffer_store_dwordx4 v[136:139], v1, s[20:23], s7 offen offset:2048 sc0 sc1
    v_cvt_pk_bf16_f32 v145, v146, v147
    v_cvt_pk_bf16_f32 v146, v148, v149
    v_cvt_pk_bf16_f32 v147, v150, v151
    v_pk_maximum3_f16 v216, v144, v145, v216
    s_waitcnt lgkmcnt(12)
    v_pk_maximum3_f16 v216, v146, v147, v216
    v_add_f32 v14, v14, v15
    v_rcp_f32 v80, v14
    v_pk_add_f32 v[152:153], v[152:153], v[160:161]
    v_pk_add_f32 v[154:155], v[154:155], v[162:163]
    v_pk_add_f32 v[156:157], v[156:157], v[164:165]
    v_pk_add_f32 v[158:159], v[158:159], v[166:167]
    v_pk_mul_f32 v[152:153], v[152:153], v[80:81] op_sel_hi:[1,0]
    v_pk_mul_f32 v[154:155], v[154:155], v[80:81] op_sel_hi:[1,0]
    v_pk_mul_f32 v[156:157], v[156:157], v[80:81] op_sel_hi:[1,0]
    v_pk_mul_f32 v[158:159], v[158:159], v[80:81] op_sel_hi:[1,0]
    buffer_store_dwordx4 v[144:147], v1, s[20:23], s7 offen offset:3072 sc0 sc1
    v_cvt_pk_bf16_f32 v160, v152, v153
    v_cvt_pk_bf16_f32 v161, v154, v155
    v_cvt_pk_bf16_f32 v162, v156, v157
    v_cvt_pk_bf16_f32 v163, v158, v159
    v_pk_maximum3_f16 v216, v160, v161, v216
    v_pk_maximum3_f16 v216, v162, v163, v216
    v_add_f32 v16, v16, v17
    v_rcp_f32 v82, v16
    v_pk_add_f32 v[168:169], v[168:169], v[176:177]
    v_pk_add_f32 v[170:171], v[170:171], v[178:179]
    v_pk_add_f32 v[172:173], v[172:173], v[180:181]
    v_pk_add_f32 v[174:175], v[174:175], v[182:183]
    v_pk_mul_f32 v[168:169], v[168:169], v[82:83] op_sel_hi:[1,0]
    v_pk_mul_f32 v[170:171], v[170:171], v[82:83] op_sel_hi:[1,0]
    v_pk_mul_f32 v[172:173], v[172:173], v[82:83] op_sel_hi:[1,0]
    v_pk_mul_f32 v[174:175], v[174:175], v[82:83] op_sel_hi:[1,0]
    buffer_store_dwordx4 v[160:163], v1, s[20:23], s35 offen offset:0 sc0 sc1
    s_waitcnt lgkmcnt(0)
    v_cvt_pk_bf16_f32 v176, v168, v169
    v_cvt_pk_bf16_f32 v177, v170, v171
    v_cvt_pk_bf16_f32 v178, v172, v173
    v_cvt_pk_bf16_f32 v179, v174, v175
    v_pk_maximum3_f16 v216, v176, v177, v216
    v_pk_maximum3_f16 v216, v178, v179, v216
    v_add_f32 v24, v24, v25
    v_add_f32 v26, v26, v27
    v_add_f32 v24, v24, v26
    v_rcp_f32 v84, v24
    v_pk_add_f32 v[48:49], v[48:49], v[56:57]
    v_pk_add_f32 v[50:51], v[50:51], v[58:59]
    v_pk_add_f32 v[52:53], v[52:53], v[60:61]
    v_pk_add_f32 v[54:55], v[54:55], v[62:63]
    v_pk_add_f32 v[64:65], v[64:65], v[72:73]
    buffer_store_dwordx4 v[176:179], v1, s[20:23], s35 offen offset:1024 sc0 sc1
    v_pk_add_f32 v[66:67], v[66:67], v[74:75]
    v_pk_add_f32 v[68:69], v[68:69], v[76:77]
    v_pk_add_f32 v[70:71], v[70:71], v[78:79]
    v_pk_add_f32 v[48:49], v[48:49], v[64:65]
    v_pk_add_f32 v[50:51], v[50:51], v[66:67]
    v_pk_add_f32 v[52:53], v[52:53], v[68:69]
    v_pk_add_f32 v[54:55], v[54:55], v[70:71]
    v_pk_mul_f32 v[48:49], v[48:49], v[84:85] op_sel_hi:[1,0]
    v_pk_mul_f32 v[50:51], v[50:51], v[84:85] op_sel_hi:[1,0]
    v_pk_mul_f32 v[52:53], v[52:53], v[84:85] op_sel_hi:[1,0]
    v_pk_mul_f32 v[54:55], v[54:55], v[84:85] op_sel_hi:[1,0]
    v_cvt_pk_bf16_f32 v56, v48, v49
    v_cvt_pk_bf16_f32 v57, v50, v51
    v_cvt_pk_bf16_f32 v58, v52, v53
    v_cvt_pk_bf16_f32 v59, v54, v55
    v_pk_maximum3_f16 v216, v56, v57, v216
    v_pk_maximum3_f16 v216, v58, v59, v216
    buffer_store_dwordx4 v[56:59], v1, s[20:23], s41 offen offset:0 sc0 sc1
    s_branch L_guard
L_pre2:
    s_nop 7
    v_mfma_f32_16x16x32_bf16 v[24:27], v[152:155], v[200:203], v[148:151]
    v_mov_b32 v248, 0
    v_mov_b32 v249, 0
    v_mfma_f32_16x16x32_bf16 v[24:27], v[156:159], v[204:207], v[24:27]
    v_mov_b32 v250, 0
    v_mov_b32 v251, 0
    v_mfma_f32_16x16x32_bf16 v[24:27], v[160:163], v[208:211], v[24:27]
    v_exp_f32 v8, v8
    v_mfma_f32_16x16x32_bf16 v[24:27], v[164:167], v[212:215], v[24:27]
    v_exp_f32 v9, v9
    v_mfma_f32_16x16x32_bf16 v[44:47], v[168:171], v[200:203], v[148:151]
    v_exp_f32 v10, v10
    v_mfma_f32_16x16x32_bf16 v[44:47], v[172:175], v[204:207], v[44:47]
    v_exp_f32 v11, v11
    v_mfma_f32_16x16x32_bf16 v[44:47], v[176:179], v[208:211], v[44:47]
    s_nop 1
    v_exp_f32 v24, v24
    v_mfma_f32_16x16x32_bf16 v[44:47], v[180:183], v[212:215], v[44:47]
    v_exp_f32 v25, v25
    v_exp_f32 v26, v26
    v_exp_f32 v27, v27
    v_add_f32 v239, v24, v239
    v_add_f32 v239, v25, v239
    v_cvt_pk_bf16_f32 v80, v24, v25
    v_add_f32 v239, v26, v239
    v_add_f32 v239, v27, v239
    v_cvt_pk_bf16_f32 v81, v26, v27
    v_exp_f32 v44, v44
    v_exp_f32 v45, v45
    v_exp_f32 v46, v46
    v_exp_f32 v47, v47
    v_add_f32 v239, v44, v239
    v_add_f32 v239, v45, v239
    v_cvt_pk_bf16_f32 v82, v44, v45
    v_add_f32 v239, v46, v239
    v_add_f32 v239, v47, v239
    v_cvt_pk_bf16_f32 v83, v46, v47
    v_exp_f32 v12, v12
    v_cvt_pk_bf16_f32 v52, v8, v9
    v_cvt_pk_bf16_f32 v53, v10, v11
    v_exp_f32 v13, v13
    s_nop 0
    v_cvt_pk_bf16_f32 v60, v12, v13
    v_exp_f32 v14, v14
    v_exp_f32 v15, v15
    s_nop 0
    v_cvt_pk_bf16_f32 v61, v14, v15
    v_exp_f32 v16, v16
    s_nop 0
    v_add_f32 v236, v16, v236
    v_exp_f32 v17, v17
    s_nop 0
    v_add_f32 v236, v17, v236
    v_exp_f32 v18, v18
    v_cvt_pk_bf16_f32 v68, v16, v17
    v_exp_f32 v19, v19
    v_add_f32 v236, v18, v236
    v_exp_f32 v20, v20
    v_add_f32 v236, v19, v236
    v_exp_f32 v21, v21
    v_cvt_pk_bf16_f32 v69, v18, v19
    v_exp_f32 v22, v22
    v_exp_f32 v23, v23
    v_exp_f32 v28, v28
    v_exp_f32 v29, v29
    v_add_f32 v237, v20, v237
    v_add_f32 v237, v21, v237
    v_exp_f32 v30, v30
    v_cvt_pk_bf16_f32 v76, v20, v21
    v_add_f32 v237, v22, v237
    v_exp_f32 v31, v31
    v_add_f32 v237, v23, v237
    v_exp_f32 v32, v32
    v_cvt_pk_bf16_f32 v77, v22, v23
    v_exp_f32 v33, v33
    v_cvt_pk_bf16_f32 v54, v28, v29
    v_exp_f32 v34, v34
    v_cvt_pk_bf16_f32 v55, v30, v31
    v_exp_f32 v35, v35
    v_exp_f32 v36, v36
    v_cvt_pk_bf16_f32 v62, v32, v33
    v_cvt_pk_bf16_f32 v63, v34, v35
    v_exp_f32 v37, v37
    v_add_f32 v236, v36, v236
    v_add_f32 v236, v37, v236
    v_exp_f32 v38, v38
    v_cvt_pk_bf16_f32 v70, v36, v37
    v_add_f32 v236, v38, v236
    v_exp_f32 v39, v39
    s_waitcnt vmcnt(8)
    s_barrier
    ds_read_b128 v[152:155], v216 offset:0
    ds_read_b128 v[156:159], v217 offset:0
    ds_read_b128 v[160:163], v218 offset:0
    ds_read_b128 v[164:167], v219 offset:0
    s_waitcnt lgkmcnt(0)
    s_branch L_loop2
L_tail2:
    s_nop 7
    v_mfma_f32_16x16x32_bf16 v[244:247], v[240:243], v[88:91], v[244:247]
    ds_read_b64_tr_b16 v[152:153], v220 offset:49152
    ds_read_b64_tr_b16 v[154:155], v220 offset:53248
    v_mfma_f32_16x16x32_bf16 v[244:247], v[240:243], v[92:95], v[244:247]
    v_add_u32 v218, 1056, v4
    ds_read_b64_tr_b16 v[156:157], v220 offset:57344
    ds_read_b64_tr_b16 v[158:159], v220 offset:61440
    ds_read_b64_tr_b16 v[160:161], v221 offset:49152
    ds_read_b64_tr_b16 v[162:163], v221 offset:53248
    ds_read_b64_tr_b16 v[164:165], v221 offset:57344
    ds_read_b64_tr_b16 v[166:167], v221 offset:61440
    ds_read_b64_tr_b16 v[168:169], v222 offset:49152
    ds_read_b64_tr_b16 v[170:171], v222 offset:53248
    ds_read_b64_tr_b16 v[172:173], v222 offset:57344
    ds_read_b64_tr_b16 v[174:175], v222 offset:61440
    ds_read_b64_tr_b16 v[176:177], v223 offset:49152
    ds_read_b64_tr_b16 v[178:179], v223 offset:53248
    ds_read_b64_tr_b16 v[180:181], v223 offset:57344
    ds_read_b64_tr_b16 v[182:183], v223 offset:61440
    ds_read_b64_tr_b16 v[48:49], v224 offset:49152
    ds_read_b64_tr_b16 v[50:51], v224 offset:53248
    ds_read_b64_tr_b16 v[52:53], v224 offset:57344
    ds_read_b64_tr_b16 v[54:55], v224 offset:61440
    ds_read_b64_tr_b16 v[56:57], v225 offset:49152
    ds_read_b64_tr_b16 v[58:59], v225 offset:53248
    ds_read_b64_tr_b16 v[60:61], v225 offset:57344
    ds_read_b64_tr_b16 v[62:63], v225 offset:61440
    ds_read_b64_tr_b16 v[64:65], v226 offset:49152
    ds_read_b64_tr_b16 v[66:67], v226 offset:53248
    ds_read_b64_tr_b16 v[68:69], v226 offset:57344
    ds_read_b64_tr_b16 v[70:71], v226 offset:61440
    ds_read_b64_tr_b16 v[72:73], v227 offset:49152
    ds_read_b64_tr_b16 v[74:75], v227 offset:53248
    ds_read_b64_tr_b16 v[76:77], v227 offset:57344
    ds_read_b64_tr_b16 v[78:79], v227 offset:61440
    v_add_u32 v219, 1056, v2
    v_add_u32 v232, 8448, v2
    v_add_u32 v233, 9504, v2
    v_mov_b32 v8, v244
    v_mov_b32 v14, v8
    v_mfma_f32_16x16x32_bf16 v[248:251], v[240:243], v[96:99], v[248:251]
    s_nop 0
    v_permlane16_swap_b32 v8, v14
    s_waitcnt lgkmcnt(15)
    v_mfma_f32_16x16x32_bf16 a[0:3], v[88:91], v[152:155], a[0:3]
    v_add_f32 v8, v8, v14
    v_mov_b32 v14, v8
    v_mfma_f32_16x16x32_bf16 a[0:3], v[92:95], v[156:159], a[0:3]
    s_nop 0
    v_permlane32_swap_b32 v8, v14
    v_mfma_f32_16x16x32_bf16 a[4:7], v[88:91], v[160:163], a[4:7]
    v_add_f32 v8, v8, v14
    v_rcp_f32 v20, v8
    v_mfma_f32_16x16x32_bf16 a[4:7], v[92:95], v[164:167], a[4:7]
    s_waitcnt lgkmcnt(15)
    v_exp_f32 v40, v40
    v_mfma_f32_16x16x32_bf16 a[8:11], v[88:91], v[168:171], a[8:11]
    v_cvt_pk_bf16_f32 v110, v36, v37
    ds_write_b32 v254, v20 offset:0
    v_mfma_f32_16x16x32_bf16 a[8:11], v[92:95], v[172:175], a[8:11]
    ds_write2_b32 v4, a0, a1 offset0:0 offset1:132
    v_mfma_f32_16x16x32_bf16 a[12:15], v[88:91], v[176:179], a[12:15]
    s_waitcnt lgkmcnt(10)
    v_add_f32 v236, v38, v236
    v_mfma_f32_16x16x32_bf16 a[12:15], v[92:95], v[180:183], a[12:15]
    ds_write2_b32 v218, a2, a3 offset0:0 offset1:132
    v_mfma_f32_16x16x32_bf16 a[16:19], v[88:91], v[48:51], a[16:19]
    v_exp_f32 v41, v41
    v_mfma_f32_16x16x32_bf16 a[16:19], v[92:95], v[52:55], a[16:19]
    ds_write2_b32 v4, a4, a5 offset0:16 offset1:148
    v_mfma_f32_16x16x32_bf16 a[20:23], v[88:91], v[56:59], a[20:23]
    s_waitcnt lgkmcnt(4)
    v_add_f32 v236, v39, v236
    v_mfma_f32_16x16x32_bf16 a[20:23], v[92:95], v[60:63], a[20:23]
    ds_write2_b32 v218, a6, a7 offset0:16 offset1:148
    v_mfma_f32_16x16x32_bf16 a[24:27], v[88:91], v[64:67], a[24:27]
    v_cvt_pk_bf16_f32 v111, v38, v39
    v_add_f32 v237, v40, v237
    v_mfma_f32_16x16x32_bf16 a[24:27], v[92:95], v[68:71], a[24:27]
    ds_write2_b32 v4, a8, a9 offset0:32 offset1:164
    v_mfma_f32_16x16x32_bf16 a[28:31], v[88:91], v[72:75], a[28:31]
    v_exp_f32 v42, v42
    v_mfma_f32_16x16x32_bf16 a[28:31], v[92:95], v[76:79], a[28:31]
    ds_write2_b32 v218, a10, a11 offset0:32 offset1:164
    ds_write2_b32 v4, a12, a13 offset0:48 offset1:180
    ds_write2_b32 v218, a14, a15 offset0:48 offset1:180
    ds_write2_b32 v4, a16, a17 offset0:64 offset1:196
    ds_write2_b32 v218, a18, a19 offset0:64 offset1:196
    ds_write2_b32 v4, a20, a21 offset0:80 offset1:212
    ds_write2_b32 v218, a22, a23 offset0:80 offset1:212
    ds_write2_b32 v4, a24, a25 offset0:96 offset1:228
    ds_write2_b32 v218, a26, a27 offset0:96 offset1:228
    ds_write2_b32 v4, a28, a29 offset0:112 offset1:244
    ds_write2_b32 v218, a30, a31 offset0:112 offset1:244
    ds_read_b32 v28, v255 offset:0
    ds_read_b128 v[184:187], v5 offset:0
    ds_read_b128 v[188:191], v5 offset:16
    ds_read_b32 v29, v255 offset:16
    ds_read_b128 v[192:195], v5 offset:2112
    ds_read_b128 v[196:199], v5 offset:2128
    ds_read_b32 v30, v255 offset:32
    ds_read_b128 v[200:203], v5 offset:4224
    ds_read_b128 v[204:207], v5 offset:4240
    ds_read_b32 v31, v255 offset:48
    ds_read_b128 v[208:211], v5 offset:6336
    ds_read_b128 v[212:215], v5 offset:6352
    v_mfma_f32_16x16x32_bf16 v[248:251], v[240:243], v[100:103], v[248:251]
    v_add_f32 v237, v41, v237
    v_exp_f32 v43, v43
    v_mfma_f32_16x16x32_bf16 a[32:35], v[96:99], v[152:155], a[32:35]
    v_cvt_pk_bf16_f32 v118, v40, v41
    v_add_f32 v237, v42, v237
    v_mfma_f32_16x16x32_bf16 a[32:35], v[100:103], v[156:159], a[32:35]
    v_exp_f32 v44, v44
    v_mfma_f32_16x16x32_bf16 a[36:39], v[96:99], v[160:163], a[36:39]
    v_exp_f32 v45, v45
    v_mfma_f32_16x16x32_bf16 a[36:39], v[100:103], v[164:167], a[36:39]
    v_exp_f32 v46, v46
    v_mfma_f32_16x16x32_bf16 a[40:43], v[96:99], v[168:171], a[40:43]
    v_add_f32 v237, v43, v237
    v_cvt_pk_bf16_f32 v119, v42, v43
    v_mfma_f32_16x16x32_bf16 a[40:43], v[100:103], v[172:175], a[40:43]
    v_exp_f32 v47, v47
    v_mfma_f32_16x16x32_bf16 a[44:47], v[96:99], v[176:179], a[44:47]
    v_add_f32 v238, v44, v238
    v_add_f32 v238, v45, v238
    v_mfma_f32_16x16x32_bf16 a[44:47], v[100:103], v[180:183], a[44:47]
    v_cvt_pk_bf16_f32 v126, v44, v45
    v_add_f32 v238, v46, v238
    v_mfma_f32_16x16x32_bf16 a[48:51], v[96:99], v[48:51], a[48:51]
    v_add_f32 v238, v47, v238
    v_cvt_pk_bf16_f32 v127, v46, v47
    v_mfma_f32_16x16x32_bf16 a[48:51], v[100:103], v[52:55], a[48:51]
    v_mov_b32 v216, 0
    v_mov_b32 v9, v248
    v_mfma_f32_16x16x32_bf16 a[52:55], v[96:99], v[56:59], a[52:55]
    v_mov_b32 v10, v236
    v_mov_b32 v11, v237
    v_mfma_f32_16x16x32_bf16 a[52:55], v[100:103], v[60:63], a[52:55]
    v_mov_b32 v12, v238
    v_mov_b32 v13, v239
    v_mfma_f32_16x16x32_bf16 a[56:59], v[96:99], v[64:67], a[56:59]
    v_mov_b32 v15, v9
    v_mov_b32 v16, v10
    v_mfma_f32_16x16x32_bf16 a[56:59], v[100:103], v[68:71], a[56:59]
    v_mov_b32 v17, v11
    v_mov_b32 v18, v12
    v_mfma_f32_16x16x32_bf16 a[60:63], v[96:99], v[72:75], a[60:63]
    v_mov_b32 v19, v13
    ds_write2_b32 v232, a160, a161 offset0:0 offset1:132
    s_waitcnt lgkmcnt(7)
    v_pk_mul_f32 v[184:185], v[184:185], v[28:29] op_sel_hi:[1,0]
    v_pk_mul_f32 v[186:187], v[186:187], v[28:29] op_sel_hi:[1,0]
    v_pk_mul_f32 v[188:189], v[188:189], v[28:29] op_sel_hi:[1,0]
    v_pk_mul_f32 v[190:191], v[190:191], v[28:29] op_sel_hi:[1,0]
    v_cvt_pk_bf16_f32 v184, v184, v185
    v_cvt_pk_bf16_f32 v185, v186, v187
    v_cvt_pk_bf16_f32 v186, v188, v189
    v_cvt_pk_bf16_f32 v187, v190, v191
    buffer_store_dwordx4 v[184:187], v1, s[20:23], s4 offen offset:0 sc0 sc1
    v_pk_maximum3_f16 v216, v184, v185, v216
    v_pk_maximum3_f16 v216, v186, v187, v216
    v_pk_mul_f32 v[192:193], v[192:193], v[28:29] op_sel:[0,1] op_sel_hi:[1,1]
    v_pk_mul_f32 v[194:195], v[194:195], v[28:29] op_sel:[0,1] op_sel_hi:[1,1]
    s_waitcnt lgkmcnt(1)
    v_pk_mul_f32 v[196:197], v[196:197], v[28:29] op_sel:[0,1] op_sel_hi:[1,1]
    v_pk_mul_f32 v[198:199], v[198:199], v[28:29] op_sel:[0,1] op_sel_hi:[1,1]
    v_cvt_pk_bf16_f32 v192, v192, v193
    v_cvt_pk_bf16_f32 v193, v194, v195
    v_cvt_pk_bf16_f32 v194, v196, v197
    v_cvt_pk_bf16_f32 v195, v198, v199
    v_pk_maximum3_f16 v216, v192, v193, v216
    v_pk_maximum3_f16 v216, v194, v195, v216
    v_pk_mul_f32 v[200:201], v[200:201], v[30:31] op_sel_hi:[1,0]
    v_pk_mul_f32 v[202:203], v[202:203], v[30:31] op_sel_hi:[1,0]
    v_pk_mul_f32 v[204:205], v[204:205], v[30:31] op_sel_hi:[1,0]
    v_pk_mul_f32 v[206:207], v[206:207], v[30:31] op_sel_hi:[1,0]
    buffer_store_dwordx4 v[192:195], v1, s[20:23], s4 offen offset:1024 sc0 sc1
    v_cvt_pk_bf16_f32 v200, v200, v201
    v_cvt_pk_bf16_f32 v201, v202, v203
    v_cvt_pk_bf16_f32 v202, v204, v205
    v_cvt_pk_bf16_f32 v203, v206, v207
    v_pk_maximum3_f16 v216, v200, v201, v216
    v_pk_maximum3_f16 v216, v202, v203, v216
    v_pk_mul_f32 v[208:209], v[208:209], v[30:31] op_sel:[0,1] op_sel_hi:[1,1]
    v_pk_mul_f32 v[210:211], v[210:211], v[30:31] op_sel:[0,1] op_sel_hi:[1,1]
    v_pk_mul_f32 v[212:213], v[212:213], v[30:31] op_sel:[0,1] op_sel_hi:[1,1]
    v_pk_mul_f32 v[214:215], v[214:215], v[30:31] op_sel:[0,1] op_sel_hi:[1,1]
    v_cvt_pk_bf16_f32 v208, v208, v209
    v_cvt_pk_bf16_f32 v209, v210, v211
    v_cvt_pk_bf16_f32 v210, v212, v213
    v_cvt_pk_bf16_f32 v211, v214, v215
    v_pk_maximum3_f16 v216, v208, v209, v216
    v_pk_maximum3_f16 v216, v210, v211, v216
    v_mfma_f32_16x16x32_bf16 a[60:63], v[100:103], v[76:79], a[60:63]
    buffer_store_dwordx4 v[200:203], v1, s[20:23], s4 offen offset:2048 sc0 sc1
    v_mfma_f32_16x16x32_bf16 a[128:131], v[120:123], v[152:155], a[128:131]
    ds_write2_b32 v233, a162, a163 offset0:0 offset1:132
    v_mfma_f32_16x16x32_bf16 a[128:131], v[124:127], v[156:159], a[128:131]
    v_permlane16_swap_b32 v9, v15
    v_mfma_f32_16x16x32_bf16 a[132:135], v[120:123], v[160:163], a[132:135]
    ds_write2_b32 v232, a164, a165 offset0:16 offset1:148
    v_mfma_f32_16x16x32_bf16 a[132:135], v[124:127], v[164:167], a[132:135]
    v_permlane16_swap_b32 v10, v16
    buffer_store_dwordx4 v[208:211], v1, s[20:23], s4 offen offset:3072 sc0 sc1
    v_mfma_f32_16x16x32_bf16 a[136:139], v[120:123], v[168:171], a[136:139]
    ds_write2_b32 v233, a166, a167 offset0:16 offset1:148
    v_mfma_f32_16x16x32_bf16 a[136:139], v[124:127], v[172:175], a[136:139]
    v_permlane16_swap_b32 v11, v17
    v_mfma_f32_16x16x32_bf16 a[140:143], v[120:123], v[176:179], a[140:143]
    ds_write2_b32 v232, a168, a169 offset0:32 offset1:164
    v_mfma_f32_16x16x32_bf16 a[140:143], v[124:127], v[180:183], a[140:143]
    v_permlane16_swap_b32 v12, v18
    v_mfma_f32_16x16x32_bf16 a[144:147], v[120:123], v[48:51], a[144:147]
    ds_write2_b32 v233, a170, a171 offset0:32 offset1:164
    v_mfma_f32_16x16x32_bf16 a[144:147], v[124:127], v[52:55], a[144:147]
    v_permlane16_swap_b32 v13, v19
    v_mfma_f32_16x16x32_bf16 a[148:151], v[120:123], v[56:59], a[148:151]
    ds_write2_b32 v232, a172, a173 offset0:48 offset1:180
    v_mfma_f32_16x16x32_bf16 a[148:151], v[124:127], v[60:63], a[148:151]
    v_add_f32 v9, v9, v15
    v_add_f32 v10, v10, v16
    v_mfma_f32_16x16x32_bf16 a[152:155], v[120:123], v[64:67], a[152:155]
    ds_write2_b32 v233, a174, a175 offset0:48 offset1:180
    v_mfma_f32_16x16x32_bf16 a[152:155], v[124:127], v[68:71], a[152:155]
    v_add_f32 v11, v11, v17
    v_add_f32 v12, v12, v18
    v_mfma_f32_16x16x32_bf16 a[156:159], v[120:123], v[72:75], a[156:159]
    ds_write2_b32 v232, a176, a177 offset0:64 offset1:196
    v_mfma_f32_16x16x32_bf16 a[156:159], v[124:127], v[76:79], a[156:159]
    v_add_f32 v13, v13, v19
    v_mov_b32 v15, v9
    v_mfma_f32_16x16x32_bf16 a[64:67], v[104:107], v[152:155], a[64:67]
    ds_write2_b32 v233, a178, a179 offset0:64 offset1:196
    v_mfma_f32_16x16x32_bf16 a[64:67], v[108:111], v[156:159], a[64:67]
    v_mov_b32 v16, v10
    v_mov_b32 v17, v11
    v_mfma_f32_16x16x32_bf16 a[68:71], v[104:107], v[160:163], a[68:71]
    ds_write2_b32 v232, a180, a181 offset0:80 offset1:212
    v_mfma_f32_16x16x32_bf16 a[68:71], v[108:111], v[164:167], a[68:71]
    v_mov_b32 v18, v12
    v_mov_b32 v19, v13
    v_mfma_f32_16x16x32_bf16 a[72:75], v[104:107], v[168:171], a[72:75]
    ds_write2_b32 v233, a182, a183 offset0:80 offset1:212
    v_mfma_f32_16x16x32_bf16 a[72:75], v[108:111], v[172:175], a[72:75]
    v_permlane32_swap_b32 v9, v15
    v_mfma_f32_16x16x32_bf16 a[76:79], v[104:107], v[176:179], a[76:79]
    ds_write2_b32 v232, a184, a185 offset0:96 offset1:228
    v_mfma_f32_16x16x32_bf16 a[76:79], v[108:111], v[180:183], a[76:79]
    v_permlane32_swap_b32 v10, v16
    v_mfma_f32_16x16x32_bf16 a[80:83], v[104:107], v[48:51], a[80:83]
    ds_write2_b32 v233, a186, a187 offset0:96 offset1:228
    v_mfma_f32_16x16x32_bf16 a[80:83], v[108:111], v[52:55], a[80:83]
    v_permlane32_swap_b32 v11, v17
    v_mfma_f32_16x16x32_bf16 a[84:87], v[104:107], v[56:59], a[84:87]
    ds_write2_b32 v232, a188, a189 offset0:112 offset1:244
    v_mfma_f32_16x16x32_bf16 a[84:87], v[108:111], v[60:63], a[84:87]
    v_permlane32_swap_b32 v12, v18
    v_mfma_f32_16x16x32_bf16 a[88:91], v[104:107], v[64:67], a[88:91]
    ds_write2_b32 v233, a190, a191 offset0:112 offset1:244
    v_mfma_f32_16x16x32_bf16 a[88:91], v[108:111], v[68:71], a[88:91]
    v_permlane32_swap_b32 v13, v19
    v_mfma_f32_16x16x32_bf16 a[92:95], v[104:107], v[72:75], a[92:95]
    v_add_f32 v9, v9, v15
    v_add_f32 v10, v10, v16
    v_mfma_f32_16x16x32_bf16 a[92:95], v[108:111], v[76:79], a[92:95]
    v_add_f32 v11, v11, v17
    v_add_f32 v12, v12, v18
    v_mfma_f32_16x16x32_bf16 a[96:99], v[112:115], v[152:155], a[96:99]
    v_add_f32 v13, v13, v19
    v_rcp_f32 v21, v9
    v_mfma_f32_16x16x32_bf16 a[96:99], v[116:119], v[156:159], a[96:99]
    ds_write_b32 v254, v21 offset:64
    ds_write2_b32 v4, a32, a33 offset0:0 offset1:132
    v_mfma_f32_16x16x32_bf16 a[100:103], v[112:115], v[160:163], a[100:103]
    v_rcp_f32 v22, v10
    v_mfma_f32_16x16x32_bf16 a[100:103], v[116:119], v[164:167], a[100:103]
    ds_write2_b32 v218, a34, a35 offset0:0 offset1:132
    v_mfma_f32_16x16x32_bf16 a[104:107], v[112:115], v[168:171], a[104:107]
    v_rcp_f32 v23, v11
    v_mfma_f32_16x16x32_bf16 a[104:107], v[116:119], v[172:175], a[104:107]
    ds_write2_b32 v4, a36, a37 offset0:16 offset1:148
    v_mfma_f32_16x16x32_bf16 a[108:111], v[112:115], v[176:179], a[108:111]
    v_mfma_f32_16x16x32_bf16 a[108:111], v[116:119], v[180:183], a[108:111]
    ds_write2_b32 v218, a38, a39 offset0:16 offset1:148
    v_mfma_f32_16x16x32_bf16 a[112:115], v[112:115], v[48:51], a[112:115]
    v_mfma_f32_16x16x32_bf16 a[112:115], v[116:119], v[52:55], a[112:115]
    ds_write2_b32 v4, a40, a41 offset0:32 offset1:164
    v_mfma_f32_16x16x32_bf16 a[116:119], v[112:115], v[56:59], a[116:119]
    v_mfma_f32_16x16x32_bf16 a[116:119], v[116:119], v[60:63], a[116:119]
    ds_write2_b32 v218, a42, a43 offset0:32 offset1:164
    v_mfma_f32_16x16x32_bf16 a[120:123], v[112:115], v[64:67], a[120:123]
    v_mfma_f32_16x16x32_bf16 a[120:123], v[116:119], v[68:71], a[120:123]
    ds_write2_b32 v4, a44, a45 offset0:48 offset1:180
    v_mfma_f32_16x16x32_bf16 a[124:127], v[112:115], v[72:75], a[124:127]
    v_mfma_f32_16x16x32_bf16 a[124:127], v[116:119], v[76:79], a[124:127]
    ds_write2_b32 v218, a46, a47 offset0:48 offset1:180
    ds_write2_b32 v4, a48, a49 offset0:64 offset1:196
    ds_write2_b32 v218, a50, a51 offset0:64 offset1:196
    ds_write2_b32 v4, a52, a53 offset0:80 offset1:212
    ds_write2_b32 v218, a54, a55 offset0:80 offset1:212
    ds_write2_b32 v4, a56, a57 offset0:96 offset1:228
    ds_write2_b32 v218, a58, a59 offset0:96 offset1:228
    ds_write2_b32 v4, a60, a61 offset0:112 offset1:244
    ds_write2_b32 v218, a62, a63 offset0:112 offset1:244
    ds_read_b32 v32, v255 offset:64
    ds_read_b128 v[120:123], v5 offset:0
    ds_read_b128 v[124:127], v5 offset:16
    ds_read_b32 v33, v255 offset:80
    ds_read_b128 v[128:131], v5 offset:2112
    ds_read_b128 v[132:135], v5 offset:2128
    ds_read_b32 v34, v255 offset:96
    ds_read_b128 v[136:139], v5 offset:4224
    ds_read_b128 v[140:143], v5 offset:4240
    ds_read_b32 v35, v255 offset:112
    ds_read_b128 v[144:147], v5 offset:6336
    ds_read_b128 v[148:151], v5 offset:6352
    ds_write2_b32 v2, a128, a129 offset0:0 offset1:132
    ds_write2_b32 v219, a130, a131 offset0:0 offset1:132
    ds_write2_b32 v2, a132, a133 offset0:16 offset1:148
    ds_write2_b32 v219, a134, a135 offset0:16 offset1:148
    ds_write2_b32 v2, a136, a137 offset0:32 offset1:164
    ds_write2_b32 v219, a138, a139 offset0:32 offset1:164
    ds_write2_b32 v2, a140, a141 offset0:48 offset1:180
    ds_write2_b32 v219, a142, a143 offset0:48 offset1:180
    ds_write2_b32 v2, a144, a145 offset0:64 offset1:196
    ds_write2_b32 v219, a146, a147 offset0:64 offset1:196
    ds_write2_b32 v2, a148, a149 offset0:80 offset1:212
    ds_write2_b32 v219, a150, a151 offset0:80 offset1:212
    ds_write2_b32 v2, a152, a153 offset0:96 offset1:228
    ds_write2_b32 v219, a154, a155 offset0:96 offset1:228
    ds_write2_b32 v2, a156, a157 offset0:112 offset1:244
    s_waitcnt lgkmcnt(15)
    v_mul_f32 v120, v120, v32
    v_mul_f32 v121, v121, v32
    v_mul_f32 v122, v122, v32
    v_mul_f32 v123, v123, v32
    v_mul_f32 v124, v124, v32
    v_mul_f32 v125, v125, v32
    v_mul_f32 v126, v126, v32
    v_mul_f32 v127, v127, v32
    v_cvt_pk_bf16_f32 v120, v120, v121
    v_cvt_pk_bf16_f32 v121, v122, v123
    v_cvt_pk_bf16_f32 v122, v124, v125
    v_cvt_pk_bf16_f32 v123, v126, v127
    buffer_store_dwordx4 v[120:123], v1, s[20:23], s5 offen offset:0 sc0 sc1
    s_waitcnt lgkmcnt(15)
    v_pk_maximum3_f16 v216, v120, v121, v216
    v_pk_maximum3_f16 v216, v122, v123, v216
    v_mul_f32 v128, v128, v33
    v_mul_f32 v129, v129, v33
    v_mul_f32 v130, v130, v33
    v_mul_f32 v131, v131, v33
    v_mul_f32 v132, v132, v33
    v_mul_f32 v133, v133, v33
    v_mul_f32 v134, v134, v33
    v_mul_f32 v135, v135, v33
    v_cvt_pk_bf16_f32 v128, v128, v129
    v_cvt_pk_bf16_f32 v129, v130, v131
    v_cvt_pk_bf16_f32 v130, v132, v133
    v_cvt_pk_bf16_f32 v131, v134, v135
    v_pk_maximum3_f16 v216, v128, v129, v216
    v_pk_maximum3_f16 v216, v130, v131, v216
    buffer_store_dwordx4 v[128:131], v1, s[20:23], s5 offen offset:1024 sc0 sc1
    v_mul_f32 v136, v136, v34
    v_mul_f32 v137, v137, v34
    v_mul_f32 v138, v138, v34
    v_mul_f32 v139, v139, v34
    v_mul_f32 v140, v140, v34
    v_mul_f32 v141, v141, v34
    v_mul_f32 v142, v142, v34
    v_mul_f32 v143, v143, v34
    v_cvt_pk_bf16_f32 v136, v136, v137
    v_cvt_pk_bf16_f32 v137, v138, v139
    v_cvt_pk_bf16_f32 v138, v140, v141
    v_cvt_pk_bf16_f32 v139, v142, v143
    v_pk_maximum3_f16 v216, v136, v137, v216
    v_pk_maximum3_f16 v216, v138, v139, v216
    v_mul_f32 v144, v144, v35
    v_mul_f32 v145, v145, v35
    v_mul_f32 v146, v146, v35
    buffer_store_dwordx4 v[136:139], v1, s[20:23], s5 offen offset:2048 sc0 sc1
    v_mul_f32 v147, v147, v35
    v_mul_f32 v148, v148, v35
    v_mul_f32 v149, v149, v35
    v_mul_f32 v150, v150, v35
    v_mul_f32 v151, v151, v35
    v_cvt_pk_bf16_f32 v144, v144, v145
    v_cvt_pk_bf16_f32 v145, v146, v147
    v_cvt_pk_bf16_f32 v146, v148, v149
    v_cvt_pk_bf16_f32 v147, v150, v151
    v_pk_maximum3_f16 v216, v144, v145, v216
    v_pk_maximum3_f16 v216, v146, v147, v216
    ds_write2_b32 v219, a158, a159 offset0:112 offset1:244
    buffer_store_dwordx4 v[144:147], v1, s[20:23], s5 offen offset:3072 sc0 sc1
    ds_write_b32 v3, v12 offset:0
    ds_write_b32 v3, v13 offset:256
    ds_write_b32 v254, v22 offset:128
    ds_write2_b32 v4, a64, a65 offset0:0 offset1:132
    ds_write2_b32 v218, a66, a67 offset0:0 offset1:132
    ds_write2_b32 v4, a68, a69 offset0:16 offset1:148
    ds_write2_b32 v218, a70, a71 offset0:16 offset1:148
    ds_write2_b32 v4, a72, a73 offset0:32 offset1:164
    ds_write2_b32 v218, a74, a75 offset0:32 offset1:164
    ds_write2_b32 v4, a76, a77 offset0:48 offset1:180
    ds_write2_b32 v218, a78, a79 offset0:48 offset1:180
    ds_write2_b32 v4, a80, a81 offset0:64 offset1:196
    ds_write2_b32 v218, a82, a83 offset0:64 offset1:196
    ds_write2_b32 v4, a84, a85 offset0:80 offset1:212
    ds_write2_b32 v218, a86, a87 offset0:80 offset1:212
    ds_write2_b32 v4, a88, a89 offset0:96 offset1:228
    ds_write2_b32 v218, a90, a91 offset0:96 offset1:228
    ds_write2_b32 v4, a92, a93 offset0:112 offset1:244
    ds_write2_b32 v218, a94, a95 offset0:112 offset1:244
    ds_read_b32 v36, v255 offset:128
    ds_read_b128 v[184:187], v5 offset:0
    ds_read_b128 v[188:191], v5 offset:16
    ds_read_b32 v37, v255 offset:144
    ds_read_b128 v[192:195], v5 offset:2112
    ds_read_b128 v[196:199], v5 offset:2128
    ds_read_b32 v38, v255 offset:160
    ds_read_b128 v[200:203], v5 offset:4224
    ds_read_b128 v[204:207], v5 offset:4240
    ds_read_b32 v39, v255 offset:176
    ds_read_b128 v[208:211], v5 offset:6336
    ds_read_b128 v[212:215], v5 offset:6352
    ds_write_b32 v254, v23 offset:192
    ds_write2_b32 v4, a96, a97 offset0:0 offset1:132
    ds_write2_b32 v218, a98, a99 offset0:0 offset1:132
    ds_write2_b32 v4, a100, a101 offset0:16 offset1:148
    ds_write2_b32 v218, a102, a103 offset0:16 offset1:148
    ds_write2_b32 v4, a104, a105 offset0:32 offset1:164
    ds_write2_b32 v218, a106, a107 offset0:32 offset1:164
    ds_write2_b32 v4, a108, a109 offset0:48 offset1:180
    ds_write2_b32 v218, a110, a111 offset0:48 offset1:180
    ds_write2_b32 v4, a112, a113 offset0:64 offset1:196
    ds_write2_b32 v218, a114, a115 offset0:64 offset1:196
    ds_write2_b32 v4, a116, a117 offset0:80 offset1:212
    ds_write2_b32 v218, a118, a119 offset0:80 offset1:212
    ds_write2_b32 v4, a120, a121 offset0:96 offset1:228
    ds_write2_b32 v218, a122, a123 offset0:96 offset1:228
    s_waitcnt lgkmcnt(15)
    v_pk_mul_f32 v[184:185], v[184:185], v[36:37] op_sel_hi:[1,0]
    v_pk_mul_f32 v[186:187], v[186:187], v[36:37] op_sel_hi:[1,0]
    v_pk_mul_f32 v[188:189], v[188:189], v[36:37] op_sel_hi:[1,0]
    v_pk_mul_f32 v[190:191], v[190:191], v[36:37] op_sel_hi:[1,0]
    v_cvt_pk_bf16_f32 v184, v184, v185
    v_cvt_pk_bf16_f32 v185, v186, v187
    v_cvt_pk_bf16_f32 v186, v188, v189
    v_cvt_pk_bf16_f32 v187, v190, v191
    buffer_store_dwordx4 v[184:187], v1, s[20:23], s6 offen offset:0 sc0 sc1
    v_pk_maximum3_f16 v216, v184, v185, v216
    v_pk_maximum3_f16 v216, v186, v187, v216
    v_pk_mul_f32 v[192:193], v[192:193], v[36:37] op_sel:[0,1] op_sel_hi:[1,1]
    v_pk_mul_f32 v[194:195], v[194:195], v[36:37] op_sel:[0,1] op_sel_hi:[1,1]
    s_waitcnt lgkmcnt(15)
    v_pk_mul_f32 v[196:197], v[196:197], v[36:37] op_sel:[0,1] op_sel_hi:[1,1]
    v_pk_mul_f32 v[198:199], v[198:199], v[36:37] op_sel:[0,1] op_sel_hi:[1,1]
    v_cvt_pk_bf16_f32 v192, v192, v193
    v_cvt_pk_bf16_f32 v193, v194, v195
    v_cvt_pk_bf16_f32 v194, v196, v197
    v_cvt_pk_bf16_f32 v195, v198, v199
    v_pk_maximum3_f16 v216, v192, v193, v216
    v_pk_maximum3_f16 v216, v194, v195, v216
    v_pk_mul_f32 v[200:201], v[200:201], v[38:39] op_sel_hi:[1,0]
    v_pk_mul_f32 v[202:203], v[202:203], v[38:39] op_sel_hi:[1,0]
    v_pk_mul_f32 v[204:205], v[204:205], v[38:39] op_sel_hi:[1,0]
    v_pk_mul_f32 v[206:207], v[206:207], v[38:39] op_sel_hi:[1,0]
    buffer_store_dwordx4 v[192:195], v1, s[20:23], s6 offen offset:1024 sc0 sc1
    v_cvt_pk_bf16_f32 v200, v200, v201
    v_cvt_pk_bf16_f32 v201, v202, v203
    v_cvt_pk_bf16_f32 v202, v204, v205
    v_cvt_pk_bf16_f32 v203, v206, v207
    v_pk_maximum3_f16 v216, v200, v201, v216
    v_pk_maximum3_f16 v216, v202, v203, v216
    v_pk_mul_f32 v[208:209], v[208:209], v[38:39] op_sel:[0,1] op_sel_hi:[1,1]
    v_pk_mul_f32 v[210:211], v[210:211], v[38:39] op_sel:[0,1] op_sel_hi:[1,1]
    v_pk_mul_f32 v[212:213], v[212:213], v[38:39] op_sel:[0,1] op_sel_hi:[1,1]
    v_pk_mul_f32 v[214:215], v[214:215], v[38:39] op_sel:[0,1] op_sel_hi:[1,1]
    v_cvt_pk_bf16_f32 v208, v208, v209
    v_cvt_pk_bf16_f32 v209, v210, v211
    v_cvt_pk_bf16_f32 v210, v212, v213
    v_cvt_pk_bf16_f32 v211, v214, v215
    v_pk_maximum3_f16 v216, v208, v209, v216
    v_pk_maximum3_f16 v216, v210, v211, v216
    buffer_store_dwordx4 v[200:203], v1, s[20:23], s6 offen offset:2048 sc0 sc1
    ds_write2_b32 v4, a124, a125 offset0:112 offset1:244
    buffer_store_dwordx4 v[208:211], v1, s[20:23], s6 offen offset:3072 sc0 sc1
    ds_write2_b32 v218, a126, a127 offset0:112 offset1:244
    ds_read_b32 v40, v255 offset:192
    ds_read_b128 v[120:123], v5 offset:0
    ds_read_b128 v[124:127], v5 offset:16
    ds_read_b32 v41, v255 offset:208
    ds_read_b128 v[128:131], v5 offset:2112
    ds_read_b128 v[132:135], v5 offset:2128
    ds_read_b32 v42, v255 offset:224
    ds_read_b128 v[136:139], v5 offset:4224
    ds_read_b128 v[140:143], v5 offset:4240
    ds_read_b32 v43, v255 offset:240
    ds_read_b128 v[144:147], v5 offset:6336
    ds_read_b128 v[148:151], v5 offset:6352
    s_waitcnt lgkmcnt(6)
    v_pk_mul_f32 v[120:121], v[120:121], v[40:41] op_sel_hi:[1,0]
    v_pk_mul_f32 v[122:123], v[122:123], v[40:41] op_sel_hi:[1,0]
    v_pk_mul_f32 v[124:125], v[124:125], v[40:41] op_sel_hi:[1,0]
    v_pk_mul_f32 v[126:127], v[126:127], v[40:41] op_sel_hi:[1,0]
    v_cvt_pk_bf16_f32 v120, v120, v121
    v_cvt_pk_bf16_f32 v121, v122, v123
    v_cvt_pk_bf16_f32 v122, v124, v125
    v_cvt_pk_bf16_f32 v123, v126, v127
    buffer_store_dwordx4 v[120:123], v1, s[20:23], s7 offen offset:0 sc0 sc1
    v_pk_maximum3_f16 v216, v120, v121, v216
    v_pk_maximum3_f16 v216, v122, v123, v216
    v_pk_mul_f32 v[128:129], v[128:129], v[40:41] op_sel:[0,1] op_sel_hi:[1,1]
    v_pk_mul_f32 v[130:131], v[130:131], v[40:41] op_sel:[0,1] op_sel_hi:[1,1]
    s_waitcnt lgkmcnt(0)
    s_barrier
    ds_read_b128 v[152:155], v6 offset:0
    ds_read_b128 v[156:159], v6 offset:16
    ds_read_b32 v14, v7 offset:0
    ds_read_b128 v[160:163], v6 offset:33792
    ds_read_b128 v[164:167], v6 offset:33808
    ds_read_b32 v15, v7 offset:1024
    ds_read_b128 v[168:171], v6 offset:2112
    ds_read_b128 v[172:175], v6 offset:2128
    ds_read_b32 v16, v7 offset:16
    ds_read_b128 v[176:179], v6 offset:35904
    ds_read_b128 v[180:183], v6 offset:35920
    ds_read_b32 v17, v7 offset:1040
    ds_read_b128 v[48:51], v252 offset:0
    ds_read_b128 v[52:55], v252 offset:16
    ds_read_b32 v24, v253 offset:0
    ds_read_b128 v[56:59], v252 offset:16896
    ds_read_b128 v[60:63], v252 offset:16912
    ds_read_b32 v25, v253 offset:512
    ds_read_b128 v[64:67], v252 offset:33792
    ds_read_b128 v[68:71], v252 offset:33808
    ds_read_b32 v26, v253 offset:1024
    ds_read_b128 v[72:75], v252 offset:50688
    ds_read_b128 v[76:79], v252 offset:50704
    ds_read_b32 v27, v253 offset:1536
    v_pk_mul_f32 v[132:133], v[132:133], v[40:41] op_sel:[0,1] op_sel_hi:[1,1]
    v_pk_mul_f32 v[134:135], v[134:135], v[40:41] op_sel:[0,1] op_sel_hi:[1,1]
    v_cvt_pk_bf16_f32 v128, v128, v129
    v_cvt_pk_bf16_f32 v129, v130, v131
    v_cvt_pk_bf16_f32 v130, v132, v133
    v_cvt_pk_bf16_f32 v131, v134, v135
    buffer_store_dwordx4 v[128:131], v1, s[20:23], s7 offen offset:1024 sc0 sc1
    v_pk_maximum3_f16 v216, v128, v129, v216
    v_pk_maximum3_f16 v216, v130, v131, v216
    v_pk_mul_f32 v[136:137], v[136:137], v[42:43] op_sel_hi:[1,0]
    v_pk_mul_f32 v[138:139], v[138:139], v[42:43] op_sel_hi:[1,0]
    v_pk_mul_f32 v[140:141], v[140:141], v[42:43] op_sel_hi:[1,0]
    v_pk_mul_f32 v[142:143], v[142:143], v[42:43] op_sel_hi:[1,0]
    v_cvt_pk_bf16_f32 v136, v136, v137
    v_cvt_pk_bf16_f32 v137, v138, v139
    v_cvt_pk_bf16_f32 v138, v140, v141
    v_cvt_pk_bf16_f32 v139, v142, v143
    v_pk_maximum3_f16 v216, v136, v137, v216
    v_pk_maximum3_f16 v216, v138, v139, v216
    v_pk_mul_f32 v[144:145], v[144:145], v[42:43] op_sel:[0,1] op_sel_hi:[1,1]
    v_pk_mul_f32 v[146:147], v[146:147], v[42:43] op_sel:[0,1] op_sel_hi:[1,1]
    v_pk_mul_f32 v[148:149], v[148:149], v[42:43] op_sel:[0,1] op_sel_hi:[1,1]
    v_pk_mul_f32 v[150:151], v[150:151], v[42:43] op_sel:[0,1] op_sel_hi:[1,1]
    v_cvt_pk_bf16_f32 v144, v144, v145
    buffer_store_dwordx4 v[136:139], v1, s[20:23], s7 offen offset:2048 sc0 sc1
    v_cvt_pk_bf16_f32 v145, v146, v147
    v_cvt_pk_bf16_f32 v146, v148, v149
    v_cvt_pk_bf16_f32 v147, v150, v151
    v_pk_maximum3_f16 v216, v144, v145, v216
    s_waitcnt lgkmcnt(12)
    v_pk_maximum3_f16 v216, v146, v147, v216
    v_add_f32 v14, v14, v15
    v_rcp_f32 v80, v14
    v_pk_add_f32 v[152:153], v[152:153], v[160:161]
    v_pk_add_f32 v[154:155], v[154:155], v[162:163]
    v_pk_add_f32 v[156:157], v[156:157], v[164:165]
    v_pk_add_f32 v[158:159], v[158:159], v[166:167]
    v_pk_mul_f32 v[152:153], v[152:153], v[80:81] op_sel_hi:[1,0]
    v_pk_mul_f32 v[154:155], v[154:155], v[80:81] op_sel_hi:[1,0]
    v_pk_mul_f32 v[156:157], v[156:157], v[80:81] op_sel_hi:[1,0]
    v_pk_mul_f32 v[158:159], v[158:159], v[80:81] op_sel_hi:[1,0]
    buffer_store_dwordx4 v[144:147], v1, s[20:23], s7 offen offset:3072 sc0 sc1
    v_cvt_pk_bf16_f32 v160, v152, v153
    v_cvt_pk_bf16_f32 v161, v154, v155
    v_cvt_pk_bf16_f32 v162, v156, v157
    v_cvt_pk_bf16_f32 v163, v158, v159
    v_pk_maximum3_f16 v216, v160, v161, v216
    v_pk_maximum3_f16 v216, v162, v163, v216
    v_add_f32 v16, v16, v17
    v_rcp_f32 v82, v16
    v_pk_add_f32 v[168:169], v[168:169], v[176:177]
    v_pk_add_f32 v[170:171], v[170:171], v[178:179]
    v_pk_add_f32 v[172:173], v[172:173], v[180:181]
    v_pk_add_f32 v[174:175], v[174:175], v[182:183]
    v_pk_mul_f32 v[168:169], v[168:169], v[82:83] op_sel_hi:[1,0]
    v_pk_mul_f32 v[170:171], v[170:171], v[82:83] op_sel_hi:[1,0]
    v_pk_mul_f32 v[172:173], v[172:173], v[82:83] op_sel_hi:[1,0]
    v_pk_mul_f32 v[174:175], v[174:175], v[82:83] op_sel_hi:[1,0]
    buffer_store_dwordx4 v[160:163], v1, s[20:23], s35 offen offset:0 sc0 sc1
    s_waitcnt lgkmcnt(0)
    v_cvt_pk_bf16_f32 v176, v168, v169
    v_cvt_pk_bf16_f32 v177, v170, v171
    v_cvt_pk_bf16_f32 v178, v172, v173
    v_cvt_pk_bf16_f32 v179, v174, v175
    v_pk_maximum3_f16 v216, v176, v177, v216
    v_pk_maximum3_f16 v216, v178, v179, v216
    v_add_f32 v24, v24, v25
    v_add_f32 v26, v26, v27
    v_add_f32 v24, v24, v26
    v_rcp_f32 v84, v24
    v_pk_add_f32 v[48:49], v[48:49], v[56:57]
    v_pk_add_f32 v[50:51], v[50:51], v[58:59]
    v_pk_add_f32 v[52:53], v[52:53], v[60:61]
    v_pk_add_f32 v[54:55], v[54:55], v[62:63]
    v_pk_add_f32 v[64:65], v[64:65], v[72:73]
    buffer_store_dwordx4 v[176:179], v1, s[20:23], s35 offen offset:1024 sc0 sc1
    v_pk_add_f32 v[66:67], v[66:67], v[74:75]
    v_pk_add_f32 v[68:69], v[68:69], v[76:77]
    v_pk_add_f32 v[70:71], v[70:71], v[78:79]
    v_pk_add_f32 v[48:49], v[48:49], v[64:65]
    v_pk_add_f32 v[50:51], v[50:51], v[66:67]
    v_pk_add_f32 v[52:53], v[52:53], v[68:69]
    v_pk_add_f32 v[54:55], v[54:55], v[70:71]
    v_pk_mul_f32 v[48:49], v[48:49], v[84:85] op_sel_hi:[1,0]
    v_pk_mul_f32 v[50:51], v[50:51], v[84:85] op_sel_hi:[1,0]
    v_pk_mul_f32 v[52:53], v[52:53], v[84:85] op_sel_hi:[1,0]
    v_pk_mul_f32 v[54:55], v[54:55], v[84:85] op_sel_hi:[1,0]
    v_cvt_pk_bf16_f32 v56, v48, v49
    v_cvt_pk_bf16_f32 v57, v50, v51
    v_cvt_pk_bf16_f32 v58, v52, v53
    v_cvt_pk_bf16_f32 v59, v54, v55
    v_pk_maximum3_f16 v216, v56, v57, v216
    v_pk_maximum3_f16 v216, v58, v59, v216
    buffer_store_dwordx4 v[56:59], v1, s[20:23], s41 offen offset:0 sc0 sc1
    s_branch L_guard
L_pre3:
    s_nop 7
    v_mfma_f32_16x16x32_bf16 v[24:27], v[88:91], v[200:203], v[148:151]
    v_mov_b32 v248, 0
    v_mov_b32 v249, 0
    v_mfma_f32_16x16x32_bf16 v[24:27], v[92:95], v[204:207], v[24:27]
    v_mov_b32 v250, 0
    v_mov_b32 v251, 0
    v_mfma_f32_16x16x32_bf16 v[24:27], v[96:99], v[208:211], v[24:27]
    v_exp_f32 v8, v8
    v_mfma_f32_16x16x32_bf16 v[24:27], v[100:103], v[212:215], v[24:27]
    v_exp_f32 v9, v9
    v_mfma_f32_16x16x32_bf16 v[44:47], v[104:107], v[200:203], v[148:151]
    v_exp_f32 v10, v10
    v_mfma_f32_16x16x32_bf16 v[44:47], v[108:111], v[204:207], v[44:47]
    v_cvt_pk_bf16_f32 v52, v8, v9
    v_exp_f32 v11, v11
    v_mfma_f32_16x16x32_bf16 v[44:47], v[112:115], v[208:211], v[44:47]
    v_cvt_pk_bf16_f32 v53, v10, v11
    v_exp_f32 v12, v12
    v_mfma_f32_16x16x32_bf16 v[44:47], v[116:119], v[212:215], v[44:47]
    v_exp_f32 v13, v13
    s_nop 0
    v_cvt_pk_bf16_f32 v60, v12, v13
    v_exp_f32 v14, v14
    v_exp_f32 v15, v15
    s_nop 0
    v_cvt_pk_bf16_f32 v61, v14, v15
    v_exp_f32 v16, v16
    s_nop 0
    v_add_f32 v236, v16, v236
    v_exp_f32 v17, v17
    s_nop 0
    v_add_f32 v236, v17, v236
    v_exp_f32 v18, v18
    v_exp_f32 v19, v19
    v_exp_f32 v20, v20
    v_cvt_pk_bf16_f32 v68, v16, v17
    v_add_f32 v236, v18, v236
    v_add_f32 v236, v19, v236
    v_exp_f32 v21, v21
    v_cvt_pk_bf16_f32 v69, v18, v19
    v_add_f32 v237, v20, v237
    v_exp_f32 v22, v22
    v_add_f32 v237, v21, v237
    v_cvt_pk_bf16_f32 v76, v20, v21
    v_exp_f32 v23, v23
    v_add_f32 v237, v22, v237
    v_exp_f32 v24, v24
    v_add_f32 v237, v23, v237
    v_exp_f32 v25, v25
    v_cvt_pk_bf16_f32 v77, v22, v23
    v_exp_f32 v26, v26
    v_add_f32 v239, v24, v239
    v_exp_f32 v27, v27
    v_add_f32 v239, v25, v239
    v_exp_f32 v28, v28
    v_cvt_pk_bf16_f32 v84, v24, v25
    v_exp_f32 v29, v29
    v_add_f32 v239, v26, v239
    v_exp_f32 v30, v30
    v_exp_f32 v31, v31
    v_exp_f32 v32, v32
    v_exp_f32 v33, v33
    v_add_f32 v239, v27, v239
    v_cvt_pk_bf16_f32 v85, v26, v27
    v_exp_f32 v34, v34
    v_cvt_pk_bf16_f32 v54, v28, v29
    v_cvt_pk_bf16_f32 v55, v30, v31
    v_exp_f32 v35, v35
    v_cvt_pk_bf16_f32 v62, v32, v33
    v_exp_f32 v36, v36
    v_cvt_pk_bf16_f32 v63, v34, v35
    v_exp_f32 v37, v37
    v_add_f32 v236, v36, v236
    v_exp_f32 v38, v38
    v_add_f32 v236, v37, v236
    v_exp_f32 v39, v39
    v_exp_f32 v40, v40
    v_cvt_pk_bf16_f32 v70, v36, v37
    v_add_f32 v236, v38, v236
    v_exp_f32 v41, v41
    v_add_f32 v236, v39, v236
    v_cvt_pk_bf16_f32 v71, v38, v39
    v_exp_f32 v42, v42
    v_add_f32 v237, v40, v237
    v_add_f32 v237, v41, v237
    v_exp_f32 v43, v43
    s_waitcnt vmcnt(8)
    s_barrier
    ds_read_b128 v[152:155], v216 offset:0
    ds_read_b128 v[156:159], v217 offset:0
    ds_read_b128 v[160:163], v218 offset:0
    ds_read_b128 v[164:167], v219 offset:0
    s_waitcnt lgkmcnt(0)
    s_branch L_loop3
L_tail3:
    s_nop 7
    v_mfma_f32_16x16x32_bf16 v[244:247], v[240:243], v[88:91], v[244:247]
    ds_read_b64_tr_b16 v[152:153], v220 offset:49152
    ds_read_b64_tr_b16 v[154:155], v220 offset:53248
    v_mfma_f32_16x16x32_bf16 v[244:247], v[240:243], v[92:95], v[244:247]
    v_add_u32 v218, 1056, v4
    ds_read_b64_tr_b16 v[156:157], v220 offset:57344
    ds_read_b64_tr_b16 v[158:159], v220 offset:61440
    ds_read_b64_tr_b16 v[160:161], v221 offset:49152
    ds_read_b64_tr_b16 v[162:163], v221 offset:53248
    ds_read_b64_tr_b16 v[164:165], v221 offset:57344
    ds_read_b64_tr_b16 v[166:167], v221 offset:61440
    ds_read_b64_tr_b16 v[168:169], v222 offset:49152
    ds_read_b64_tr_b16 v[170:171], v222 offset:53248
    ds_read_b64_tr_b16 v[172:173], v222 offset:57344
    ds_read_b64_tr_b16 v[174:175], v222 offset:61440
    ds_read_b64_tr_b16 v[176:177], v223 offset:49152
    ds_read_b64_tr_b16 v[178:179], v223 offset:53248
    ds_read_b64_tr_b16 v[180:181], v223 offset:57344
    ds_read_b64_tr_b16 v[182:183], v223 offset:61440
    ds_read_b64_tr_b16 v[48:49], v224 offset:49152
    ds_read_b64_tr_b16 v[50:51], v224 offset:53248
    ds_read_b64_tr_b16 v[52:53], v224 offset:57344
    ds_read_b64_tr_b16 v[54:55], v224 offset:61440
    ds_read_b64_tr_b16 v[56:57], v225 offset:49152
    ds_read_b64_tr_b16 v[58:59], v225 offset:53248
    ds_read_b64_tr_b16 v[60:61], v225 offset:57344
    ds_read_b64_tr_b16 v[62:63], v225 offset:61440
    ds_read_b64_tr_b16 v[64:65], v226 offset:49152
    ds_read_b64_tr_b16 v[66:67], v226 offset:53248
    ds_read_b64_tr_b16 v[68:69], v226 offset:57344
    ds_read_b64_tr_b16 v[70:71], v226 offset:61440
    ds_read_b64_tr_b16 v[72:73], v227 offset:49152
    ds_read_b64_tr_b16 v[74:75], v227 offset:53248
    ds_read_b64_tr_b16 v[76:77], v227 offset:57344
    ds_read_b64_tr_b16 v[78:79], v227 offset:61440
    v_add_u32 v219, 1056, v2
    v_add_u32 v232, 8448, v2
    v_add_u32 v233, 9504, v2
    v_mov_b32 v8, v244
    v_mov_b32 v14, v8
    v_mfma_f32_16x16x32_bf16 v[248:251], v[240:243], v[96:99], v[248:251]
    s_nop 0
    v_permlane16_swap_b32 v8, v14
    s_waitcnt lgkmcnt(15)
    v_mfma_f32_16x16x32_bf16 a[0:3], v[88:91], v[152:155], a[0:3]
    v_add_f32 v8, v8, v14
    v_mov_b32 v14, v8
    v_mfma_f32_16x16x32_bf16 a[0:3], v[92:95], v[156:159], a[0:3]
    s_nop 0
    v_permlane32_swap_b32 v8, v14
    v_mfma_f32_16x16x32_bf16 a[4:7], v[88:91], v[160:163], a[4:7]
    v_add_f32 v8, v8, v14
    v_rcp_f32 v20, v8
    v_mfma_f32_16x16x32_bf16 a[4:7], v[92:95], v[164:167], a[4:7]
    s_waitcnt lgkmcnt(15)
    v_cvt_pk_bf16_f32 v110, v36, v37
    v_mfma_f32_16x16x32_bf16 a[8:11], v[88:91], v[168:171], a[8:11]
    v_exp_f32 v40, v40
    v_mfma_f32_16x16x32_bf16 a[8:11], v[92:95], v[172:175], a[8:11]
    ds_write_b32 v254, v20 offset:0
    ds_write2_b32 v4, a0, a1 offset0:0 offset1:132
    v_mfma_f32_16x16x32_bf16 a[12:15], v[88:91], v[176:179], a[12:15]
    v_add_f32 v236, v38, v236
    s_waitcnt lgkmcnt(10)
    v_mfma_f32_16x16x32_bf16 a[12:15], v[92:95], v[180:183], a[12:15]
    ds_write2_b32 v218, a2, a3 offset0:0 offset1:132
    v_mfma_f32_16x16x32_bf16 a[16:19], v[88:91], v[48:51], a[16:19]
    v_exp_f32 v41, v41
    v_mfma_f32_16x16x32_bf16 a[16:19], v[92:95], v[52:55], a[16:19]
    ds_write2_b32 v4, a4, a5 offset0:16 offset1:148
    v_mfma_f32_16x16x32_bf16 a[20:23], v[88:91], v[56:59], a[20:23]
    s_waitcnt lgkmcnt(4)
    v_add_f32 v236, v39, v236
    v_mfma_f32_16x16x32_bf16 a[20:23], v[92:95], v[60:63], a[20:23]
    ds_write2_b32 v218, a6, a7 offset0:16 offset1:148
    v_mfma_f32_16x16x32_bf16 a[24:27], v[88:91], v[64:67], a[24:27]
    v_cvt_pk_bf16_f32 v111, v38, v39
    v_exp_f32 v42, v42
    v_mfma_f32_16x16x32_bf16 a[24:27], v[92:95], v[68:71], a[24:27]
    ds_write2_b32 v4, a8, a9 offset0:32 offset1:164
    v_mfma_f32_16x16x32_bf16 a[28:31], v[88:91], v[72:75], a[28:31]
    v_exp_f32 v43, v43
    v_mfma_f32_16x16x32_bf16 a[28:31], v[92:95], v[76:79], a[28:31]
    ds_write2_b32 v218, a10, a11 offset0:32 offset1:164
    ds_write2_b32 v4, a12, a13 offset0:48 offset1:180
    ds_write2_b32 v218, a14, a15 offset0:48 offset1:180
    ds_write2_b32 v4, a16, a17 offset0:64 offset1:196
    ds_write2_b32 v218, a18, a19 offset0:64 offset1:196
    ds_write2_b32 v4, a20, a21 offset0:80 offset1:212
    ds_write2_b32 v218, a22, a23 offset0:80 offset1:212
    ds_write2_b32 v4, a24, a25 offset0:96 offset1:228
    ds_write2_b32 v218, a26, a27 offset0:96 offset1:228
    ds_write2_b32 v4, a28, a29 offset0:112 offset1:244
    ds_write2_b32 v218, a30, a31 offset0:112 offset1:244
    ds_read_b32 v28, v255 offset:0
    ds_read_b128 v[184:187], v5 offset:0
    ds_read_b128 v[188:191], v5 offset:16
    ds_read_b32 v29, v255 offset:16
    ds_read_b128 v[192:195], v5 offset:2112
    ds_read_b128 v[196:199], v5 offset:2128
    ds_read_b32 v30, v255 offset:32
    ds_read_b128 v[200:203], v5 offset:4224
    ds_read_b128 v[204:207], v5 offset:4240
    ds_read_b32 v31, v255 offset:48
    ds_read_b128 v[208:211], v5 offset:6336
    ds_read_b128 v[212:215], v5 offset:6352
    v_mfma_f32_16x16x32_bf16 v[248:251], v[240:243], v[100:103], v[248:251]
    v_exp_f32 v44, v44
    v_mfma_f32_16x16x32_bf16 a[32:35], v[96:99], v[152:155], a[32:35]
    v_add_f32 v237, v40, v237
    v_add_f32 v237, v41, v237
    v_mfma_f32_16x16x32_bf16 a[32:35], v[100:103], v[156:159], a[32:35]
    v_exp_f32 v45, v45
    v_mfma_f32_16x16x32_bf16 a[36:39], v[96:99], v[160:163], a[36:39]
    v_cvt_pk_bf16_f32 v118, v40, v41
    v_add_f32 v237, v42, v237
    v_mfma_f32_16x16x32_bf16 a[36:39], v[100:103], v[164:167], a[36:39]
    v_exp_f32 v46, v46
    v_mfma_f32_16x16x32_bf16 a[40:43], v[96:99], v[168:171], a[40:43]
    v_add_f32 v237, v43, v237
    v_cvt_pk_bf16_f32 v119, v42, v43
    v_mfma_f32_16x16x32_bf16 a[40:43], v[100:103], v[172:175], a[40:43]
    v_exp_f32 v47, v47
    v_mfma_f32_16x16x32_bf16 a[44:47], v[96:99], v[176:179], a[44:47]
    v_add_f32 v238, v44, v238
    v_add_f32 v238, v45, v238
    v_mfma_f32_16x16x32_bf16 a[44:47], v[100:103], v[180:183], a[44:47]
    v_cvt_pk_bf16_f32 v126, v44, v45
    v_add_f32 v238, v46, v238
    v_mfma_f32_16x16x32_bf16 a[48:51], v[96:99], v[48:51], a[48:51]
    v_add_f32 v238, v47, v238
    v_cvt_pk_bf16_f32 v127, v46, v47
    v_mfma_f32_16x16x32_bf16 a[48:51], v[100:103], v[52:55], a[48:51]
    v_mov_b32 v216, 0
    v_mov_b32 v9, v248
    v_mfma_f32_16x16x32_bf16 a[52:55], v[96:99], v[56:59], a[52:55]
    v_mov_b32 v10, v236
    v_mov_b32 v11, v237
    v_mfma_f32_16x16x32_bf16 a[52:55], v[100:103], v[60:63], a[52:55]
    v_mov_b32 v12, v238
    v_mov_b32 v13, v239
    v_mfma_f32_16x16x32_bf16 a[56:59], v[96:99], v[64:67], a[56:59]
    v_mov_b32 v15, v9
    v_mov_b32 v16, v10
    v_mfma_f32_16x16x32_bf16 a[56:59], v[100:103], v[68:71], a[56:59]
    v_mov_b32 v17, v11
    v_mov_b32 v18, v12
    v_mfma_f32_16x16x32_bf16 a[60:63], v[96:99], v[72:75], a[60:63]
    v_mov_b32 v19, v13
    v_permlane16_swap_b32 v9, v15
    v_mfma_f32_16x16x32_bf16 a[60:63], v[100:103], v[76:79], a[60:63]
    ds_write2_b32 v232, a160, a161 offset0:0 offset1:132
    s_waitcnt lgkmcnt(7)
    v_pk_mul_f32 v[184:185], v[184:185], v[28:29] op_sel_hi:[1,0]
    v_pk_mul_f32 v[186:187], v[186:187], v[28:29] op_sel_hi:[1,0]
    v_pk_mul_f32 v[188:189], v[188:189], v[28:29] op_sel_hi:[1,0]
    v_pk_mul_f32 v[190:191], v[190:191], v[28:29] op_sel_hi:[1,0]
    v_cvt_pk_bf16_f32 v184, v184, v185
    v_cvt_pk_bf16_f32 v185, v186, v187
    v_cvt_pk_bf16_f32 v186, v188, v189
    v_cvt_pk_bf16_f32 v187, v190, v191
    buffer_store_dwordx4 v[184:187], v1, s[20:23], s4 offen offset:0 sc0 sc1
    v_pk_maximum3_f16 v216, v184, v185, v216
    v_pk_maximum3_f16 v216, v186, v187, v216
    v_pk_mul_f32 v[192:193], v[192:193], v[28:29] op_sel:[0,1] op_sel_hi:[1,1]
    s_waitcnt lgkmcnt(1)
    v_pk_mul_f32 v[194:195], v[194:195], v[28:29] op_sel:[0,1] op_sel_hi:[1,1]
    v_pk_mul_f32 v[196:197], v[196:197], v[28:29] op_sel:[0,1] op_sel_hi:[1,1]
    v_pk_mul_f32 v[198:199], v[198:199], v[28:29] op_sel:[0,1] op_sel_hi:[1,1]
    v_cvt_pk_bf16_f32 v192, v192, v193
    v_cvt_pk_bf16_f32 v193, v194, v195
    v_cvt_pk_bf16_f32 v194, v196, v197
    v_cvt_pk_bf16_f32 v195, v198, v199
    v_pk_maximum3_f16 v216, v192, v193, v216
    v_pk_maximum3_f16 v216, v194, v195, v216
    v_pk_mul_f32 v[200:201], v[200:201], v[30:31] op_sel_hi:[1,0]
    v_pk_mul_f32 v[202:203], v[202:203], v[30:31] op_sel_hi:[1,0]
    v_pk_mul_f32 v[204:205], v[204:205], v[30:31] op_sel_hi:[1,0]
    v_pk_mul_f32 v[206:207], v[206:207], v[30:31] op_sel_hi:[1,0]
    buffer_store_dwordx4 v[192:195], v1, s[20:23], s4 offen offset:1024 sc0 sc1
    v_cvt_pk_bf16_f32 v200, v200, v201
    v_cvt_pk_bf16_f32 v201, v202, v203
    v_cvt_pk_bf16_f32 v202, v204, v205
    v_cvt_pk_bf16_f32 v203, v206, v207
    v_pk_maximum3_f16 v216, v200, v201, v216
    v_pk_maximum3_f16 v216, v202, v203, v216
    v_pk_mul_f32 v[208:209], v[208:209], v[30:31] op_sel:[0,1] op_sel_hi:[1,1]
    v_pk_mul_f32 v[210:211], v[210:211], v[30:31] op_sel:[0,1] op_sel_hi:[1,1]
    v_pk_mul_f32 v[212:213], v[212:213], v[30:31] op_sel:[0,1] op_sel_hi:[1,1]
    v_pk_mul_f32 v[214:215], v[214:215], v[30:31] op_sel:[0,1] op_sel_hi:[1,1]
    v_cvt_pk_bf16_f32 v208, v208, v209
    v_cvt_pk_bf16_f32 v209, v210, v211
    v_cvt_pk_bf16_f32 v210, v212, v213
    v_cvt_pk_bf16_f32 v211, v214, v215
    v_pk_maximum3_f16 v216, v208, v209, v216
    v_pk_maximum3_f16 v216, v210, v211, v216
    v_mfma_f32_16x16x32_bf16 a[128:131], v[120:123], v[152:155], a[128:131]
    buffer_store_dwordx4 v[200:203], v1, s[20:23], s4 offen offset:2048 sc0 sc1
    v_mfma_f32_16x16x32_bf16 a[128:131], v[124:127], v[156:159], a[128:131]
    ds_write2_b32 v233, a162, a163 offset0:0 offset1:132
    v_mfma_f32_16x16x32_bf16 a[132:135], v[120:123], v[160:163], a[132:135]
    v_permlane16_swap_b32 v10, v16
    v_mfma_f32_16x16x32_bf16 a[132:135], v[124:127], v[164:167], a[132:135]
    ds_write2_b32 v232, a164, a165 offset0:16 offset1:148
    v_mfma_f32_16x16x32_bf16 a[136:139], v[120:123], v[168:171], a[136:139]
    v_permlane16_swap_b32 v11, v17
    buffer_store_dwordx4 v[208:211], v1, s[20:23], s4 offen offset:3072 sc0 sc1
    v_mfma_f32_16x16x32_bf16 a[136:139], v[124:127], v[172:175], a[136:139]
    ds_write2_b32 v233, a166, a167 offset0:16 offset1:148
    v_mfma_f32_16x16x32_bf16 a[140:143], v[120:123], v[176:179], a[140:143]
    v_permlane16_swap_b32 v12, v18
    v_mfma_f32_16x16x32_bf16 a[140:143], v[124:127], v[180:183], a[140:143]
    ds_write2_b32 v232, a168, a169 offset0:32 offset1:164
    v_mfma_f32_16x16x32_bf16 a[144:147], v[120:123], v[48:51], a[144:147]
    v_permlane16_swap_b32 v13, v19
    v_mfma_f32_16x16x32_bf16 a[144:147], v[124:127], v[52:55], a[144:147]
    ds_write2_b32 v233, a170, a171 offset0:32 offset1:164
    v_mfma_f32_16x16x32_bf16 a[148:151], v[120:123], v[56:59], a[148:151]
    v_add_f32 v9, v9, v15
    v_add_f32 v10, v10, v16
    v_mfma_f32_16x16x32_bf16 a[148:151], v[124:127], v[60:63], a[148:151]
    ds_write2_b32 v232, a172, a173 offset0:48 offset1:180
    v_mfma_f32_16x16x32_bf16 a[152:155], v[120:123], v[64:67], a[152:155]
    v_add_f32 v11, v11, v17
    v_add_f32 v12, v12, v18
    v_mfma_f32_16x16x32_bf16 a[152:155], v[124:127], v[68:71], a[152:155]
    ds_write2_b32 v233, a174, a175 offset0:48 offset1:180
    v_mfma_f32_16x16x32_bf16 a[156:159], v[120:123], v[72:75], a[156:159]
    v_add_f32 v13, v13, v19
    v_mov_b32 v15, v9
    v_mfma_f32_16x16x32_bf16 a[156:159], v[124:127], v[76:79], a[156:159]
    ds_write2_b32 v232, a176, a177 offset0:64 offset1:196
    v_mfma_f32_16x16x32_bf16 a[64:67], v[104:107], v[152:155], a[64:67]
    v_mov_b32 v16, v10
    v_mov_b32 v17, v11
    v_mfma_f32_16x16x32_bf16 a[64:67], v[108:111], v[156:159], a[64:67]
    ds_write2_b32 v233, a178, a179 offset0:64 offset1:196
    v_mfma_f32_16x16x32_bf16 a[68:71], v[104:107], v[160:163], a[68:71]
    v_mov_b32 v18, v12
    v_mov_b32 v19, v13
    v_mfma_f32_16x16x32_bf16 a[68:71], v[108:111], v[164:167], a[68:71]
    ds_write2_b32 v232, a180, a181 offset0:80 offset1:212
    v_mfma_f32_16x16x32_bf16 a[72:75], v[104:107], v[168:171], a[72:75]
    v_permlane32_swap_b32 v9, v15
    v_mfma_f32_16x16x32_bf16 a[72:75], v[108:111], v[172:175], a[72:75]
    ds_write2_b32 v233, a182, a183 offset0:80 offset1:212
    v_mfma_f32_16x16x32_bf16 a[76:79], v[104:107], v[176:179], a[76:79]
    v_permlane32_swap_b32 v10, v16
    v_mfma_f32_16x16x32_bf16 a[76:79], v[108:111], v[180:183], a[76:79]
    ds_write2_b32 v232, a184, a185 offset0:96 offset1:228
    v_mfma_f32_16x16x32_bf16 a[80:83], v[104:107], v[48:51], a[80:83]
    v_permlane32_swap_b32 v11, v17
    v_mfma_f32_16x16x32_bf16 a[80:83], v[108:111], v[52:55], a[80:83]
    ds_write2_b32 v233, a186, a187 offset0:96 offset1:228
    v_mfma_f32_16x16x32_bf16 a[84:87], v[104:107], v[56:59], a[84:87]
    v_permlane32_swap_b32 v12, v18
    v_mfma_f32_16x16x32_bf16 a[84:87], v[108:111], v[60:63], a[84:87]
    ds_write2_b32 v232, a188, a189 offset0:112 offset1:244
    v_mfma_f32_16x16x32_bf16 a[88:91], v[104:107], v[64:67], a[88:91]
    v_permlane32_swap_b32 v13, v19
    v_mfma_f32_16x16x32_bf16 a[88:91], v[108:111], v[68:71], a[88:91]
    ds_write2_b32 v233, a190, a191 offset0:112 offset1:244
    v_mfma_f32_16x16x32_bf16 a[92:95], v[104:107], v[72:75], a[92:95]
    v_add_f32 v9, v9, v15
    v_add_f32 v10, v10, v16
    v_mfma_f32_16x16x32_bf16 a[92:95], v[108:111], v[76:79], a[92:95]
    v_add_f32 v11, v11, v17
    v_add_f32 v12, v12, v18
    v_mfma_f32_16x16x32_bf16 a[96:99], v[112:115], v[152:155], a[96:99]
    v_add_f32 v13, v13, v19
    v_rcp_f32 v21, v9
    v_mfma_f32_16x16x32_bf16 a[96:99], v[116:119], v[156:159], a[96:99]
    ds_write_b32 v254, v21 offset:64
    ds_write2_b32 v4, a32, a33 offset0:0 offset1:132
    v_mfma_f32_16x16x32_bf16 a[100:103], v[112:115], v[160:163], a[100:103]
    v_rcp_f32 v22, v10
    v_mfma_f32_16x16x32_bf16 a[100:103], v[116:119], v[164:167], a[100:103]
    ds_write2_b32 v218, a34, a35 offset0:0 offset1:132
    v_mfma_f32_16x16x32_bf16 a[104:107], v[112:115], v[168:171], a[104:107]
    v_rcp_f32 v23, v11
    v_mfma_f32_16x16x32_bf16 a[104:107], v[116:119], v[172:175], a[104:107]
    ds_write2_b32 v4, a36, a37 offset0:16 offset1:148
    v_mfma_f32_16x16x32_bf16 a[108:111], v[112:115], v[176:179], a[108:111]
    v_mfma_f32_16x16x32_bf16 a[108:111], v[116:119], v[180:183], a[108:111]
    ds_write2_b32 v218, a38, a39 offset0:16 offset1:148
    v_mfma_f32_16x16x32_bf16 a[112:115], v[112:115], v[48:51], a[112:115]
    v_mfma_f32_16x16x32_bf16 a[112:115], v[116:119], v[52:55], a[112:115]
    ds_write2_b32 v4, a40, a41 offset0:32 offset1:164
    v_mfma_f32_16x16x32_bf16 a[116:119], v[112:115], v[56:59], a[116:119]
    v_mfma_f32_16x16x32_bf16 a[116:119], v[116:119], v[60:63], a[116:119]
    ds_write2_b32 v218, a42, a43 offset0:32 offset1:164
    v_mfma_f32_16x16x32_bf16 a[120:123], v[112:115], v[64:67], a[120:123]
    v_mfma_f32_16x16x32_bf16 a[120:123], v[116:119], v[68:71], a[120:123]
    ds_write2_b32 v4, a44, a45 offset0:48 offset1:180
    v_mfma_f32_16x16x32_bf16 a[124:127], v[112:115], v[72:75], a[124:127]
    v_mfma_f32_16x16x32_bf16 a[124:127], v[116:119], v[76:79], a[124:127]
    ds_write2_b32 v218, a46, a47 offset0:48 offset1:180
    ds_write2_b32 v4, a48, a49 offset0:64 offset1:196
    ds_write2_b32 v218, a50, a51 offset0:64 offset1:196
    ds_write2_b32 v4, a52, a53 offset0:80 offset1:212
    ds_write2_b32 v218, a54, a55 offset0:80 offset1:212
    ds_write2_b32 v4, a56, a57 offset0:96 offset1:228
    ds_write2_b32 v218, a58, a59 offset0:96 offset1:228
    ds_write2_b32 v4, a60, a61 offset0:112 offset1:244
    ds_write2_b32 v218, a62, a63 offset0:112 offset1:244
    ds_read_b32 v32, v255 offset:64
    ds_read_b128 v[120:123], v5 offset:0
    ds_read_b128 v[124:127], v5 offset:16
    ds_read_b32 v33, v255 offset:80
    ds_read_b128 v[128:131], v5 offset:2112
    ds_read_b128 v[132:135], v5 offset:2128
    ds_read_b32 v34, v255 offset:96
    ds_read_b128 v[136:139], v5 offset:4224
    ds_read_b128 v[140:143], v5 offset:4240
    ds_read_b32 v35, v255 offset:112
    ds_read_b128 v[144:147], v5 offset:6336
    ds_read_b128 v[148:151], v5 offset:6352
    ds_write2_b32 v2, a128, a129 offset0:0 offset1:132
    ds_write2_b32 v219, a130, a131 offset0:0 offset1:132
    ds_write2_b32 v2, a132, a133 offset0:16 offset1:148
    ds_write2_b32 v219, a134, a135 offset0:16 offset1:148
    ds_write2_b32 v2, a136, a137 offset0:32 offset1:164
    ds_write2_b32 v219, a138, a139 offset0:32 offset1:164
    ds_write2_b32 v2, a140, a141 offset0:48 offset1:180
    ds_write2_b32 v219, a142, a143 offset0:48 offset1:180
    ds_write2_b32 v2, a144, a145 offset0:64 offset1:196
    ds_write2_b32 v219, a146, a147 offset0:64 offset1:196
    ds_write2_b32 v2, a148, a149 offset0:80 offset1:212
    ds_write2_b32 v219, a150, a151 offset0:80 offset1:212
    ds_write2_b32 v2, a152, a153 offset0:96 offset1:228
    ds_write2_b32 v219, a154, a155 offset0:96 offset1:228
    ds_write2_b32 v2, a156, a157 offset0:112 offset1:244
    s_waitcnt lgkmcnt(15)
    v_mul_f32 v120, v120, v32
    v_mul_f32 v121, v121, v32
    v_mul_f32 v122, v122, v32
    v_mul_f32 v123, v123, v32
    v_mul_f32 v124, v124, v32
    v_mul_f32 v125, v125, v32
    v_mul_f32 v126, v126, v32
    v_mul_f32 v127, v127, v32
    v_cvt_pk_bf16_f32 v120, v120, v121
    v_cvt_pk_bf16_f32 v121, v122, v123
    v_cvt_pk_bf16_f32 v122, v124, v125
    v_cvt_pk_bf16_f32 v123, v126, v127
    buffer_store_dwordx4 v[120:123], v1, s[20:23], s5 offen offset:0 sc0 sc1
    s_waitcnt lgkmcnt(15)
    v_pk_maximum3_f16 v216, v120, v121, v216
    v_pk_maximum3_f16 v216, v122, v123, v216
    v_mul_f32 v128, v128, v33
    v_mul_f32 v129, v129, v33
    v_mul_f32 v130, v130, v33
    v_mul_f32 v131, v131, v33
    v_mul_f32 v132, v132, v33
    v_mul_f32 v133, v133, v33
    v_mul_f32 v134, v134, v33
    v_mul_f32 v135, v135, v33
    v_cvt_pk_bf16_f32 v128, v128, v129
    v_cvt_pk_bf16_f32 v129, v130, v131
    v_cvt_pk_bf16_f32 v130, v132, v133
    v_cvt_pk_bf16_f32 v131, v134, v135
    v_pk_maximum3_f16 v216, v128, v129, v216
    v_pk_maximum3_f16 v216, v130, v131, v216
    buffer_store_dwordx4 v[128:131], v1, s[20:23], s5 offen offset:1024 sc0 sc1
    v_mul_f32 v136, v136, v34
    v_mul_f32 v137, v137, v34
    v_mul_f32 v138, v138, v34
    v_mul_f32 v139, v139, v34
    v_mul_f32 v140, v140, v34
    v_mul_f32 v141, v141, v34
    v_mul_f32 v142, v142, v34
    v_mul_f32 v143, v143, v34
    v_cvt_pk_bf16_f32 v136, v136, v137
    v_cvt_pk_bf16_f32 v137, v138, v139
    v_cvt_pk_bf16_f32 v138, v140, v141
    v_cvt_pk_bf16_f32 v139, v142, v143
    v_pk_maximum3_f16 v216, v136, v137, v216
    v_pk_maximum3_f16 v216, v138, v139, v216
    v_mul_f32 v144, v144, v35
    v_mul_f32 v145, v145, v35
    v_mul_f32 v146, v146, v35
    buffer_store_dwordx4 v[136:139], v1, s[20:23], s5 offen offset:2048 sc0 sc1
    v_mul_f32 v147, v147, v35
    v_mul_f32 v148, v148, v35
    v_mul_f32 v149, v149, v35
    v_mul_f32 v150, v150, v35
    v_mul_f32 v151, v151, v35
    v_cvt_pk_bf16_f32 v144, v144, v145
    v_cvt_pk_bf16_f32 v145, v146, v147
    v_cvt_pk_bf16_f32 v146, v148, v149
    v_cvt_pk_bf16_f32 v147, v150, v151
    v_pk_maximum3_f16 v216, v144, v145, v216
    v_pk_maximum3_f16 v216, v146, v147, v216
    ds_write2_b32 v219, a158, a159 offset0:112 offset1:244
    buffer_store_dwordx4 v[144:147], v1, s[20:23], s5 offen offset:3072 sc0 sc1
    ds_write_b32 v3, v12 offset:0
    ds_write_b32 v3, v13 offset:256
    ds_write_b32 v254, v22 offset:128
    ds_write2_b32 v4, a64, a65 offset0:0 offset1:132
    ds_write2_b32 v218, a66, a67 offset0:0 offset1:132
    ds_write2_b32 v4, a68, a69 offset0:16 offset1:148
    ds_write2_b32 v218, a70, a71 offset0:16 offset1:148
    ds_write2_b32 v4, a72, a73 offset0:32 offset1:164
    ds_write2_b32 v218, a74, a75 offset0:32 offset1:164
    ds_write2_b32 v4, a76, a77 offset0:48 offset1:180
    ds_write2_b32 v218, a78, a79 offset0:48 offset1:180
    ds_write2_b32 v4, a80, a81 offset0:64 offset1:196
    ds_write2_b32 v218, a82, a83 offset0:64 offset1:196
    ds_write2_b32 v4, a84, a85 offset0:80 offset1:212
    ds_write2_b32 v218, a86, a87 offset0:80 offset1:212
    ds_write2_b32 v4, a88, a89 offset0:96 offset1:228
    ds_write2_b32 v218, a90, a91 offset0:96 offset1:228
    ds_write2_b32 v4, a92, a93 offset0:112 offset1:244
    ds_write2_b32 v218, a94, a95 offset0:112 offset1:244
    ds_read_b32 v36, v255 offset:128
    ds_read_b128 v[184:187], v5 offset:0
    ds_read_b128 v[188:191], v5 offset:16
    ds_read_b32 v37, v255 offset:144
    ds_read_b128 v[192:195], v5 offset:2112
    ds_read_b128 v[196:199], v5 offset:2128
    ds_read_b32 v38, v255 offset:160
    ds_read_b128 v[200:203], v5 offset:4224
    ds_read_b128 v[204:207], v5 offset:4240
    ds_read_b32 v39, v255 offset:176
    ds_read_b128 v[208:211], v5 offset:6336
    ds_read_b128 v[212:215], v5 offset:6352
    ds_write_b32 v254, v23 offset:192
    ds_write2_b32 v4, a96, a97 offset0:0 offset1:132
    ds_write2_b32 v218, a98, a99 offset0:0 offset1:132
    ds_write2_b32 v4, a100, a101 offset0:16 offset1:148
    ds_write2_b32 v218, a102, a103 offset0:16 offset1:148
    ds_write2_b32 v4, a104, a105 offset0:32 offset1:164
    ds_write2_b32 v218, a106, a107 offset0:32 offset1:164
    ds_write2_b32 v4, a108, a109 offset0:48 offset1:180
    ds_write2_b32 v218, a110, a111 offset0:48 offset1:180
    ds_write2_b32 v4, a112, a113 offset0:64 offset1:196
    ds_write2_b32 v218, a114, a115 offset0:64 offset1:196
    ds_write2_b32 v4, a116, a117 offset0:80 offset1:212
    ds_write2_b32 v218, a118, a119 offset0:80 offset1:212
    ds_write2_b32 v4, a120, a121 offset0:96 offset1:228
    ds_write2_b32 v218, a122, a123 offset0:96 offset1:228
    s_waitcnt lgkmcnt(15)
    v_pk_mul_f32 v[184:185], v[184:185], v[36:37] op_sel_hi:[1,0]
    v_pk_mul_f32 v[186:187], v[186:187], v[36:37] op_sel_hi:[1,0]
    v_pk_mul_f32 v[188:189], v[188:189], v[36:37] op_sel_hi:[1,0]
    v_pk_mul_f32 v[190:191], v[190:191], v[36:37] op_sel_hi:[1,0]
    v_cvt_pk_bf16_f32 v184, v184, v185
    v_cvt_pk_bf16_f32 v185, v186, v187
    v_cvt_pk_bf16_f32 v186, v188, v189
    v_cvt_pk_bf16_f32 v187, v190, v191
    buffer_store_dwordx4 v[184:187], v1, s[20:23], s6 offen offset:0 sc0 sc1
    v_pk_maximum3_f16 v216, v184, v185, v216
    v_pk_maximum3_f16 v216, v186, v187, v216
    v_pk_mul_f32 v[192:193], v[192:193], v[36:37] op_sel:[0,1] op_sel_hi:[1,1]
    v_pk_mul_f32 v[194:195], v[194:195], v[36:37] op_sel:[0,1] op_sel_hi:[1,1]
    s_waitcnt lgkmcnt(15)
    v_pk_mul_f32 v[196:197], v[196:197], v[36:37] op_sel:[0,1] op_sel_hi:[1,1]
    v_pk_mul_f32 v[198:199], v[198:199], v[36:37] op_sel:[0,1] op_sel_hi:[1,1]
    v_cvt_pk_bf16_f32 v192, v192, v193
    v_cvt_pk_bf16_f32 v193, v194, v195
    v_cvt_pk_bf16_f32 v194, v196, v197
    v_cvt_pk_bf16_f32 v195, v198, v199
    v_pk_maximum3_f16 v216, v192, v193, v216
    v_pk_maximum3_f16 v216, v194, v195, v216
    v_pk_mul_f32 v[200:201], v[200:201], v[38:39] op_sel_hi:[1,0]
    v_pk_mul_f32 v[202:203], v[202:203], v[38:39] op_sel_hi:[1,0]
    v_pk_mul_f32 v[204:205], v[204:205], v[38:39] op_sel_hi:[1,0]
    v_pk_mul_f32 v[206:207], v[206:207], v[38:39] op_sel_hi:[1,0]
    buffer_store_dwordx4 v[192:195], v1, s[20:23], s6 offen offset:1024 sc0 sc1
    v_cvt_pk_bf16_f32 v200, v200, v201
    v_cvt_pk_bf16_f32 v201, v202, v203
    v_cvt_pk_bf16_f32 v202, v204, v205
    v_cvt_pk_bf16_f32 v203, v206, v207
    v_pk_maximum3_f16 v216, v200, v201, v216
    v_pk_maximum3_f16 v216, v202, v203, v216
    v_pk_mul_f32 v[208:209], v[208:209], v[38:39] op_sel:[0,1] op_sel_hi:[1,1]
    v_pk_mul_f32 v[210:211], v[210:211], v[38:39] op_sel:[0,1] op_sel_hi:[1,1]
    v_pk_mul_f32 v[212:213], v[212:213], v[38:39] op_sel:[0,1] op_sel_hi:[1,1]
    v_pk_mul_f32 v[214:215], v[214:215], v[38:39] op_sel:[0,1] op_sel_hi:[1,1]
    v_cvt_pk_bf16_f32 v208, v208, v209
    v_cvt_pk_bf16_f32 v209, v210, v211
    v_cvt_pk_bf16_f32 v210, v212, v213
    v_cvt_pk_bf16_f32 v211, v214, v215
    v_pk_maximum3_f16 v216, v208, v209, v216
    v_pk_maximum3_f16 v216, v210, v211, v216
    buffer_store_dwordx4 v[200:203], v1, s[20:23], s6 offen offset:2048 sc0 sc1
    ds_write2_b32 v4, a124, a125 offset0:112 offset1:244
    buffer_store_dwordx4 v[208:211], v1, s[20:23], s6 offen offset:3072 sc0 sc1
    ds_write2_b32 v218, a126, a127 offset0:112 offset1:244
    ds_read_b32 v40, v255 offset:192
    ds_read_b128 v[120:123], v5 offset:0
    ds_read_b128 v[124:127], v5 offset:16
    ds_read_b32 v41, v255 offset:208
    ds_read_b128 v[128:131], v5 offset:2112
    ds_read_b128 v[132:135], v5 offset:2128
    ds_read_b32 v42, v255 offset:224
    ds_read_b128 v[136:139], v5 offset:4224
    ds_read_b128 v[140:143], v5 offset:4240
    ds_read_b32 v43, v255 offset:240
    ds_read_b128 v[144:147], v5 offset:6336
    ds_read_b128 v[148:151], v5 offset:6352
    s_waitcnt lgkmcnt(6)
    v_pk_mul_f32 v[120:121], v[120:121], v[40:41] op_sel_hi:[1,0]
    v_pk_mul_f32 v[122:123], v[122:123], v[40:41] op_sel_hi:[1,0]
    v_pk_mul_f32 v[124:125], v[124:125], v[40:41] op_sel_hi:[1,0]
    v_pk_mul_f32 v[126:127], v[126:127], v[40:41] op_sel_hi:[1,0]
    v_cvt_pk_bf16_f32 v120, v120, v121
    v_cvt_pk_bf16_f32 v121, v122, v123
    v_cvt_pk_bf16_f32 v122, v124, v125
    v_cvt_pk_bf16_f32 v123, v126, v127
    buffer_store_dwordx4 v[120:123], v1, s[20:23], s7 offen offset:0 sc0 sc1
    v_pk_maximum3_f16 v216, v120, v121, v216
    v_pk_maximum3_f16 v216, v122, v123, v216
    v_pk_mul_f32 v[128:129], v[128:129], v[40:41] op_sel:[0,1] op_sel_hi:[1,1]
    v_pk_mul_f32 v[130:131], v[130:131], v[40:41] op_sel:[0,1] op_sel_hi:[1,1]
    s_waitcnt lgkmcnt(0)
    s_barrier
    ds_read_b128 v[152:155], v6 offset:0
    ds_read_b128 v[156:159], v6 offset:16
    ds_read_b32 v14, v7 offset:0
    ds_read_b128 v[160:163], v6 offset:33792
    ds_read_b128 v[164:167], v6 offset:33808
    ds_read_b32 v15, v7 offset:1024
    ds_read_b128 v[168:171], v6 offset:2112
    ds_read_b128 v[172:175], v6 offset:2128
    ds_read_b32 v16, v7 offset:16
    ds_read_b128 v[176:179], v6 offset:35904
    ds_read_b128 v[180:183], v6 offset:35920
    ds_read_b32 v17, v7 offset:1040
    ds_read_b128 v[48:51], v252 offset:0
    ds_read_b128 v[52:55], v252 offset:16
    ds_read_b32 v24, v253 offset:0
    ds_read_b128 v[56:59], v252 offset:16896
    ds_read_b128 v[60:63], v252 offset:16912
    ds_read_b32 v25, v253 offset:512
    ds_read_b128 v[64:67], v252 offset:33792
    ds_read_b128 v[68:71], v252 offset:33808
    ds_read_b32 v26, v253 offset:1024
    ds_read_b128 v[72:75], v252 offset:50688
    ds_read_b128 v[76:79], v252 offset:50704
    ds_read_b32 v27, v253 offset:1536
    v_pk_mul_f32 v[132:133], v[132:133], v[40:41] op_sel:[0,1] op_sel_hi:[1,1]
    v_pk_mul_f32 v[134:135], v[134:135], v[40:41] op_sel:[0,1] op_sel_hi:[1,1]
    v_cvt_pk_bf16_f32 v128, v128, v129
    v_cvt_pk_bf16_f32 v129, v130, v131
    v_cvt_pk_bf16_f32 v130, v132, v133
    v_cvt_pk_bf16_f32 v131, v134, v135
    buffer_store_dwordx4 v[128:131], v1, s[20:23], s7 offen offset:1024 sc0 sc1
    v_pk_maximum3_f16 v216, v128, v129, v216
    v_pk_maximum3_f16 v216, v130, v131, v216
    v_pk_mul_f32 v[136:137], v[136:137], v[42:43] op_sel_hi:[1,0]
    v_pk_mul_f32 v[138:139], v[138:139], v[42:43] op_sel_hi:[1,0]
    v_pk_mul_f32 v[140:141], v[140:141], v[42:43] op_sel_hi:[1,0]
    v_pk_mul_f32 v[142:143], v[142:143], v[42:43] op_sel_hi:[1,0]
    v_cvt_pk_bf16_f32 v136, v136, v137
    v_cvt_pk_bf16_f32 v137, v138, v139
    v_cvt_pk_bf16_f32 v138, v140, v141
    v_cvt_pk_bf16_f32 v139, v142, v143
    v_pk_maximum3_f16 v216, v136, v137, v216
    v_pk_maximum3_f16 v216, v138, v139, v216
    v_pk_mul_f32 v[144:145], v[144:145], v[42:43] op_sel:[0,1] op_sel_hi:[1,1]
    v_pk_mul_f32 v[146:147], v[146:147], v[42:43] op_sel:[0,1] op_sel_hi:[1,1]
    v_pk_mul_f32 v[148:149], v[148:149], v[42:43] op_sel:[0,1] op_sel_hi:[1,1]
    v_pk_mul_f32 v[150:151], v[150:151], v[42:43] op_sel:[0,1] op_sel_hi:[1,1]
    v_cvt_pk_bf16_f32 v144, v144, v145
    buffer_store_dwordx4 v[136:139], v1, s[20:23], s7 offen offset:2048 sc0 sc1
    v_cvt_pk_bf16_f32 v145, v146, v147
    v_cvt_pk_bf16_f32 v146, v148, v149
    v_cvt_pk_bf16_f32 v147, v150, v151
    v_pk_maximum3_f16 v216, v144, v145, v216
    s_waitcnt lgkmcnt(12)
    v_pk_maximum3_f16 v216, v146, v147, v216
    v_add_f32 v14, v14, v15
    v_rcp_f32 v80, v14
    v_pk_add_f32 v[152:153], v[152:153], v[160:161]
    v_pk_add_f32 v[154:155], v[154:155], v[162:163]
    v_pk_add_f32 v[156:157], v[156:157], v[164:165]
    v_pk_add_f32 v[158:159], v[158:159], v[166:167]
    v_pk_mul_f32 v[152:153], v[152:153], v[80:81] op_sel_hi:[1,0]
    v_pk_mul_f32 v[154:155], v[154:155], v[80:81] op_sel_hi:[1,0]
    v_pk_mul_f32 v[156:157], v[156:157], v[80:81] op_sel_hi:[1,0]
    v_pk_mul_f32 v[158:159], v[158:159], v[80:81] op_sel_hi:[1,0]
    buffer_store_dwordx4 v[144:147], v1, s[20:23], s7 offen offset:3072 sc0 sc1
    v_cvt_pk_bf16_f32 v160, v152, v153
    v_cvt_pk_bf16_f32 v161, v154, v155
    v_cvt_pk_bf16_f32 v162, v156, v157
    v_cvt_pk_bf16_f32 v163, v158, v159
    v_pk_maximum3_f16 v216, v160, v161, v216
    v_pk_maximum3_f16 v216, v162, v163, v216
    v_add_f32 v16, v16, v17
    v_rcp_f32 v82, v16
    v_pk_add_f32 v[168:169], v[168:169], v[176:177]
    v_pk_add_f32 v[170:171], v[170:171], v[178:179]
    v_pk_add_f32 v[172:173], v[172:173], v[180:181]
    v_pk_add_f32 v[174:175], v[174:175], v[182:183]
    v_pk_mul_f32 v[168:169], v[168:169], v[82:83] op_sel_hi:[1,0]
    v_pk_mul_f32 v[170:171], v[170:171], v[82:83] op_sel_hi:[1,0]
    v_pk_mul_f32 v[172:173], v[172:173], v[82:83] op_sel_hi:[1,0]
    v_pk_mul_f32 v[174:175], v[174:175], v[82:83] op_sel_hi:[1,0]
    buffer_store_dwordx4 v[160:163], v1, s[20:23], s35 offen offset:0 sc0 sc1
    s_waitcnt lgkmcnt(0)
    v_cvt_pk_bf16_f32 v176, v168, v169
    v_cvt_pk_bf16_f32 v177, v170, v171
    v_cvt_pk_bf16_f32 v178, v172, v173
    v_cvt_pk_bf16_f32 v179, v174, v175
    v_pk_maximum3_f16 v216, v176, v177, v216
    v_pk_maximum3_f16 v216, v178, v179, v216
    v_add_f32 v24, v24, v25
    v_add_f32 v26, v26, v27
    v_add_f32 v24, v24, v26
    v_rcp_f32 v84, v24
    v_pk_add_f32 v[48:49], v[48:49], v[56:57]
    v_pk_add_f32 v[50:51], v[50:51], v[58:59]
    v_pk_add_f32 v[52:53], v[52:53], v[60:61]
    v_pk_add_f32 v[54:55], v[54:55], v[62:63]
    v_pk_add_f32 v[64:65], v[64:65], v[72:73]
    buffer_store_dwordx4 v[176:179], v1, s[20:23], s35 offen offset:1024 sc0 sc1
    v_pk_add_f32 v[66:67], v[66:67], v[74:75]
    v_pk_add_f32 v[68:69], v[68:69], v[76:77]
    v_pk_add_f32 v[70:71], v[70:71], v[78:79]
    v_pk_add_f32 v[48:49], v[48:49], v[64:65]
    v_pk_add_f32 v[50:51], v[50:51], v[66:67]
    v_pk_add_f32 v[52:53], v[52:53], v[68:69]
    v_pk_add_f32 v[54:55], v[54:55], v[70:71]
    v_pk_mul_f32 v[48:49], v[48:49], v[84:85] op_sel_hi:[1,0]
    v_pk_mul_f32 v[50:51], v[50:51], v[84:85] op_sel_hi:[1,0]
    v_pk_mul_f32 v[52:53], v[52:53], v[84:85] op_sel_hi:[1,0]
    v_pk_mul_f32 v[54:55], v[54:55], v[84:85] op_sel_hi:[1,0]
    v_cvt_pk_bf16_f32 v56, v48, v49
    v_cvt_pk_bf16_f32 v57, v50, v51
    v_cvt_pk_bf16_f32 v58, v52, v53
    v_cvt_pk_bf16_f32 v59, v54, v55
    v_pk_maximum3_f16 v216, v56, v57, v216
    v_pk_maximum3_f16 v216, v58, v59, v216
    buffer_store_dwordx4 v[56:59], v1, s[20:23], s41 offen offset:0 sc0 sc1
L_guard:
    s_cmp_eq_u32 s30, 1
    s_cbranch_scc1 L_done
    v_maximum3_f32 v217, v8, v9, v10
    v_maximum3_f32 v217, v11, v14, v217
    v_maximum3_f32 v217, v16, v24, v217
    v_mov_b32 v1, 0x5d800000
    v_cmp_nle_f32 vcc, v217, v1
    v_and_b32 v1, 0x7c007c00, v216
    v_add_u32 v1, 0x04000400, v1
    v_and_b32 v1, 0x80008000, v1
    v_cmp_ne_u32 s[36:37], 0, v1
    s_nop 3
    s_or_b64 vcc, vcc, s[36:37]
    s_lshl_b32 s31, s24, 2
    s_add_u32 s31, s31, 102400
    v_mov_b32 v6, s31
    s_nop 2
    s_cmp_lg_u64 vcc, 0
    s_cselect_b32 s32, 1, 0
    v_mov_b32 v7, s32
    ds_write_b32 v6, v7
    s_waitcnt lgkmcnt(0)
    s_barrier
    v_mov_b32 v6, 102400
    ds_read_b128 v[8:11], v6
    s_waitcnt lgkmcnt(0)
    v_or_b32 v8, v8, v9
    v_or3_b32 v8, v8, v10, v11
    s_nop 0
    v_readfirstlane_b32 s32, v8
    s_nop 3
    s_cmp_eq_u32 s32, 0
    s_cbranch_scc1 L_done
    s_mov_b32 s30, 1
    s_mov_b32 s10, 524288
    v_and_b32 v2, 15, v0
    v_lshrrev_b32 v3, 4, v0
    v_lshlrev_b32 v6, 4, v3
    v_lshl_add_u32 v4, v2, 8, v6
    s_waitcnt vmcnt(0)
    s_and_b32 s32, s34, 4096
    s_add_u32 s32, s32, 65536
    s_mov_b32 s33, 73728
    buffer_load_dwordx4 v[184:187], v4, s[16:19], s32 offen offset:0
    buffer_load_dwordx4 v[200:203], v4, s[16:19], s33 offen offset:0
    buffer_load_dwordx4 v[188:191], v4, s[16:19], s32 offen offset:64
    buffer_load_dwordx4 v[204:207], v4, s[16:19], s33 offen offset:64
    buffer_load_dwordx4 v[192:195], v4, s[16:19], s32 offen offset:128
    buffer_load_dwordx4 v[208:211], v4, s[16:19], s33 offen offset:128
    buffer_load_dwordx4 v[196:199], v4, s[16:19], s32 offen offset:192
    buffer_load_dwordx4 v[212:215], v4, s[16:19], s33 offen offset:192
    s_waitcnt vmcnt(0)
    v_lshlrev_b32 v120, 16, v184
    v_and_b32 v121, 0xffff0000, v184
    v_lshlrev_b32 v122, 16, v185
    v_and_b32 v123, 0xffff0000, v185
    v_lshlrev_b32 v124, 16, v186
    v_and_b32 v125, 0xffff0000, v186
    v_lshlrev_b32 v126, 16, v187
    v_and_b32 v127, 0xffff0000, v187
    v_pk_mul_f32 v[120:121], v[120:121], s[42:43]
    v_pk_mul_f32 v[122:123], v[122:123], s[42:43]
    v_pk_mul_f32 v[124:125], v[124:125], s[42:43]
    v_pk_mul_f32 v[126:127], v[126:127], s[42:43]
    v_cvt_pk_bf16_f32 v184, v120, v121
    v_cvt_pk_bf16_f32 v185, v122, v123
    v_cvt_pk_bf16_f32 v186, v124, v125
    v_cvt_pk_bf16_f32 v187, v126, v127
    v_lshlrev_b32 v80, 16, v188
    v_and_b32 v81, 0xffff0000, v188
    v_lshlrev_b32 v82, 16, v189
    v_and_b32 v83, 0xffff0000, v189
    v_lshlrev_b32 v84, 16, v190
    v_and_b32 v85, 0xffff0000, v190
    v_lshlrev_b32 v86, 16, v191
    v_and_b32 v87, 0xffff0000, v191
    v_pk_mul_f32 v[80:81], v[80:81], s[42:43]
    v_pk_mul_f32 v[82:83], v[82:83], s[42:43]
    v_pk_mul_f32 v[84:85], v[84:85], s[42:43]
    v_pk_mul_f32 v[86:87], v[86:87], s[42:43]
    v_cvt_pk_bf16_f32 v188, v80, v81
    v_cvt_pk_bf16_f32 v189, v82, v83
    v_cvt_pk_bf16_f32 v190, v84, v85
    v_cvt_pk_bf16_f32 v191, v86, v87
    v_lshlrev_b32 v120, 16, v192
    v_and_b32 v121, 0xffff0000, v192
    v_lshlrev_b32 v122, 16, v193
    v_and_b32 v123, 0xffff0000, v193
    v_lshlrev_b32 v124, 16, v194
    v_and_b32 v125, 0xffff0000, v194
    v_lshlrev_b32 v126, 16, v195
    v_and_b32 v127, 0xffff0000, v195
    v_pk_mul_f32 v[120:121], v[120:121], s[42:43]
    v_pk_mul_f32 v[122:123], v[122:123], s[42:43]
    v_pk_mul_f32 v[124:125], v[124:125], s[42:43]
    v_pk_mul_f32 v[126:127], v[126:127], s[42:43]
    v_cvt_pk_bf16_f32 v192, v120, v121
    v_cvt_pk_bf16_f32 v193, v122, v123
    v_cvt_pk_bf16_f32 v194, v124, v125
    v_cvt_pk_bf16_f32 v195, v126, v127
    v_lshlrev_b32 v80, 16, v196
    v_and_b32 v81, 0xffff0000, v196
    v_lshlrev_b32 v82, 16, v197
    v_and_b32 v83, 0xffff0000, v197
    v_lshlrev_b32 v84, 16, v198
    v_and_b32 v85, 0xffff0000, v198
    v_lshlrev_b32 v86, 16, v199
    v_and_b32 v87, 0xffff0000, v199
    v_pk_mul_f32 v[80:81], v[80:81], s[42:43]
    v_pk_mul_f32 v[82:83], v[82:83], s[42:43]
    v_pk_mul_f32 v[84:85], v[84:85], s[42:43]
    v_pk_mul_f32 v[86:87], v[86:87], s[42:43]
    v_cvt_pk_bf16_f32 v196, v80, v81
    v_cvt_pk_bf16_f32 v197, v82, v83
    v_cvt_pk_bf16_f32 v198, v84, v85
    v_cvt_pk_bf16_f32 v199, v86, v87
    v_lshlrev_b32 v120, 16, v200
    v_and_b32 v121, 0xffff0000, v200
    v_lshlrev_b32 v122, 16, v201
    v_and_b32 v123, 0xffff0000, v201
    v_lshlrev_b32 v124, 16, v202
    v_and_b32 v125, 0xffff0000, v202
    v_lshlrev_b32 v126, 16, v203
    v_and_b32 v127, 0xffff0000, v203
    v_pk_mul_f32 v[120:121], v[120:121], s[42:43]
    v_pk_mul_f32 v[122:123], v[122:123], s[42:43]
    v_pk_mul_f32 v[124:125], v[124:125], s[42:43]
    v_pk_mul_f32 v[126:127], v[126:127], s[42:43]
    v_cvt_pk_bf16_f32 v200, v120, v121
    v_cvt_pk_bf16_f32 v201, v122, v123
    v_cvt_pk_bf16_f32 v202, v124, v125
    v_cvt_pk_bf16_f32 v203, v126, v127
    v_lshlrev_b32 v80, 16, v204
    v_and_b32 v81, 0xffff0000, v204
    v_lshlrev_b32 v82, 16, v205
    v_and_b32 v83, 0xffff0000, v205
    v_lshlrev_b32 v84, 16, v206
    v_and_b32 v85, 0xffff0000, v206
    v_lshlrev_b32 v86, 16, v207
    v_and_b32 v87, 0xffff0000, v207
    v_pk_mul_f32 v[80:81], v[80:81], s[42:43]
    v_pk_mul_f32 v[82:83], v[82:83], s[42:43]
    v_pk_mul_f32 v[84:85], v[84:85], s[42:43]
    v_pk_mul_f32 v[86:87], v[86:87], s[42:43]
    v_cvt_pk_bf16_f32 v204, v80, v81
    v_cvt_pk_bf16_f32 v205, v82, v83
    v_cvt_pk_bf16_f32 v206, v84, v85
    v_cvt_pk_bf16_f32 v207, v86, v87
    v_lshlrev_b32 v120, 16, v208
    v_and_b32 v121, 0xffff0000, v208
    v_lshlrev_b32 v122, 16, v209
    v_and_b32 v123, 0xffff0000, v209
    v_lshlrev_b32 v124, 16, v210
    v_and_b32 v125, 0xffff0000, v210
    v_lshlrev_b32 v126, 16, v211
    v_and_b32 v127, 0xffff0000, v211
    v_pk_mul_f32 v[120:121], v[120:121], s[42:43]
    v_pk_mul_f32 v[122:123], v[122:123], s[42:43]
    v_pk_mul_f32 v[124:125], v[124:125], s[42:43]
    v_pk_mul_f32 v[126:127], v[126:127], s[42:43]
    v_cvt_pk_bf16_f32 v208, v120, v121
    v_cvt_pk_bf16_f32 v209, v122, v123
    v_cvt_pk_bf16_f32 v210, v124, v125
    v_cvt_pk_bf16_f32 v211, v126, v127
    v_lshlrev_b32 v80, 16, v212
    v_and_b32 v81, 0xffff0000, v212
    v_lshlrev_b32 v82, 16, v213
    v_and_b32 v83, 0xffff0000, v213
    v_lshlrev_b32 v84, 16, v214
    v_and_b32 v85, 0xffff0000, v214
    v_lshlrev_b32 v86, 16, v215
    v_and_b32 v87, 0xffff0000, v215
    v_pk_mul_f32 v[80:81], v[80:81], s[42:43]
    v_pk_mul_f32 v[82:83], v[82:83], s[42:43]
    v_pk_mul_f32 v[84:85], v[84:85], s[42:43]
    v_pk_mul_f32 v[86:87], v[86:87], s[42:43]
    v_cvt_pk_bf16_f32 v212, v80, v81
    v_cvt_pk_bf16_f32 v213, v82, v83
    v_cvt_pk_bf16_f32 v214, v84, v85
    v_cvt_pk_bf16_f32 v215, v86, v87
    v_mov_b32 v128, 0xff7fffff
    v_mov_b32 v132, 0xff7fffff
    v_mov_b32 v136, 0xff7fffff
    v_mov_b32 v140, 0xff7fffff
    v_mov_b32 v144, 0xff7fffff
    v_mov_b32 v148, 0xff7fffff
    s_mov_b32 s33, 0
L_mx:
    buffer_load_dwordx4 v[152:155], v4, s[8:11], s33 offen offset:0
    buffer_load_dwordx4 v[156:159], v4, s[8:11], s33 offen offset:64
    buffer_load_dwordx4 v[160:163], v4, s[8:11], s33 offen offset:128
    buffer_load_dwordx4 v[164:167], v4, s[8:11], s33 offen offset:192
    s_waitcnt vmcnt(0)
    v_mfma_f32_16x16x32_bf16 v[8:11], v[152:155], a[192:195], 0
    v_mfma_f32_16x16x32_bf16 v[8:11], v[156:159], a[196:199], v[8:11]
    v_mfma_f32_16x16x32_bf16 v[8:11], v[160:163], a[200:203], v[8:11]
    v_mfma_f32_16x16x32_bf16 v[8:11], v[164:167], a[204:207], v[8:11]
    v_mfma_f32_16x16x32_bf16 v[12:15], v[152:155], a[208:211], 0
    v_mfma_f32_16x16x32_bf16 v[12:15], v[156:159], a[212:215], v[12:15]
    v_mfma_f32_16x16x32_bf16 v[12:15], v[160:163], a[216:219], v[12:15]
    v_mfma_f32_16x16x32_bf16 v[12:15], v[164:167], a[220:223], v[12:15]
    v_mfma_f32_16x16x32_bf16 v[16:19], v[152:155], a[224:227], 0
    v_mfma_f32_16x16x32_bf16 v[16:19], v[156:159], a[228:231], v[16:19]
    v_mfma_f32_16x16x32_bf16 v[16:19], v[160:163], a[232:235], v[16:19]
    v_mfma_f32_16x16x32_bf16 v[16:19], v[164:167], a[236:239], v[16:19]
    v_mfma_f32_16x16x32_bf16 v[20:23], v[152:155], a[240:243], 0
    v_mfma_f32_16x16x32_bf16 v[20:23], v[156:159], a[244:247], v[20:23]
    v_mfma_f32_16x16x32_bf16 v[20:23], v[160:163], a[248:251], v[20:23]
    v_mfma_f32_16x16x32_bf16 v[20:23], v[164:167], a[252:255], v[20:23]
    v_mfma_f32_16x16x32_bf16 v[24:27], v[152:155], v[184:187], 0
    v_mfma_f32_16x16x32_bf16 v[24:27], v[156:159], v[188:191], v[24:27]
    v_mfma_f32_16x16x32_bf16 v[24:27], v[160:163], v[192:195], v[24:27]
    v_mfma_f32_16x16x32_bf16 v[24:27], v[164:167], v[196:199], v[24:27]
    v_mfma_f32_16x16x32_bf16 v[44:47], v[152:155], v[200:203], 0
    v_mfma_f32_16x16x32_bf16 v[44:47], v[156:159], v[204:207], v[44:47]
    v_mfma_f32_16x16x32_bf16 v[44:47], v[160:163], v[208:211], v[44:47]
    v_mfma_f32_16x16x32_bf16 v[44:47], v[164:167], v[212:215], v[44:47]
    s_nop 15
    v_max3_f32 v128, v8, v9, v128
    v_max3_f32 v128, v10, v11, v128
    v_max3_f32 v132, v12, v13, v132
    v_max3_f32 v132, v14, v15, v132
    v_max3_f32 v136, v16, v17, v136
    v_max3_f32 v136, v18, v19, v136
    v_max3_f32 v140, v20, v21, v140
    v_max3_f32 v140, v22, v23, v140
    v_max3_f32 v144, v24, v25, v144
    v_max3_f32 v144, v26, v27, v144
    v_max3_f32 v148, v44, v45, v148
    v_max3_f32 v148, v46, v47, v148
    s_add_u32 s33, s33, 4096
    s_cmp_lt_u32 s33, 524288
    s_cbranch_scc1 L_mx
    s_waitcnt vmcnt(0) lgkmcnt(0)
    s_barrier
    s_branch L_restart
L_done:
L_end:
    s_endpgm
L_loops:
.p2align 6
L_loop0:
    v_mfma_f32_16x16x32_bf16 v[8:11], v[152:155], a[192:195], v[128:131]
    v_exp_f32 v42, v42
    v_mfma_f32_16x16x32_bf16 v[8:11], v[156:159], a[196:199], v[8:11]
    s_waitcnt lgkmcnt(0)
    v_exp_f32 v43, v43
    v_mfma_f32_16x16x32_bf16 v[8:11], v[160:163], a[200:203], v[8:11]
    s_mov_b32 m0, s28
    v_add_f32 v237, v41, v237
    v_cvt_pk_bf16_f32 v78, v40, v41
    v_mfma_f32_16x16x32_bf16 v[8:11], v[164:167], a[204:207], v[8:11]
    buffer_load_dwordx4 v228, s[8:11], s26 offen offset:0 nt lds
    v_mfma_f32_16x16x32_bf16 v[12:15], v[164:167], a[220:223], v[132:135]
    ds_read_b128 v[168:171], v216 offset:4096
    v_add_f32 v237, v42, v237
    v_mfma_f32_16x16x32_bf16 v[12:15], v[160:163], a[216:219], v[12:15]
    v_exp_f32 v44, v44
    v_mfma_f32_16x16x32_bf16 v[12:15], v[156:159], a[212:215], v[12:15]
    ds_read_b128 v[172:175], v217 offset:4096
    v_add_f32 v237, v43, v237
    v_mfma_f32_16x16x32_bf16 v[12:15], v[152:155], a[208:211], v[12:15]
    v_exp_f32 v45, v45
    v_mfma_f32_16x16x32_bf16 v[16:19], v[152:155], a[224:227], v[136:139]
    ds_read_b128 v[176:179], v218 offset:4096
    v_cvt_pk_bf16_f32 v79, v42, v43
    v_mfma_f32_16x16x32_bf16 v[16:19], v[156:159], a[228:231], v[16:19]
    v_exp_f32 v46, v46
    v_mfma_f32_16x16x32_bf16 v[16:19], v[160:163], a[232:235], v[16:19]
    ds_read_b128 v[180:183], v219 offset:4096
    v_add_f32 v238, v44, v238
    v_mfma_f32_16x16x32_bf16 v[16:19], v[164:167], a[236:239], v[16:19]
    v_exp_f32 v47, v47
    v_mfma_f32_16x16x32_bf16 v[20:23], v[164:167], a[252:255], v[140:143]
    v_exp_f32 v8, v8
    v_mfma_f32_16x16x32_bf16 v[20:23], v[160:163], a[248:251], v[20:23]
    v_add_f32 v238, v45, v238
    v_cvt_pk_bf16_f32 v86, v44, v45
    v_mfma_f32_16x16x32_bf16 v[20:23], v[156:159], a[244:247], v[20:23]
    v_exp_f32 v9, v9
    v_mfma_f32_16x16x32_bf16 v[20:23], v[152:155], a[240:243], v[20:23]
    v_add_f32 v238, v46, v238
    v_add_f32 v238, v47, v238
    v_mfma_f32_16x16x32_bf16 v[24:27], v[152:155], v[200:203], v[148:151]
    v_exp_f32 v10, v10
    v_mfma_f32_16x16x32_bf16 v[24:27], v[156:159], v[204:207], v[24:27]
    v_cvt_pk_bf16_f32 v87, v46, v47
    v_cvt_pk_bf16_f32 v88, v8, v9
    v_mfma_f32_16x16x32_bf16 v[24:27], v[160:163], v[208:211], v[24:27]
    buffer_load_dwordx4 v229, s[8:11], s26 offen offset:1024 nt lds
    v_mfma_f32_16x16x32_bf16 v[24:27], v[164:167], v[212:215], v[24:27]
    s_waitcnt lgkmcnt(2)
    v_exp_f32 v11, v11
    v_mfma_f32_16x16x32_bf16 v[28:31], v[168:171], a[192:195], v[128:131]
    v_exp_f32 v12, v12
    v_mfma_f32_16x16x32_bf16 v[28:31], v[172:175], a[196:199], v[28:31]
    s_waitcnt lgkmcnt(0)
    v_cvt_pk_bf16_f32 v89, v10, v11
    v_mfma_f32_16x16x32_bf16 v[28:31], v[176:179], a[200:203], v[28:31]
    v_exp_f32 v13, v13
    v_mfma_f32_16x16x32_bf16 v[28:31], v[180:183], a[204:207], v[28:31]
    v_cvt_pk_bf16_f32 v96, v12, v13
    v_mfma_f32_16x16x32_bf16 v[32:35], v[180:183], a[220:223], v[132:135]
    ds_read_b64_tr_b16 v[152:153], v220 offset:16384
    v_mfma_f32_16x16x32_bf16 v[32:35], v[176:179], a[216:219], v[32:35]
    v_exp_f32 v14, v14
    v_mfma_f32_16x16x32_bf16 v[32:35], v[172:175], a[212:215], v[32:35]
    ds_read_b64_tr_b16 v[154:155], v220 offset:20480
    v_mfma_f32_16x16x32_bf16 v[32:35], v[168:171], a[208:211], v[32:35]
    v_exp_f32 v15, v15
    v_mfma_f32_16x16x32_bf16 v[36:39], v[168:171], a[224:227], v[136:139]
    ds_read_b64_tr_b16 v[156:157], v220 offset:24576
    v_cvt_pk_bf16_f32 v97, v14, v15
    v_mfma_f32_16x16x32_bf16 v[36:39], v[172:175], a[228:231], v[36:39]
    v_exp_f32 v16, v16
    v_mfma_f32_16x16x32_bf16 v[36:39], v[176:179], a[232:235], v[36:39]
    ds_read_b64_tr_b16 v[158:159], v220 offset:28672
    v_add_f32 v236, v16, v236
    v_mfma_f32_16x16x32_bf16 v[36:39], v[180:183], a[236:239], v[36:39]
    v_exp_f32 v17, v17
    v_mfma_f32_16x16x32_bf16 v[40:43], v[180:183], a[252:255], v[140:143]
    v_exp_f32 v18, v18
    v_mfma_f32_16x16x32_bf16 v[40:43], v[176:179], a[248:251], v[40:43]
    v_add_f32 v236, v17, v236
    v_cvt_pk_bf16_f32 v104, v16, v17
    v_mfma_f32_16x16x32_bf16 v[40:43], v[172:175], a[244:247], v[40:43]
    buffer_load_dwordx4 v230, s[8:11], s26 offen offset:2048 nt lds
    v_mfma_f32_16x16x32_bf16 v[40:43], v[168:171], a[240:243], v[40:43]
    ds_read_b64_tr_b16 v[160:161], v221 offset:16384
    v_add_f32 v236, v18, v236
    v_mfma_f32_16x16x32_bf16 v[44:47], v[168:171], v[200:203], v[148:151]
    v_exp_f32 v19, v19
    v_mfma_f32_16x16x32_bf16 v[44:47], v[172:175], v[204:207], v[44:47]
    ds_read_b64_tr_b16 v[162:163], v221 offset:20480
    v_add_f32 v236, v19, v236
    v_mfma_f32_16x16x32_bf16 v[44:47], v[176:179], v[208:211], v[44:47]
    v_exp_f32 v20, v20
    v_mfma_f32_16x16x32_bf16 v[44:47], v[180:183], v[212:215], v[44:47]
    s_waitcnt lgkmcnt(2)
    ds_read_b64_tr_b16 v[164:165], v221 offset:24576
    v_cvt_pk_bf16_f32 v105, v18, v19
    v_mfma_f32_16x16x32_bf16 a[0:3], v[48:51], v[152:155], a[0:3]
    v_exp_f32 v21, v21
    v_mfma_f32_16x16x32_bf16 a[0:3], v[52:55], v[156:159], a[0:3]
    ds_read_b64_tr_b16 v[166:167], v221 offset:28672
    v_add_f32 v237, v20, v237
    v_mfma_f32_16x16x32_bf16 a[32:35], v[60:63], v[156:159], a[32:35]
    v_exp_f32 v22, v22
    v_mfma_f32_16x16x32_bf16 a[32:35], v[56:59], v[152:155], a[32:35]
    v_exp_f32 v23, v23
    v_mfma_f32_16x16x32_bf16 a[64:67], v[64:67], v[152:155], a[64:67]
    v_exp_f32 v24, v24
    v_mfma_f32_16x16x32_bf16 a[64:67], v[68:71], v[156:159], a[64:67]
    v_add_f32 v237, v21, v237
    v_cvt_pk_bf16_f32 v112, v20, v21
    v_mfma_f32_16x16x32_bf16 a[96:99], v[76:79], v[156:159], a[96:99]
    ds_read_b64_tr_b16 v[168:169], v222 offset:16384
    v_add_f32 v237, v22, v237
    v_mfma_f32_16x16x32_bf16 a[96:99], v[72:75], v[152:155], a[96:99]
    v_exp_f32 v25, v25
    v_mfma_f32_16x16x32_bf16 a[128:131], v[80:83], v[152:155], a[128:131]
    ds_read_b64_tr_b16 v[170:171], v222 offset:20480
    v_add_f32 v237, v23, v237
    v_mfma_f32_16x16x32_bf16 a[128:131], v[84:87], v[156:159], a[128:131]
    s_waitcnt lgkmcnt(2)
    buffer_load_dwordx4 v231, s[8:11], s26 offen offset:3072 nt lds
    v_mfma_f32_16x16x32_bf16 a[132:135], v[84:87], v[164:167], a[132:135]
    s_add_u32 s28, s28, 32768
    ds_read_b64_tr_b16 v[172:173], v222 offset:24576
    v_cvt_pk_bf16_f32 v113, v22, v23
    v_mfma_f32_16x16x32_bf16 a[132:135], v[80:83], v[160:163], a[132:135]
    s_and_b32 s28, s28, 131071
    v_exp_f32 v26, v26
    v_mfma_f32_16x16x32_bf16 a[100:103], v[72:75], v[160:163], a[100:103]
    s_add_u32 s26, s26, 16384
    ds_read_b64_tr_b16 v[174:175], v222 offset:28672
    v_add_f32 v239, v24, v239
    v_mfma_f32_16x16x32_bf16 a[100:103], v[76:79], v[164:167], a[100:103]
    s_cmp_lt_u32 s26, 524288
    v_exp_f32 v27, v27
    v_mfma_f32_16x16x32_bf16 a[68:71], v[68:71], v[164:167], a[68:71]
    s_cselect_b32 s10, 524288, 0
    v_exp_f32 v28, v28
    v_mfma_f32_16x16x32_bf16 a[68:71], v[64:67], v[160:163], a[68:71]
    v_exp_f32 v29, v29
    v_mfma_f32_16x16x32_bf16 a[36:39], v[56:59], v[160:163], a[36:39]
    v_add_f32 v239, v25, v239
    v_cvt_pk_bf16_f32 v120, v24, v25
    v_mfma_f32_16x16x32_bf16 a[36:39], v[60:63], v[164:167], a[36:39]
    ds_read_b64_tr_b16 v[176:177], v223 offset:16384
    v_add_f32 v239, v26, v239
    v_mfma_f32_16x16x32_bf16 a[4:7], v[52:55], v[164:167], a[4:7]
    v_exp_f32 v30, v30
    v_mfma_f32_16x16x32_bf16 a[4:7], v[48:51], v[160:163], a[4:7]
    ds_read_b64_tr_b16 v[178:179], v223 offset:20480
    v_add_f32 v239, v27, v239
    v_mfma_f32_16x16x32_bf16 v[244:247], v[240:243], v[48:51], v[244:247]
    v_exp_f32 v31, v31
    v_mfma_f32_16x16x32_bf16 v[244:247], v[240:243], v[52:55], v[244:247]
    s_waitcnt lgkmcnt(2)
    ds_read_b64_tr_b16 v[180:181], v223 offset:24576
    v_cvt_pk_bf16_f32 v121, v26, v27
    v_mfma_f32_16x16x32_bf16 a[8:11], v[48:51], v[168:171], a[8:11]
    v_exp_f32 v32, v32
    v_mfma_f32_16x16x32_bf16 a[8:11], v[52:55], v[172:175], a[8:11]
    ds_read_b64_tr_b16 v[182:183], v223 offset:28672
    v_cvt_pk_bf16_f32 v90, v28, v29
    v_mfma_f32_16x16x32_bf16 a[40:43], v[60:63], v[172:175], a[40:43]
    s_mov_b32 m0, s29
    v_exp_f32 v33, v33
    v_mfma_f32_16x16x32_bf16 a[40:43], v[56:59], v[168:171], a[40:43]
    buffer_load_dwordx4 v232, s[12:15], s27 offen offset:0 nt lds
    v_mfma_f32_16x16x32_bf16 a[72:75], v[64:67], v[168:171], a[72:75]
    ds_read_b128 v[152:155], v216 offset:8192
    v_cvt_pk_bf16_f32 v91, v30, v31
    v_mfma_f32_16x16x32_bf16 a[72:75], v[68:71], v[172:175], a[72:75]
    v_exp_f32 v34, v34
    v_mfma_f32_16x16x32_bf16 a[104:107], v[76:79], v[172:175], a[104:107]
    ds_read_b128 v[156:159], v217 offset:8192
    v_cvt_pk_bf16_f32 v98, v32, v33
    v_mfma_f32_16x16x32_bf16 a[104:107], v[72:75], v[168:171], a[104:107]
    v_exp_f32 v35, v35
    v_mfma_f32_16x16x32_bf16 a[136:139], v[80:83], v[168:171], a[136:139]
    ds_read_b128 v[160:163], v218 offset:8192
    v_cvt_pk_bf16_f32 v99, v34, v35
    v_mfma_f32_16x16x32_bf16 a[136:139], v[84:87], v[172:175], a[136:139]
    s_waitcnt lgkmcnt(3)
    v_exp_f32 v36, v36
    v_mfma_f32_16x16x32_bf16 a[140:143], v[84:87], v[180:183], a[140:143]
    ds_read_b128 v[164:167], v219 offset:8192
    v_add_f32 v236, v36, v236
    v_mfma_f32_16x16x32_bf16 a[140:143], v[80:83], v[176:179], a[140:143]
    v_exp_f32 v37, v37
    v_mfma_f32_16x16x32_bf16 a[108:111], v[72:75], v[176:179], a[108:111]
    v_exp_f32 v38, v38
    v_mfma_f32_16x16x32_bf16 a[108:111], v[76:79], v[180:183], a[108:111]
    v_exp_f32 v39, v39
    v_mfma_f32_16x16x32_bf16 a[76:79], v[68:71], v[180:183], a[76:79]
    v_add_f32 v236, v37, v236
    v_cvt_pk_bf16_f32 v106, v36, v37
    v_mfma_f32_16x16x32_bf16 a[76:79], v[64:67], v[176:179], a[76:79]
    v_exp_f32 v40, v40
    v_mfma_f32_16x16x32_bf16 a[44:47], v[56:59], v[176:179], a[44:47]
    v_add_f32 v236, v38, v236
    v_add_f32 v236, v39, v236
    v_mfma_f32_16x16x32_bf16 a[44:47], v[60:63], v[180:183], a[44:47]
    v_exp_f32 v41, v41
    v_mfma_f32_16x16x32_bf16 a[12:15], v[52:55], v[180:183], a[12:15]
    buffer_load_dwordx4 v233, s[12:15], s27 offen offset:1024 nt lds
    v_mfma_f32_16x16x32_bf16 a[12:15], v[48:51], v[176:179], a[12:15]
    s_waitcnt lgkmcnt(2)
    v_exp_f32 v42, v42
    v_mfma_f32_16x16x32_bf16 v[8:11], v[152:155], a[192:195], v[128:131]
    ds_read_b128 v[168:171], v216 offset:12288
    v_cvt_pk_bf16_f32 v107, v38, v39
    v_mfma_f32_16x16x32_bf16 v[8:11], v[156:159], a[196:199], v[8:11]
    s_waitcnt lgkmcnt(1)
    v_exp_f32 v43, v43
    v_mfma_f32_16x16x32_bf16 v[8:11], v[160:163], a[200:203], v[8:11]
    ds_read_b128 v[172:175], v217 offset:12288
    v_add_f32 v237, v40, v237
    v_mfma_f32_16x16x32_bf16 v[8:11], v[164:167], a[204:207], v[8:11]
    v_exp_f32 v44, v44
    v_mfma_f32_16x16x32_bf16 v[12:15], v[164:167], a[220:223], v[132:135]
    ds_read_b128 v[176:179], v218 offset:12288
    v_add_f32 v237, v41, v237
    v_mfma_f32_16x16x32_bf16 v[12:15], v[160:163], a[216:219], v[12:15]
    v_exp_f32 v45, v45
    v_mfma_f32_16x16x32_bf16 v[12:15], v[156:159], a[212:215], v[12:15]
    ds_read_b128 v[180:183], v219 offset:12288
    v_cvt_pk_bf16_f32 v114, v40, v41
    v_mfma_f32_16x16x32_bf16 v[12:15], v[152:155], a[208:211], v[12:15]
    v_add_f32 v237, v42, v237
    v_add_f32 v237, v43, v237
    v_mfma_f32_16x16x32_bf16 v[16:19], v[152:155], a[224:227], v[136:139]
    v_exp_f32 v46, v46
    v_mfma_f32_16x16x32_bf16 v[16:19], v[156:159], a[228:231], v[16:19]
    v_cvt_pk_bf16_f32 v115, v42, v43
    v_add_f32 v239, v44, v239
    v_mfma_f32_16x16x32_bf16 v[16:19], v[160:163], a[232:235], v[16:19]
    v_exp_f32 v47, v47
    v_mfma_f32_16x16x32_bf16 v[16:19], v[164:167], a[236:239], v[16:19]
    v_add_f32 v239, v45, v239
    v_cvt_pk_bf16_f32 v122, v44, v45
    v_mfma_f32_16x16x32_bf16 v[20:23], v[164:167], a[252:255], v[140:143]
    v_exp_f32 v8, v8
    v_mfma_f32_16x16x32_bf16 v[20:23], v[160:163], a[248:251], v[20:23]
    v_add_f32 v239, v46, v239
    v_add_f32 v239, v47, v239
    v_mfma_f32_16x16x32_bf16 v[20:23], v[156:159], a[244:247], v[20:23]
    buffer_load_dwordx4 v232, s[12:15], s27 offen offset:2048 nt lds
    v_mfma_f32_16x16x32_bf16 v[20:23], v[152:155], a[240:243], v[20:23]
    s_waitcnt lgkmcnt(2)
    v_exp_f32 v9, v9
    v_mfma_f32_16x16x32_bf16 v[28:31], v[168:171], a[192:195], v[128:131]
    ds_read_b64_tr_b16 v[152:153], v224 offset:16384
    v_cvt_pk_bf16_f32 v123, v46, v47
    v_mfma_f32_16x16x32_bf16 v[28:31], v[172:175], a[196:199], v[28:31]
    s_waitcnt lgkmcnt(1)
    v_exp_f32 v10, v10
    v_mfma_f32_16x16x32_bf16 v[28:31], v[176:179], a[200:203], v[28:31]
    ds_read_b64_tr_b16 v[154:155], v224 offset:20480
    v_cvt_pk_bf16_f32 v92, v8, v9
    v_mfma_f32_16x16x32_bf16 v[28:31], v[180:183], a[204:207], v[28:31]
    v_exp_f32 v11, v11
    v_mfma_f32_16x16x32_bf16 v[32:35], v[180:183], a[220:223], v[132:135]
    ds_read_b64_tr_b16 v[156:157], v224 offset:24576
    v_cvt_pk_bf16_f32 v93, v10, v11
    v_mfma_f32_16x16x32_bf16 v[32:35], v[176:179], a[216:219], v[32:35]
    v_exp_f32 v12, v12
    v_mfma_f32_16x16x32_bf16 v[32:35], v[172:175], a[212:215], v[32:35]
    ds_read_b64_tr_b16 v[158:159], v224 offset:28672
    v_mfma_f32_16x16x32_bf16 v[32:35], v[168:171], a[208:211], v[32:35]
    v_exp_f32 v13, v13
    v_mfma_f32_16x16x32_bf16 v[36:39], v[168:171], a[224:227], v[136:139]
    v_exp_f32 v14, v14
    v_mfma_f32_16x16x32_bf16 v[36:39], v[172:175], a[228:231], v[36:39]
    v_cvt_pk_bf16_f32 v100, v12, v13
    v_mfma_f32_16x16x32_bf16 v[36:39], v[176:179], a[232:235], v[36:39]
    v_exp_f32 v15, v15
    v_mfma_f32_16x16x32_bf16 v[36:39], v[180:183], a[236:239], v[36:39]
    ds_read_b64_tr_b16 v[160:161], v225 offset:16384
    v_cvt_pk_bf16_f32 v101, v14, v15
    v_mfma_f32_16x16x32_bf16 v[40:43], v[180:183], a[252:255], v[140:143]
    v_exp_f32 v16, v16
    v_mfma_f32_16x16x32_bf16 v[40:43], v[176:179], a[248:251], v[40:43]
    ds_read_b64_tr_b16 v[162:163], v225 offset:20480
    v_add_f32 v236, v16, v236
    v_mfma_f32_16x16x32_bf16 v[40:43], v[172:175], a[244:247], v[40:43]
    buffer_load_dwordx4 v233, s[12:15], s27 offen offset:3072 nt lds
    v_mfma_f32_16x16x32_bf16 v[40:43], v[168:171], a[240:243], v[40:43]
    s_waitcnt lgkmcnt(2)
    ds_read_b64_tr_b16 v[164:165], v225 offset:24576
    v_mfma_f32_16x16x32_bf16 a[16:19], v[48:51], v[152:155], a[16:19]
    s_add_u32 s29, s29, 32768
    v_exp_f32 v17, v17
    v_mfma_f32_16x16x32_bf16 a[16:19], v[52:55], v[156:159], a[16:19]
    s_and_b32 s29, s29, 131071
    ds_read_b64_tr_b16 v[166:167], v225 offset:28672
    v_add_f32 v236, v17, v236
    v_mfma_f32_16x16x32_bf16 a[48:51], v[60:63], v[156:159], a[48:51]
    s_add_u32 s27, s27, 16384
    ds_read_b64_tr_b16 v[168:169], v226 offset:16384
    v_cvt_pk_bf16_f32 v108, v16, v17
    v_mfma_f32_16x16x32_bf16 a[48:51], v[56:59], v[152:155], a[48:51]
    s_cmp_lt_u32 s27, 524288
    v_exp_f32 v18, v18
    v_mfma_f32_16x16x32_bf16 a[80:83], v[64:67], v[152:155], a[80:83]
    s_cselect_b32 s14, 524288, 0
    ds_read_b64_tr_b16 v[170:171], v226 offset:20480
    v_add_f32 v236, v18, v236
    v_mfma_f32_16x16x32_bf16 a[80:83], v[68:71], v[156:159], a[80:83]
    v_exp_f32 v19, v19
    v_mfma_f32_16x16x32_bf16 a[112:115], v[76:79], v[156:159], a[112:115]
    ds_read_b64_tr_b16 v[172:173], v226 offset:24576
    v_add_f32 v236, v19, v236
    v_mfma_f32_16x16x32_bf16 a[112:115], v[72:75], v[152:155], a[112:115]
    v_exp_f32 v20, v20
    v_mfma_f32_16x16x32_bf16 a[144:147], v[80:83], v[152:155], a[144:147]
    ds_read_b64_tr_b16 v[174:175], v226 offset:28672
    v_cvt_pk_bf16_f32 v109, v18, v19
    v_mfma_f32_16x16x32_bf16 a[144:147], v[84:87], v[156:159], a[144:147]
    s_waitcnt lgkmcnt(4)
    v_exp_f32 v21, v21
    v_mfma_f32_16x16x32_bf16 a[148:151], v[84:87], v[164:167], a[148:151]
    ds_read_b64_tr_b16 v[176:177], v227 offset:16384
    v_add_f32 v237, v20, v237
    v_mfma_f32_16x16x32_bf16 a[148:151], v[80:83], v[160:163], a[148:151]
    v_exp_f32 v22, v22
    v_mfma_f32_16x16x32_bf16 a[116:119], v[72:75], v[160:163], a[116:119]
    ds_read_b64_tr_b16 v[178:179], v227 offset:20480
    v_add_f32 v237, v21, v237
    v_mfma_f32_16x16x32_bf16 a[116:119], v[76:79], v[164:167], a[116:119]
    v_exp_f32 v23, v23
    v_mfma_f32_16x16x32_bf16 a[84:87], v[68:71], v[164:167], a[84:87]
    ds_read_b64_tr_b16 v[180:181], v227 offset:24576
    v_cvt_pk_bf16_f32 v116, v20, v21
    v_mfma_f32_16x16x32_bf16 a[84:87], v[64:67], v[160:163], a[84:87]
    v_exp_f32 v28, v28
    v_mfma_f32_16x16x32_bf16 a[52:55], v[56:59], v[160:163], a[52:55]
    ds_read_b64_tr_b16 v[182:183], v227 offset:28672
    v_add_f32 v237, v22, v237
    v_mfma_f32_16x16x32_bf16 a[52:55], v[60:63], v[164:167], a[52:55]
    v_exp_f32 v29, v29
    v_mfma_f32_16x16x32_bf16 a[20:23], v[52:55], v[164:167], a[20:23]
    v_exp_f32 v30, v30
    v_mfma_f32_16x16x32_bf16 a[20:23], v[48:51], v[160:163], a[20:23]
    v_exp_f32 v31, v31
    v_mfma_f32_16x16x32_bf16 v[248:251], v[240:243], v[56:59], v[248:251]
    v_add_f32 v237, v23, v237
    v_cvt_pk_bf16_f32 v117, v22, v23
    v_mfma_f32_16x16x32_bf16 v[248:251], v[240:243], v[60:63], v[248:251]
    s_waitcnt lgkmcnt(4)
    v_exp_f32 v32, v32
    v_mfma_f32_16x16x32_bf16 a[24:27], v[48:51], v[168:171], a[24:27]
    v_cvt_pk_bf16_f32 v94, v28, v29
    v_cvt_pk_bf16_f32 v95, v30, v31
    v_mfma_f32_16x16x32_bf16 a[24:27], v[52:55], v[172:175], a[24:27]
    s_waitcnt vmcnt(8) lgkmcnt(0)
    v_exp_f32 v33, v33
    v_mfma_f32_16x16x32_bf16 a[56:59], v[60:63], v[172:175], a[56:59]
    s_barrier
    v_mfma_f32_16x16x32_bf16 a[56:59], v[56:59], v[168:171], a[56:59]
    v_exp_f32 v34, v34
    v_mfma_f32_16x16x32_bf16 a[88:91], v[64:67], v[168:171], a[88:91]
    ds_read_b128 v[152:155], v216 offset:32768
    v_cvt_pk_bf16_f32 v102, v32, v33
    v_mfma_f32_16x16x32_bf16 a[88:91], v[68:71], v[172:175], a[88:91]
    v_exp_f32 v35, v35
    v_mfma_f32_16x16x32_bf16 a[120:123], v[76:79], v[172:175], a[120:123]
    ds_read_b128 v[156:159], v217 offset:32768
    v_cvt_pk_bf16_f32 v103, v34, v35
    v_mfma_f32_16x16x32_bf16 a[120:123], v[72:75], v[168:171], a[120:123]
    v_exp_f32 v36, v36
    v_mfma_f32_16x16x32_bf16 a[152:155], v[80:83], v[168:171], a[152:155]
    ds_read_b128 v[160:163], v218 offset:32768
    v_add_f32 v236, v36, v236
    v_mfma_f32_16x16x32_bf16 a[152:155], v[84:87], v[172:175], a[152:155]
    v_exp_f32 v37, v37
    v_mfma_f32_16x16x32_bf16 a[156:159], v[84:87], v[180:183], a[156:159]
    ds_read_b128 v[164:167], v219 offset:32768
    v_add_f32 v236, v37, v236
    v_mfma_f32_16x16x32_bf16 a[156:159], v[80:83], v[176:179], a[156:159]
    v_exp_f32 v38, v38
    v_mfma_f32_16x16x32_bf16 a[124:127], v[72:75], v[176:179], a[124:127]
    v_cvt_pk_bf16_f32 v110, v36, v37
    v_add_f32 v236, v38, v236
    v_mfma_f32_16x16x32_bf16 a[124:127], v[76:79], v[180:183], a[124:127]
    v_exp_f32 v39, v39
    v_mfma_f32_16x16x32_bf16 a[92:95], v[68:71], v[180:183], a[92:95]
    v_add_f32 v236, v39, v236
    v_cvt_pk_bf16_f32 v111, v38, v39
    v_mfma_f32_16x16x32_bf16 a[92:95], v[64:67], v[176:179], a[92:95]
    v_exp_f32 v40, v40
    v_mfma_f32_16x16x32_bf16 a[60:63], v[56:59], v[176:179], a[60:63]
    v_add_f32 v237, v40, v237
    v_mfma_f32_16x16x32_bf16 a[60:63], v[60:63], v[180:183], a[60:63]
    v_exp_f32 v41, v41
    v_mfma_f32_16x16x32_bf16 a[28:31], v[52:55], v[180:183], a[28:31]
    s_sub_u32 s25, s25, 1
    v_add_f32 v237, v41, v237
    v_cvt_pk_bf16_f32 v118, v40, v41
    v_mfma_f32_16x16x32_bf16 a[28:31], v[48:51], v[176:179], a[28:31]
    s_waitcnt lgkmcnt(2)
    s_cbranch_scc1 L_tail0
    v_mfma_f32_16x16x32_bf16 v[8:11], v[152:155], a[192:195], v[128:131]
    v_exp_f32 v42, v42
    v_mfma_f32_16x16x32_bf16 v[8:11], v[156:159], a[196:199], v[8:11]
    s_waitcnt lgkmcnt(0)
    v_exp_f32 v43, v43
    v_mfma_f32_16x16x32_bf16 v[8:11], v[160:163], a[200:203], v[8:11]
    s_mov_b32 m0, s28
    v_add_f32 v237, v42, v237
    v_add_f32 v237, v43, v237
    v_mfma_f32_16x16x32_bf16 v[8:11], v[164:167], a[204:207], v[8:11]
    buffer_load_dwordx4 v228, s[8:11], s26 offen offset:0 nt lds
    v_mfma_f32_16x16x32_bf16 v[12:15], v[164:167], a[220:223], v[132:135]
    ds_read_b128 v[168:171], v216 offset:36864
    v_cvt_pk_bf16_f32 v119, v42, v43
    v_mfma_f32_16x16x32_bf16 v[12:15], v[160:163], a[216:219], v[12:15]
    v_mfma_f32_16x16x32_bf16 v[12:15], v[156:159], a[212:215], v[12:15]
    ds_read_b128 v[172:175], v217 offset:36864
    v_mfma_f32_16x16x32_bf16 v[12:15], v[152:155], a[208:211], v[12:15]
    v_mfma_f32_16x16x32_bf16 v[16:19], v[152:155], a[224:227], v[136:139]
    ds_read_b128 v[176:179], v218 offset:36864
    v_mfma_f32_16x16x32_bf16 v[16:19], v[156:159], a[228:231], v[16:19]
    v_exp_f32 v8, v8
    v_mfma_f32_16x16x32_bf16 v[16:19], v[160:163], a[232:235], v[16:19]
    ds_read_b128 v[180:183], v219 offset:36864
    v_mfma_f32_16x16x32_bf16 v[16:19], v[164:167], a[236:239], v[16:19]
    v_exp_f32 v9, v9
    v_mfma_f32_16x16x32_bf16 v[20:23], v[164:167], a[252:255], v[140:143]
    v_exp_f32 v10, v10
    v_mfma_f32_16x16x32_bf16 v[20:23], v[160:163], a[248:251], v[20:23]
    v_exp_f32 v11, v11
    v_mfma_f32_16x16x32_bf16 v[20:23], v[156:159], a[244:247], v[20:23]
    v_exp_f32 v12, v12
    v_mfma_f32_16x16x32_bf16 v[20:23], v[152:155], a[240:243], v[20:23]
    v_exp_f32 v13, v13
    v_mfma_f32_16x16x32_bf16 v[24:27], v[152:155], v[184:187], v[144:147]
    v_exp_f32 v14, v14
    v_mfma_f32_16x16x32_bf16 v[24:27], v[156:159], v[188:191], v[24:27]
    v_cvt_pk_bf16_f32 v48, v8, v9
    v_cvt_pk_bf16_f32 v49, v10, v11
    v_mfma_f32_16x16x32_bf16 v[24:27], v[160:163], v[192:195], v[24:27]
    buffer_load_dwordx4 v229, s[8:11], s26 offen offset:1024 nt lds
    v_mfma_f32_16x16x32_bf16 v[24:27], v[164:167], v[196:199], v[24:27]
    s_waitcnt lgkmcnt(2)
    v_exp_f32 v15, v15
    v_mfma_f32_16x16x32_bf16 v[28:31], v[168:171], a[192:195], v[128:131]
    v_exp_f32 v16, v16
    v_mfma_f32_16x16x32_bf16 v[28:31], v[172:175], a[196:199], v[28:31]
    s_waitcnt lgkmcnt(0)
    v_cvt_pk_bf16_f32 v56, v12, v13
    v_cvt_pk_bf16_f32 v57, v14, v15
    v_mfma_f32_16x16x32_bf16 v[28:31], v[176:179], a[200:203], v[28:31]
    v_exp_f32 v17, v17
    v_mfma_f32_16x16x32_bf16 v[28:31], v[180:183], a[204:207], v[28:31]
    v_add_f32 v236, v16, v236
    v_add_f32 v236, v17, v236
    v_mfma_f32_16x16x32_bf16 v[32:35], v[180:183], a[220:223], v[132:135]
    ds_read_b64_tr_b16 v[152:153], v220 offset:49152
    v_cvt_pk_bf16_f32 v64, v16, v17
    v_mfma_f32_16x16x32_bf16 v[32:35], v[176:179], a[216:219], v[32:35]
    v_exp_f32 v18, v18
    v_mfma_f32_16x16x32_bf16 v[32:35], v[172:175], a[212:215], v[32:35]
    ds_read_b64_tr_b16 v[154:155], v220 offset:53248
    v_add_f32 v236, v18, v236
    v_mfma_f32_16x16x32_bf16 v[32:35], v[168:171], a[208:211], v[32:35]
    v_exp_f32 v19, v19
    v_mfma_f32_16x16x32_bf16 v[36:39], v[168:171], a[224:227], v[136:139]
    ds_read_b64_tr_b16 v[156:157], v220 offset:57344
    v_add_f32 v236, v19, v236
    v_mfma_f32_16x16x32_bf16 v[36:39], v[172:175], a[228:231], v[36:39]
    v_exp_f32 v20, v20
    v_mfma_f32_16x16x32_bf16 v[36:39], v[176:179], a[232:235], v[36:39]
    ds_read_b64_tr_b16 v[158:159], v220 offset:61440
    v_cvt_pk_bf16_f32 v65, v18, v19
    v_mfma_f32_16x16x32_bf16 v[36:39], v[180:183], a[236:239], v[36:39]
    v_exp_f32 v21, v21
    v_mfma_f32_16x16x32_bf16 v[40:43], v[180:183], a[252:255], v[140:143]
    v_exp_f32 v22, v22
    v_mfma_f32_16x16x32_bf16 v[40:43], v[176:179], a[248:251], v[40:43]
    ds_read_b64_tr_b16 v[160:161], v221 offset:49152
    v_add_f32 v237, v20, v237
    v_mfma_f32_16x16x32_bf16 v[40:43], v[172:175], a[244:247], v[40:43]
    buffer_load_dwordx4 v230, s[8:11], s26 offen offset:2048 nt lds
    v_mfma_f32_16x16x32_bf16 v[40:43], v[168:171], a[240:243], v[40:43]
    ds_read_b64_tr_b16 v[162:163], v221 offset:53248
    v_add_f32 v237, v21, v237
    v_mfma_f32_16x16x32_bf16 v[44:47], v[168:171], v[184:187], v[144:147]
    v_exp_f32 v23, v23
    v_mfma_f32_16x16x32_bf16 v[44:47], v[172:175], v[188:191], v[44:47]
    ds_read_b64_tr_b16 v[164:165], v221 offset:57344
    v_cvt_pk_bf16_f32 v72, v20, v21
    v_mfma_f32_16x16x32_bf16 v[44:47], v[176:179], v[192:195], v[44:47]
    v_exp_f32 v24, v24
    v_mfma_f32_16x16x32_bf16 v[44:47], v[180:183], v[196:199], v[44:47]
    s_waitcnt lgkmcnt(3)
    ds_read_b64_tr_b16 v[166:167], v221 offset:61440
    v_add_f32 v237, v22, v237
    v_mfma_f32_16x16x32_bf16 a[0:3], v[88:91], v[152:155], a[0:3]
    v_exp_f32 v25, v25
    v_xor_b32 v221, 0x10000, v221
    v_mfma_f32_16x16x32_bf16 a[0:3], v[92:95], v[156:159], a[0:3]
    v_exp_f32 v26, v26
    v_mfma_f32_16x16x32_bf16 a[32:35], v[100:103], v[156:159], a[32:35]
    v_exp_f32 v27, v27
    v_mfma_f32_16x16x32_bf16 a[32:35], v[96:99], v[152:155], a[32:35]
    v_add_f32 v237, v23, v237
    v_cvt_pk_bf16_f32 v73, v22, v23
    v_mfma_f32_16x16x32_bf16 a[64:67], v[104:107], v[152:155], a[64:67]
    ds_read_b64_tr_b16 v[168:169], v222 offset:49152
    v_add_f32 v238, v24, v238
    v_mfma_f32_16x16x32_bf16 a[64:67], v[108:111], v[156:159], a[64:67]
    v_exp_f32 v28, v28
    v_mfma_f32_16x16x32_bf16 a[96:99], v[116:119], v[156:159], a[96:99]
    ds_read_b64_tr_b16 v[170:171], v222 offset:53248
    v_add_f32 v238, v25, v238
    v_mfma_f32_16x16x32_bf16 a[96:99], v[112:115], v[152:155], a[96:99]
    v_exp_f32 v29, v29
    v_mfma_f32_16x16x32_bf16 a[160:163], v[120:123], v[152:155], a[160:163]
    s_waitcnt lgkmcnt(2)
    ds_read_b64_tr_b16 v[172:173], v222 offset:57344
    v_cvt_pk_bf16_f32 v80, v24, v25
    v_mfma_f32_16x16x32_bf16 a[164:167], v[120:123], v[160:163], a[164:167]
    buffer_load_dwordx4 v231, s[8:11], s26 offen offset:3072 nt lds
    v_mfma_f32_16x16x32_bf16 a[100:103], v[112:115], v[160:163], a[100:103]
    s_add_u32 s28, s28, 32768
    ds_read_b64_tr_b16 v[174:175], v222 offset:61440
    v_add_f32 v238, v26, v238
    v_mfma_f32_16x16x32_bf16 a[100:103], v[116:119], v[164:167], a[100:103]
    s_and_b32 s28, s28, 131071
    v_exp_f32 v30, v30
    v_xor_b32 v222, 0x10000, v222
    v_mfma_f32_16x16x32_bf16 a[68:71], v[108:111], v[164:167], a[68:71]
    s_add_u32 s26, s26, 16384
    v_exp_f32 v31, v31
    v_mfma_f32_16x16x32_bf16 a[68:71], v[104:107], v[160:163], a[68:71]
    s_cmp_lt_u32 s26, 524288
    ds_read_b64_tr_b16 v[176:177], v223 offset:49152
    v_add_f32 v238, v27, v238
    v_mfma_f32_16x16x32_bf16 a[36:39], v[96:99], v[160:163], a[36:39]
    s_cselect_b32 s10, 524288, 0
    v_exp_f32 v32, v32
    v_mfma_f32_16x16x32_bf16 a[36:39], v[100:103], v[164:167], a[36:39]
    ds_read_b64_tr_b16 v[178:179], v223 offset:53248
    v_cvt_pk_bf16_f32 v81, v26, v27
    v_mfma_f32_16x16x32_bf16 a[4:7], v[92:95], v[164:167], a[4:7]
    v_exp_f32 v33, v33
    v_mfma_f32_16x16x32_bf16 a[4:7], v[88:91], v[160:163], a[4:7]
    ds_read_b64_tr_b16 v[180:181], v223 offset:57344
    v_cvt_pk_bf16_f32 v50, v28, v29
    v_mfma_f32_16x16x32_bf16 v[244:247], v[240:243], v[88:91], v[244:247]
    v_exp_f32 v34, v34
    v_mfma_f32_16x16x32_bf16 v[244:247], v[240:243], v[92:95], v[244:247]
    s_waitcnt lgkmcnt(3)
    ds_read_b64_tr_b16 v[182:183], v223 offset:61440
    v_cvt_pk_bf16_f32 v51, v30, v31
    v_mfma_f32_16x16x32_bf16 a[8:11], v[88:91], v[168:171], a[8:11]
    v_exp_f32 v35, v35
    v_xor_b32 v223, 0x10000, v223
    v_mfma_f32_16x16x32_bf16 a[8:11], v[92:95], v[172:175], a[8:11]
    v_exp_f32 v36, v36
    v_mfma_f32_16x16x32_bf16 a[40:43], v[100:103], v[172:175], a[40:43]
    ds_read_b128 v[152:155], v216 offset:40960
    v_cvt_pk_bf16_f32 v58, v32, v33
    v_mfma_f32_16x16x32_bf16 a[40:43], v[96:99], v[168:171], a[40:43]
    v_exp_f32 v37, v37
    v_mfma_f32_16x16x32_bf16 a[72:75], v[104:107], v[168:171], a[72:75]
    s_mov_b32 m0, s29
    ds_read_b128 v[156:159], v217 offset:40960
    v_cvt_pk_bf16_f32 v59, v34, v35
    v_mfma_f32_16x16x32_bf16 a[72:75], v[108:111], v[172:175], a[72:75]
    buffer_load_dwordx4 v232, s[12:15], s27 offen offset:0 nt lds
    v_mfma_f32_16x16x32_bf16 a[104:107], v[116:119], v[172:175], a[104:107]
    ds_read_b128 v[160:163], v218 offset:40960
    v_add_f32 v236, v36, v236
    v_mfma_f32_16x16x32_bf16 a[104:107], v[112:115], v[168:171], a[104:107]
    v_exp_f32 v38, v38
    v_mfma_f32_16x16x32_bf16 a[168:171], v[120:123], v[168:171], a[168:171]
    s_waitcnt lgkmcnt(3)
    ds_read_b128 v[164:167], v219 offset:40960
    v_add_f32 v236, v37, v236
    v_mfma_f32_16x16x32_bf16 a[172:175], v[120:123], v[176:179], a[172:175]
    v_exp_f32 v39, v39
    v_mfma_f32_16x16x32_bf16 a[108:111], v[112:115], v[176:179], a[108:111]
    v_exp_f32 v40, v40
    v_mfma_f32_16x16x32_bf16 a[108:111], v[116:119], v[180:183], a[108:111]
    v_exp_f32 v41, v41
    v_mfma_f32_16x16x32_bf16 a[76:79], v[108:111], v[180:183], a[76:79]
    v_cvt_pk_bf16_f32 v66, v36, v37
    v_add_f32 v236, v38, v236
    v_mfma_f32_16x16x32_bf16 a[76:79], v[104:107], v[176:179], a[76:79]
    v_exp_f32 v42, v42
    v_mfma_f32_16x16x32_bf16 a[44:47], v[96:99], v[176:179], a[44:47]
    v_add_f32 v236, v39, v236
    v_cvt_pk_bf16_f32 v67, v38, v39
    v_mfma_f32_16x16x32_bf16 a[44:47], v[100:103], v[180:183], a[44:47]
    v_exp_f32 v43, v43
    v_mfma_f32_16x16x32_bf16 a[12:15], v[92:95], v[180:183], a[12:15]
    v_add_f32 v237, v40, v237
    v_add_f32 v237, v41, v237
    v_mfma_f32_16x16x32_bf16 a[12:15], v[88:91], v[176:179], a[12:15]
    s_waitcnt lgkmcnt(2)
    v_exp_f32 v44, v44
    v_mfma_f32_16x16x32_bf16 v[8:11], v[152:155], a[192:195], v[128:131]
    v_cvt_pk_bf16_f32 v74, v40, v41
    v_add_f32 v237, v42, v237
    v_mfma_f32_16x16x32_bf16 v[8:11], v[156:159], a[196:199], v[8:11]
    s_waitcnt lgkmcnt(0)
    v_exp_f32 v45, v45
    v_mfma_f32_16x16x32_bf16 v[8:11], v[160:163], a[200:203], v[8:11]
    buffer_load_dwordx4 v233, s[12:15], s27 offen offset:1024 nt lds
    v_mfma_f32_16x16x32_bf16 v[8:11], v[164:167], a[204:207], v[8:11]
    v_exp_f32 v46, v46
    v_mfma_f32_16x16x32_bf16 v[12:15], v[164:167], a[220:223], v[132:135]
    ds_read_b128 v[168:171], v216 offset:45056
    v_add_f32 v237, v43, v237
    v_mfma_f32_16x16x32_bf16 v[12:15], v[160:163], a[216:219], v[12:15]
    v_exp_f32 v47, v47
    v_mfma_f32_16x16x32_bf16 v[12:15], v[156:159], a[212:215], v[12:15]
    ds_read_b128 v[172:175], v217 offset:45056
    v_cvt_pk_bf16_f32 v75, v42, v43
    v_mfma_f32_16x16x32_bf16 v[12:15], v[152:155], a[208:211], v[12:15]
    v_add_f32 v238, v44, v238
    v_add_f32 v238, v45, v238
    v_mfma_f32_16x16x32_bf16 v[16:19], v[152:155], a[224:227], v[136:139]
    ds_read_b128 v[176:179], v218 offset:45056
    v_cvt_pk_bf16_f32 v82, v44, v45
    v_mfma_f32_16x16x32_bf16 v[16:19], v[156:159], a[228:231], v[16:19]
    v_exp_f32 v8, v8
    v_mfma_f32_16x16x32_bf16 v[16:19], v[160:163], a[232:235], v[16:19]
    ds_read_b128 v[180:183], v219 offset:45056
    v_add_f32 v238, v46, v238
    v_mfma_f32_16x16x32_bf16 v[16:19], v[164:167], a[236:239], v[16:19]
    v_exp_f32 v9, v9
    v_mfma_f32_16x16x32_bf16 v[20:23], v[164:167], a[252:255], v[140:143]
    v_exp_f32 v10, v10
    v_mfma_f32_16x16x32_bf16 v[20:23], v[160:163], a[248:251], v[20:23]
    v_add_f32 v238, v47, v238
    v_cvt_pk_bf16_f32 v83, v46, v47
    v_mfma_f32_16x16x32_bf16 v[20:23], v[156:159], a[244:247], v[20:23]
    v_exp_f32 v11, v11
    v_mfma_f32_16x16x32_bf16 v[20:23], v[152:155], a[240:243], v[20:23]
    v_cvt_pk_bf16_f32 v52, v8, v9
    v_cvt_pk_bf16_f32 v53, v10, v11
    v_mfma_f32_16x16x32_bf16 v[24:27], v[152:155], v[184:187], v[144:147]
    v_exp_f32 v12, v12
    v_mfma_f32_16x16x32_bf16 v[24:27], v[156:159], v[188:191], v[24:27]
    v_xor_b32 v216, 0x10000, v216
    v_xor_b32 v217, 0x10000, v217
    v_mfma_f32_16x16x32_bf16 v[24:27], v[160:163], v[192:195], v[24:27]
    buffer_load_dwordx4 v232, s[12:15], s27 offen offset:2048 nt lds
    v_mfma_f32_16x16x32_bf16 v[24:27], v[164:167], v[196:199], v[24:27]
    s_waitcnt lgkmcnt(2)
    v_exp_f32 v13, v13
    v_mfma_f32_16x16x32_bf16 v[28:31], v[168:171], a[192:195], v[128:131]
    v_exp_f32 v14, v14
    v_mfma_f32_16x16x32_bf16 v[28:31], v[172:175], a[196:199], v[28:31]
    s_waitcnt lgkmcnt(0)
    v_cvt_pk_bf16_f32 v60, v12, v13
    v_xor_b32 v218, 0x10000, v218
    v_mfma_f32_16x16x32_bf16 v[28:31], v[176:179], a[200:203], v[28:31]
    v_exp_f32 v15, v15
    v_mfma_f32_16x16x32_bf16 v[28:31], v[180:183], a[204:207], v[28:31]
    v_cvt_pk_bf16_f32 v61, v14, v15
    v_xor_b32 v219, 0x10000, v219
    v_mfma_f32_16x16x32_bf16 v[32:35], v[180:183], a[220:223], v[132:135]
    ds_read_b64_tr_b16 v[152:153], v224 offset:49152
    v_xor_b32 v220, 0x10000, v220
    v_mfma_f32_16x16x32_bf16 v[32:35], v[176:179], a[216:219], v[32:35]
    v_exp_f32 v16, v16
    v_mfma_f32_16x16x32_bf16 v[32:35], v[172:175], a[212:215], v[32:35]
    ds_read_b64_tr_b16 v[154:155], v224 offset:53248
    v_add_f32 v236, v16, v236
    v_mfma_f32_16x16x32_bf16 v[32:35], v[168:171], a[208:211], v[32:35]
    v_exp_f32 v17, v17
    v_mfma_f32_16x16x32_bf16 v[36:39], v[168:171], a[224:227], v[136:139]
    ds_read_b64_tr_b16 v[156:157], v224 offset:57344
    v_add_f32 v236, v17, v236
    v_mfma_f32_16x16x32_bf16 v[36:39], v[172:175], a[228:231], v[36:39]
    v_exp_f32 v18, v18
    v_mfma_f32_16x16x32_bf16 v[36:39], v[176:179], a[232:235], v[36:39]
    ds_read_b64_tr_b16 v[158:159], v224 offset:61440
    v_cvt_pk_bf16_f32 v68, v16, v17
    v_mfma_f32_16x16x32_bf16 v[36:39], v[180:183], a[236:239], v[36:39]
    v_exp_f32 v19, v19
    v_xor_b32 v224, 0x10000, v224
    v_mfma_f32_16x16x32_bf16 v[40:43], v[180:183], a[252:255], v[140:143]
    v_exp_f32 v20, v20
    v_mfma_f32_16x16x32_bf16 v[40:43], v[176:179], a[248:251], v[40:43]
    ds_read_b64_tr_b16 v[160:161], v225 offset:49152
    v_add_f32 v236, v18, v236
    v_mfma_f32_16x16x32_bf16 v[40:43], v[172:175], a[244:247], v[40:43]
    buffer_load_dwordx4 v233, s[12:15], s27 offen offset:3072 nt lds
    v_mfma_f32_16x16x32_bf16 v[40:43], v[168:171], a[240:243], v[40:43]
    s_add_u32 s29, s29, 32768
    ds_read_b64_tr_b16 v[162:163], v225 offset:53248
    v_add_f32 v236, v19, v236
    v_mfma_f32_16x16x32_bf16 v[44:47], v[168:171], v[184:187], v[144:147]
    s_and_b32 s29, s29, 131071
    v_exp_f32 v21, v21
    v_mfma_f32_16x16x32_bf16 v[44:47], v[172:175], v[188:191], v[44:47]
    s_add_u32 s27, s27, 16384
    ds_read_b64_tr_b16 v[164:165], v225 offset:57344
    v_cvt_pk_bf16_f32 v69, v18, v19
    v_mfma_f32_16x16x32_bf16 v[44:47], v[176:179], v[192:195], v[44:47]
    s_cmp_lt_u32 s27, 524288
    v_exp_f32 v22, v22
    v_mfma_f32_16x16x32_bf16 v[44:47], v[180:183], v[196:199], v[44:47]
    s_waitcnt lgkmcnt(3)
    ds_read_b64_tr_b16 v[166:167], v225 offset:61440
    v_add_f32 v237, v20, v237
    v_mfma_f32_16x16x32_bf16 a[16:19], v[88:91], v[152:155], a[16:19]
    s_cselect_b32 s14, 524288, 0
    ds_read_b64_tr_b16 v[168:169], v226 offset:49152
    v_add_f32 v237, v21, v237
    v_xor_b32 v225, 0x10000, v225
    v_mfma_f32_16x16x32_bf16 a[16:19], v[92:95], v[156:159], a[16:19]
    ds_read_b64_tr_b16 v[170:171], v226 offset:53248
    v_cvt_pk_bf16_f32 v76, v20, v21
    v_mfma_f32_16x16x32_bf16 a[48:51], v[100:103], v[156:159], a[48:51]
    ds_read_b64_tr_b16 v[172:173], v226 offset:57344
    v_add_f32 v237, v22, v237
    v_mfma_f32_16x16x32_bf16 a[48:51], v[96:99], v[152:155], a[48:51]
    v_exp_f32 v23, v23
    v_mfma_f32_16x16x32_bf16 a[80:83], v[104:107], v[152:155], a[80:83]
    ds_read_b64_tr_b16 v[174:175], v226 offset:61440
    v_add_f32 v237, v23, v237
    v_mfma_f32_16x16x32_bf16 a[80:83], v[108:111], v[156:159], a[80:83]
    v_exp_f32 v24, v24
    v_xor_b32 v226, 0x10000, v226
    v_mfma_f32_16x16x32_bf16 a[112:115], v[116:119], v[156:159], a[112:115]
    ds_read_b64_tr_b16 v[176:177], v227 offset:49152
    v_cvt_pk_bf16_f32 v77, v22, v23
    v_mfma_f32_16x16x32_bf16 a[112:115], v[112:115], v[152:155], a[112:115]
    v_exp_f32 v25, v25
    v_mfma_f32_16x16x32_bf16 a[176:179], v[120:123], v[152:155], a[176:179]
    s_waitcnt lgkmcnt(5)
    ds_read_b64_tr_b16 v[178:179], v227 offset:53248
    v_add_f32 v238, v24, v238
    v_mfma_f32_16x16x32_bf16 a[180:183], v[120:123], v[160:163], a[180:183]
    v_exp_f32 v26, v26
    v_mfma_f32_16x16x32_bf16 a[116:119], v[112:115], v[160:163], a[116:119]
    ds_read_b64_tr_b16 v[180:181], v227 offset:57344
    v_add_f32 v238, v25, v238
    v_mfma_f32_16x16x32_bf16 a[116:119], v[116:119], v[164:167], a[116:119]
    v_exp_f32 v27, v27
    v_mfma_f32_16x16x32_bf16 a[84:87], v[108:111], v[164:167], a[84:87]
    ds_read_b64_tr_b16 v[182:183], v227 offset:61440
    v_cvt_pk_bf16_f32 v84, v24, v25
    v_mfma_f32_16x16x32_bf16 a[84:87], v[104:107], v[160:163], a[84:87]
    v_exp_f32 v28, v28
    v_xor_b32 v227, 0x10000, v227
    v_mfma_f32_16x16x32_bf16 a[52:55], v[96:99], v[160:163], a[52:55]
    v_exp_f32 v29, v29
    v_mfma_f32_16x16x32_bf16 a[52:55], v[100:103], v[164:167], a[52:55]
    v_exp_f32 v30, v30
    v_mfma_f32_16x16x32_bf16 a[20:23], v[92:95], v[164:167], a[20:23]
    v_exp_f32 v31, v31
    v_mfma_f32_16x16x32_bf16 a[20:23], v[88:91], v[160:163], a[20:23]
    v_exp_f32 v32, v32
    v_mfma_f32_16x16x32_bf16 v[248:251], v[240:243], v[96:99], v[248:251]
    v_add_f32 v238, v26, v238
    v_add_f32 v238, v27, v238
    v_mfma_f32_16x16x32_bf16 v[248:251], v[240:243], v[100:103], v[248:251]
    s_waitcnt vmcnt(8) lgkmcnt(0)
    v_exp_f32 v33, v33
    v_mfma_f32_16x16x32_bf16 a[24:27], v[88:91], v[168:171], a[24:27]
    s_barrier
    v_mfma_f32_16x16x32_bf16 a[24:27], v[92:95], v[172:175], a[24:27]
    v_exp_f32 v34, v34
    v_mfma_f32_16x16x32_bf16 a[56:59], v[100:103], v[172:175], a[56:59]
    ds_read_b128 v[152:155], v216 offset:0
    v_cvt_pk_bf16_f32 v85, v26, v27
    v_mfma_f32_16x16x32_bf16 a[56:59], v[96:99], v[168:171], a[56:59]
    v_exp_f32 v35, v35
    v_mfma_f32_16x16x32_bf16 a[88:91], v[104:107], v[168:171], a[88:91]
    ds_read_b128 v[156:159], v217 offset:0
    v_cvt_pk_bf16_f32 v54, v28, v29
    v_mfma_f32_16x16x32_bf16 a[88:91], v[108:111], v[172:175], a[88:91]
    v_exp_f32 v36, v36
    v_mfma_f32_16x16x32_bf16 a[120:123], v[116:119], v[172:175], a[120:123]
    ds_read_b128 v[160:163], v218 offset:0
    v_cvt_pk_bf16_f32 v55, v30, v31
    v_mfma_f32_16x16x32_bf16 a[120:123], v[112:115], v[168:171], a[120:123]
    v_exp_f32 v37, v37
    v_mfma_f32_16x16x32_bf16 a[184:187], v[120:123], v[168:171], a[184:187]
    ds_read_b128 v[164:167], v219 offset:0
    v_cvt_pk_bf16_f32 v62, v32, v33
    v_mfma_f32_16x16x32_bf16 a[188:191], v[120:123], v[176:179], a[188:191]
    v_exp_f32 v38, v38
    v_mfma_f32_16x16x32_bf16 a[124:127], v[112:115], v[176:179], a[124:127]
    v_cvt_pk_bf16_f32 v63, v34, v35
    v_add_f32 v236, v36, v236
    v_mfma_f32_16x16x32_bf16 a[124:127], v[116:119], v[180:183], a[124:127]
    v_exp_f32 v39, v39
    v_mfma_f32_16x16x32_bf16 a[92:95], v[108:111], v[180:183], a[92:95]
    v_add_f32 v236, v37, v236
    v_cvt_pk_bf16_f32 v70, v36, v37
    v_mfma_f32_16x16x32_bf16 a[92:95], v[104:107], v[176:179], a[92:95]
    v_exp_f32 v40, v40
    v_mfma_f32_16x16x32_bf16 a[60:63], v[96:99], v[176:179], a[60:63]
    v_add_f32 v236, v38, v236
    v_add_f32 v236, v39, v236
    v_mfma_f32_16x16x32_bf16 a[60:63], v[100:103], v[180:183], a[60:63]
    v_exp_f32 v41, v41
    v_mfma_f32_16x16x32_bf16 a[28:31], v[92:95], v[180:183], a[28:31]
    v_cvt_pk_bf16_f32 v71, v38, v39
    v_add_f32 v237, v40, v237
    v_mfma_f32_16x16x32_bf16 a[28:31], v[88:91], v[176:179], a[28:31]
    s_waitcnt lgkmcnt(2)
    s_branch L_loop0
.p2align 6
L_loop1:
    v_mfma_f32_16x16x32_bf16 v[8:11], v[152:155], a[192:195], v[128:131]
    ds_read_b128 v[168:171], v216 offset:4096
    v_add_f32 v236, v38, v236
    v_mfma_f32_16x16x32_bf16 v[8:11], v[156:159], a[196:199], v[8:11]
    s_waitcnt lgkmcnt(1)
    v_exp_f32 v41, v41
    v_mfma_f32_16x16x32_bf16 v[8:11], v[160:163], a[200:203], v[8:11]
    ds_read_b128 v[172:175], v217 offset:4096
    v_add_f32 v236, v39, v236
    v_mfma_f32_16x16x32_bf16 v[8:11], v[164:167], a[204:207], v[8:11]
    v_exp_f32 v42, v42
    v_mfma_f32_16x16x32_bf16 v[12:15], v[164:167], a[220:223], v[132:135]
    ds_read_b128 v[176:179], v218 offset:4096
    v_cvt_pk_bf16_f32 v71, v38, v39
    v_mfma_f32_16x16x32_bf16 v[12:15], v[160:163], a[216:219], v[12:15]
    v_exp_f32 v43, v43
    v_mfma_f32_16x16x32_bf16 v[12:15], v[156:159], a[212:215], v[12:15]
    s_mov_b32 m0, s28
    ds_read_b128 v[180:183], v219 offset:4096
    v_add_f32 v237, v40, v237
    v_mfma_f32_16x16x32_bf16 v[12:15], v[152:155], a[208:211], v[12:15]
    buffer_load_dwordx4 v228, s[8:11], s26 offen offset:0 nt lds
    v_mfma_f32_16x16x32_bf16 v[16:19], v[152:155], a[224:227], v[136:139]
    v_exp_f32 v44, v44
    v_mfma_f32_16x16x32_bf16 v[16:19], v[156:159], a[228:231], v[16:19]
    v_exp_f32 v45, v45
    v_mfma_f32_16x16x32_bf16 v[16:19], v[160:163], a[232:235], v[16:19]
    v_exp_f32 v46, v46
    v_mfma_f32_16x16x32_bf16 v[16:19], v[164:167], a[236:239], v[16:19]
    v_add_f32 v237, v41, v237
    v_cvt_pk_bf16_f32 v78, v40, v41
    v_mfma_f32_16x16x32_bf16 v[20:23], v[164:167], a[252:255], v[140:143]
    v_exp_f32 v47, v47
    v_mfma_f32_16x16x32_bf16 v[20:23], v[160:163], a[248:251], v[20:23]
    v_add_f32 v237, v42, v237
    v_add_f32 v237, v43, v237
    v_mfma_f32_16x16x32_bf16 v[20:23], v[156:159], a[244:247], v[20:23]
    v_cvt_pk_bf16_f32 v79, v42, v43
    v_add_f32 v238, v44, v238
    v_mfma_f32_16x16x32_bf16 v[20:23], v[152:155], a[240:243], v[20:23]
    s_waitcnt lgkmcnt(2)
    v_exp_f32 v8, v8
    v_mfma_f32_16x16x32_bf16 v[28:31], v[168:171], a[192:195], v[128:131]
    ds_read_b64_tr_b16 v[152:153], v220 offset:16384
    v_add_f32 v238, v45, v238
    v_mfma_f32_16x16x32_bf16 v[28:31], v[172:175], a[196:199], v[28:31]
    s_waitcnt lgkmcnt(1)
    v_exp_f32 v9, v9
    v_mfma_f32_16x16x32_bf16 v[28:31], v[176:179], a[200:203], v[28:31]
    ds_read_b64_tr_b16 v[154:155], v220 offset:20480
    v_cvt_pk_bf16_f32 v86, v44, v45
    v_mfma_f32_16x16x32_bf16 v[28:31], v[180:183], a[204:207], v[28:31]
    v_exp_f32 v10, v10
    v_mfma_f32_16x16x32_bf16 v[32:35], v[180:183], a[220:223], v[132:135]
    ds_read_b64_tr_b16 v[156:157], v220 offset:24576
    v_add_f32 v238, v46, v238
    v_mfma_f32_16x16x32_bf16 v[32:35], v[176:179], a[216:219], v[32:35]
    buffer_load_dwordx4 v229, s[8:11], s26 offen offset:1024 nt lds
    v_mfma_f32_16x16x32_bf16 v[32:35], v[172:175], a[212:215], v[32:35]
    ds_read_b64_tr_b16 v[158:159], v220 offset:28672
    v_add_f32 v238, v47, v238
    v_mfma_f32_16x16x32_bf16 v[32:35], v[168:171], a[208:211], v[32:35]
    v_exp_f32 v11, v11
    v_mfma_f32_16x16x32_bf16 v[36:39], v[168:171], a[224:227], v[136:139]
    v_exp_f32 v12, v12
    v_mfma_f32_16x16x32_bf16 v[36:39], v[172:175], a[228:231], v[36:39]
    v_exp_f32 v13, v13
    v_mfma_f32_16x16x32_bf16 v[36:39], v[176:179], a[232:235], v[36:39]
    v_cvt_pk_bf16_f32 v87, v46, v47
    v_cvt_pk_bf16_f32 v88, v8, v9
    v_mfma_f32_16x16x32_bf16 v[36:39], v[180:183], a[236:239], v[36:39]
    ds_read_b64_tr_b16 v[160:161], v221 offset:16384
    v_cvt_pk_bf16_f32 v89, v10, v11
    v_mfma_f32_16x16x32_bf16 v[40:43], v[180:183], a[252:255], v[140:143]
    v_exp_f32 v14, v14
    v_mfma_f32_16x16x32_bf16 v[40:43], v[176:179], a[248:251], v[40:43]
    ds_read_b64_tr_b16 v[162:163], v221 offset:20480
    v_cvt_pk_bf16_f32 v96, v12, v13
    v_mfma_f32_16x16x32_bf16 v[40:43], v[172:175], a[244:247], v[40:43]
    v_exp_f32 v15, v15
    v_mfma_f32_16x16x32_bf16 v[40:43], v[168:171], a[240:243], v[40:43]
    s_waitcnt lgkmcnt(2)
    ds_read_b64_tr_b16 v[164:165], v221 offset:24576
    v_cvt_pk_bf16_f32 v97, v14, v15
    v_mfma_f32_16x16x32_bf16 a[0:3], v[48:51], v[152:155], a[0:3]
    v_exp_f32 v16, v16
    v_mfma_f32_16x16x32_bf16 a[0:3], v[52:55], v[156:159], a[0:3]
    ds_read_b64_tr_b16 v[166:167], v221 offset:28672
    v_add_f32 v236, v16, v236
    v_mfma_f32_16x16x32_bf16 a[32:35], v[60:63], v[156:159], a[32:35]
    v_exp_f32 v17, v17
    v_mfma_f32_16x16x32_bf16 a[32:35], v[56:59], v[152:155], a[32:35]
    v_exp_f32 v18, v18
    v_mfma_f32_16x16x32_bf16 a[64:67], v[64:67], v[152:155], a[64:67]
    v_add_f32 v236, v17, v236
    v_cvt_pk_bf16_f32 v104, v16, v17
    v_mfma_f32_16x16x32_bf16 a[64:67], v[68:71], v[156:159], a[64:67]
    buffer_load_dwordx4 v230, s[8:11], s26 offen offset:2048 nt lds
    v_mfma_f32_16x16x32_bf16 a[96:99], v[76:79], v[156:159], a[96:99]
    ds_read_b64_tr_b16 v[168:169], v222 offset:16384
    v_add_f32 v236, v18, v236
    v_mfma_f32_16x16x32_bf16 a[96:99], v[72:75], v[152:155], a[96:99]
    v_exp_f32 v19, v19
    v_mfma_f32_16x16x32_bf16 a[128:131], v[80:83], v[152:155], a[128:131]
    ds_read_b64_tr_b16 v[170:171], v222 offset:20480
    v_add_f32 v236, v19, v236
    v_mfma_f32_16x16x32_bf16 a[128:131], v[84:87], v[156:159], a[128:131]
    s_waitcnt lgkmcnt(2)
    v_exp_f32 v20, v20
    v_mfma_f32_16x16x32_bf16 a[132:135], v[84:87], v[164:167], a[132:135]
    ds_read_b64_tr_b16 v[172:173], v222 offset:24576
    v_cvt_pk_bf16_f32 v105, v18, v19
    v_mfma_f32_16x16x32_bf16 a[132:135], v[80:83], v[160:163], a[132:135]
    v_exp_f32 v21, v21
    v_mfma_f32_16x16x32_bf16 a[100:103], v[72:75], v[160:163], a[100:103]
    ds_read_b64_tr_b16 v[174:175], v222 offset:28672
    v_add_f32 v237, v20, v237
    v_mfma_f32_16x16x32_bf16 a[100:103], v[76:79], v[164:167], a[100:103]
    v_exp_f32 v22, v22
    v_mfma_f32_16x16x32_bf16 a[68:71], v[68:71], v[164:167], a[68:71]
    v_exp_f32 v23, v23
    v_mfma_f32_16x16x32_bf16 a[68:71], v[64:67], v[160:163], a[68:71]
    v_exp_f32 v28, v28
    v_mfma_f32_16x16x32_bf16 a[36:39], v[56:59], v[160:163], a[36:39]
    v_add_f32 v237, v21, v237
    v_cvt_pk_bf16_f32 v112, v20, v21
    v_mfma_f32_16x16x32_bf16 a[36:39], v[60:63], v[164:167], a[36:39]
    ds_read_b64_tr_b16 v[176:177], v223 offset:16384
    v_add_f32 v237, v22, v237
    v_mfma_f32_16x16x32_bf16 a[4:7], v[52:55], v[164:167], a[4:7]
    v_exp_f32 v29, v29
    v_mfma_f32_16x16x32_bf16 a[4:7], v[48:51], v[160:163], a[4:7]
    ds_read_b64_tr_b16 v[178:179], v223 offset:20480
    v_add_f32 v237, v23, v237
    v_mfma_f32_16x16x32_bf16 v[244:247], v[240:243], v[48:51], v[244:247]
    buffer_load_dwordx4 v231, s[8:11], s26 offen offset:3072 nt lds
    v_mfma_f32_16x16x32_bf16 v[244:247], v[240:243], v[52:55], v[244:247]
    s_waitcnt lgkmcnt(2)
    ds_read_b64_tr_b16 v[180:181], v223 offset:24576
    v_cvt_pk_bf16_f32 v113, v22, v23
    v_mfma_f32_16x16x32_bf16 a[8:11], v[48:51], v[168:171], a[8:11]
    s_add_u32 s28, s28, 32768
    v_exp_f32 v30, v30
    v_mfma_f32_16x16x32_bf16 a[8:11], v[52:55], v[172:175], a[8:11]
    s_and_b32 s28, s28, 131071
    ds_read_b64_tr_b16 v[182:183], v223 offset:28672
    v_cvt_pk_bf16_f32 v90, v28, v29
    v_mfma_f32_16x16x32_bf16 a[40:43], v[60:63], v[172:175], a[40:43]
    s_add_u32 s26, s26, 16384
    v_exp_f32 v31, v31
    v_mfma_f32_16x16x32_bf16 a[40:43], v[56:59], v[168:171], a[40:43]
    s_cmp_lt_u32 s26, 524288
    v_exp_f32 v32, v32
    v_mfma_f32_16x16x32_bf16 a[72:75], v[64:67], v[168:171], a[72:75]
    s_cselect_b32 s10, 524288, 0
    ds_read_b128 v[152:155], v216 offset:8192
    v_cvt_pk_bf16_f32 v91, v30, v31
    v_mfma_f32_16x16x32_bf16 a[72:75], v[68:71], v[172:175], a[72:75]
    v_exp_f32 v33, v33
    v_mfma_f32_16x16x32_bf16 a[104:107], v[76:79], v[172:175], a[104:107]
    ds_read_b128 v[156:159], v217 offset:8192
    v_cvt_pk_bf16_f32 v98, v32, v33
    v_mfma_f32_16x16x32_bf16 a[104:107], v[72:75], v[168:171], a[104:107]
    v_exp_f32 v34, v34
    v_mfma_f32_16x16x32_bf16 a[136:139], v[80:83], v[168:171], a[136:139]
    ds_read_b128 v[160:163], v218 offset:8192
    v_mfma_f32_16x16x32_bf16 a[136:139], v[84:87], v[172:175], a[136:139]
    s_waitcnt lgkmcnt(3)
    v_exp_f32 v35, v35
    v_mfma_f32_16x16x32_bf16 a[140:143], v[84:87], v[180:183], a[140:143]
    ds_read_b128 v[164:167], v219 offset:8192
    v_cvt_pk_bf16_f32 v99, v34, v35
    v_mfma_f32_16x16x32_bf16 a[140:143], v[80:83], v[176:179], a[140:143]
    v_exp_f32 v36, v36
    v_mfma_f32_16x16x32_bf16 a[108:111], v[72:75], v[176:179], a[108:111]
    v_exp_f32 v37, v37
    v_mfma_f32_16x16x32_bf16 a[108:111], v[76:79], v[180:183], a[108:111]
    s_mov_b32 m0, s29
    v_add_f32 v236, v36, v236
    v_add_f32 v236, v37, v236
    v_mfma_f32_16x16x32_bf16 a[76:79], v[68:71], v[180:183], a[76:79]
    buffer_load_dwordx4 v232, s[12:15], s27 offen offset:0 nt lds
    v_mfma_f32_16x16x32_bf16 a[76:79], v[64:67], v[176:179], a[76:79]
    v_exp_f32 v38, v38
    v_mfma_f32_16x16x32_bf16 a[44:47], v[56:59], v[176:179], a[44:47]
    v_exp_f32 v39, v39
    v_mfma_f32_16x16x32_bf16 a[44:47], v[60:63], v[180:183], a[44:47]
    v_cvt_pk_bf16_f32 v106, v36, v37
    v_add_f32 v236, v38, v236
    v_mfma_f32_16x16x32_bf16 a[12:15], v[52:55], v[180:183], a[12:15]
    v_exp_f32 v40, v40
    v_mfma_f32_16x16x32_bf16 a[12:15], v[48:51], v[176:179], a[12:15]
    s_waitcnt lgkmcnt(2)
    v_add_f32 v236, v39, v236
    v_cvt_pk_bf16_f32 v107, v38, v39
    v_mfma_f32_16x16x32_bf16 v[8:11], v[152:155], a[192:195], v[128:131]
    v_exp_f32 v41, v41
    v_mfma_f32_16x16x32_bf16 v[8:11], v[156:159], a[196:199], v[8:11]
    s_waitcnt lgkmcnt(0)
    v_add_f32 v237, v40, v237
    v_add_f32 v237, v41, v237
    v_mfma_f32_16x16x32_bf16 v[8:11], v[160:163], a[200:203], v[8:11]
    v_exp_f32 v42, v42
    v_mfma_f32_16x16x32_bf16 v[8:11], v[164:167], a[204:207], v[8:11]
    v_cvt_pk_bf16_f32 v114, v40, v41
    v_add_f32 v237, v42, v237
    v_mfma_f32_16x16x32_bf16 v[12:15], v[164:167], a[220:223], v[132:135]
    ds_read_b128 v[168:171], v216 offset:12288
    v_mfma_f32_16x16x32_bf16 v[12:15], v[160:163], a[216:219], v[12:15]
    v_exp_f32 v43, v43
    v_mfma_f32_16x16x32_bf16 v[12:15], v[156:159], a[212:215], v[12:15]
    ds_read_b128 v[172:175], v217 offset:12288
    v_add_f32 v237, v43, v237
    v_mfma_f32_16x16x32_bf16 v[12:15], v[152:155], a[208:211], v[12:15]
    v_cvt_pk_bf16_f32 v115, v42, v43
    v_mfma_f32_16x16x32_bf16 v[16:19], v[152:155], a[224:227], v[136:139]
    ds_read_b128 v[176:179], v218 offset:12288
    v_mfma_f32_16x16x32_bf16 v[16:19], v[156:159], a[228:231], v[16:19]
    buffer_load_dwordx4 v233, s[12:15], s27 offen offset:1024 nt lds
    v_mfma_f32_16x16x32_bf16 v[16:19], v[160:163], a[232:235], v[16:19]
    ds_read_b128 v[180:183], v219 offset:12288
    v_mfma_f32_16x16x32_bf16 v[16:19], v[164:167], a[236:239], v[16:19]
    v_exp_f32 v8, v8
    v_mfma_f32_16x16x32_bf16 v[20:23], v[164:167], a[252:255], v[140:143]
    v_exp_f32 v9, v9
    v_mfma_f32_16x16x32_bf16 v[20:23], v[160:163], a[248:251], v[20:23]
    v_exp_f32 v10, v10
    v_mfma_f32_16x16x32_bf16 v[20:23], v[156:159], a[244:247], v[20:23]
    v_exp_f32 v11, v11
    v_mfma_f32_16x16x32_bf16 v[20:23], v[152:155], a[240:243], v[20:23]
    v_exp_f32 v12, v12
    v_mfma_f32_16x16x32_bf16 v[24:27], v[152:155], v[200:203], v[148:151]
    v_exp_f32 v13, v13
    v_mfma_f32_16x16x32_bf16 v[24:27], v[156:159], v[204:207], v[24:27]
    v_cvt_pk_bf16_f32 v92, v8, v9
    v_cvt_pk_bf16_f32 v93, v10, v11
    v_mfma_f32_16x16x32_bf16 v[24:27], v[160:163], v[208:211], v[24:27]
    v_cvt_pk_bf16_f32 v100, v12, v13
    v_mfma_f32_16x16x32_bf16 v[24:27], v[164:167], v[212:215], v[24:27]
    s_waitcnt lgkmcnt(2)
    v_exp_f32 v14, v14
    v_mfma_f32_16x16x32_bf16 v[28:31], v[168:171], a[192:195], v[128:131]
    v_mfma_f32_16x16x32_bf16 v[28:31], v[172:175], a[196:199], v[28:31]
    s_waitcnt lgkmcnt(0)
    v_exp_f32 v15, v15
    v_mfma_f32_16x16x32_bf16 v[28:31], v[176:179], a[200:203], v[28:31]
    v_cvt_pk_bf16_f32 v101, v14, v15
    v_mfma_f32_16x16x32_bf16 v[28:31], v[180:183], a[204:207], v[28:31]
    v_exp_f32 v16, v16
    v_mfma_f32_16x16x32_bf16 v[32:35], v[180:183], a[220:223], v[132:135]
    ds_read_b64_tr_b16 v[152:153], v224 offset:16384
    v_add_f32 v236, v16, v236
    v_mfma_f32_16x16x32_bf16 v[32:35], v[176:179], a[216:219], v[32:35]
    buffer_load_dwordx4 v232, s[12:15], s27 offen offset:2048 nt lds
    v_mfma_f32_16x16x32_bf16 v[32:35], v[172:175], a[212:215], v[32:35]
    ds_read_b64_tr_b16 v[154:155], v224 offset:20480
    v_mfma_f32_16x16x32_bf16 v[32:35], v[168:171], a[208:211], v[32:35]
    v_exp_f32 v17, v17
    v_mfma_f32_16x16x32_bf16 v[36:39], v[168:171], a[224:227], v[136:139]
    ds_read_b64_tr_b16 v[156:157], v224 offset:24576
    v_add_f32 v236, v17, v236
    v_mfma_f32_16x16x32_bf16 v[36:39], v[172:175], a[228:231], v[36:39]
    v_exp_f32 v18, v18
    v_mfma_f32_16x16x32_bf16 v[36:39], v[176:179], a[232:235], v[36:39]
    ds_read_b64_tr_b16 v[158:159], v224 offset:28672
    v_cvt_pk_bf16_f32 v108, v16, v17
    v_mfma_f32_16x16x32_bf16 v[36:39], v[180:183], a[236:239], v[36:39]
    v_exp_f32 v19, v19
    v_mfma_f32_16x16x32_bf16 v[40:43], v[180:183], a[252:255], v[140:143]
    v_exp_f32 v20, v20
    v_mfma_f32_16x16x32_bf16 v[40:43], v[176:179], a[248:251], v[40:43]
    v_exp_f32 v21, v21
    v_mfma_f32_16x16x32_bf16 v[40:43], v[172:175], a[244:247], v[40:43]
    v_add_f32 v236, v18, v236
    v_add_f32 v236, v19, v236
    v_mfma_f32_16x16x32_bf16 v[40:43], v[168:171], a[240:243], v[40:43]
    ds_read_b64_tr_b16 v[160:161], v225 offset:16384
    v_cvt_pk_bf16_f32 v109, v18, v19
    v_mfma_f32_16x16x32_bf16 v[44:47], v[168:171], v[200:203], v[148:151]
    v_exp_f32 v22, v22
    v_mfma_f32_16x16x32_bf16 v[44:47], v[172:175], v[204:207], v[44:47]
    ds_read_b64_tr_b16 v[162:163], v225 offset:20480
    v_add_f32 v237, v20, v237
    v_mfma_f32_16x16x32_bf16 v[44:47], v[176:179], v[208:211], v[44:47]
    v_exp_f32 v23, v23
    v_mfma_f32_16x16x32_bf16 v[44:47], v[180:183], v[212:215], v[44:47]
    s_waitcnt lgkmcnt(2)
    ds_read_b64_tr_b16 v[164:165], v225 offset:24576
    v_add_f32 v237, v21, v237
    v_mfma_f32_16x16x32_bf16 a[16:19], v[48:51], v[152:155], a[16:19]
    buffer_load_dwordx4 v233, s[12:15], s27 offen offset:3072 nt lds
    v_mfma_f32_16x16x32_bf16 a[16:19], v[52:55], v[156:159], a[16:19]
    s_add_u32 s29, s29, 32768
    ds_read_b64_tr_b16 v[166:167], v225 offset:28672
    v_cvt_pk_bf16_f32 v116, v20, v21
    v_mfma_f32_16x16x32_bf16 a[48:51], v[60:63], v[156:159], a[48:51]
    s_and_b32 s29, s29, 131071
    ds_read_b64_tr_b16 v[168:169], v226 offset:16384
    v_add_f32 v237, v22, v237
    v_mfma_f32_16x16x32_bf16 a[48:51], v[56:59], v[152:155], a[48:51]
    s_add_u32 s27, s27, 16384
    v_exp_f32 v24, v24
    v_mfma_f32_16x16x32_bf16 a[80:83], v[64:67], v[152:155], a[80:83]
    s_cmp_lt_u32 s27, 524288
    ds_read_b64_tr_b16 v[170:171], v226 offset:20480
    v_add_f32 v237, v23, v237
    v_mfma_f32_16x16x32_bf16 a[80:83], v[68:71], v[156:159], a[80:83]
    s_cselect_b32 s14, 524288, 0
    v_exp_f32 v25, v25
    v_mfma_f32_16x16x32_bf16 a[112:115], v[76:79], v[156:159], a[112:115]
    ds_read_b64_tr_b16 v[172:173], v226 offset:24576
    v_cvt_pk_bf16_f32 v117, v22, v23
    v_mfma_f32_16x16x32_bf16 a[112:115], v[72:75], v[152:155], a[112:115]
    v_exp_f32 v26, v26
    v_mfma_f32_16x16x32_bf16 a[144:147], v[80:83], v[152:155], a[144:147]
    ds_read_b64_tr_b16 v[174:175], v226 offset:28672
    v_add_f32 v239, v24, v239
    v_mfma_f32_16x16x32_bf16 a[144:147], v[84:87], v[156:159], a[144:147]
    s_waitcnt lgkmcnt(4)
    v_exp_f32 v27, v27
    v_mfma_f32_16x16x32_bf16 a[148:151], v[84:87], v[164:167], a[148:151]
    ds_read_b64_tr_b16 v[176:177], v227 offset:16384
    v_add_f32 v239, v25, v239
    v_mfma_f32_16x16x32_bf16 a[148:151], v[80:83], v[160:163], a[148:151]
    v_exp_f32 v28, v28
    v_mfma_f32_16x16x32_bf16 a[116:119], v[72:75], v[160:163], a[116:119]
    ds_read_b64_tr_b16 v[178:179], v227 offset:20480
    v_cvt_pk_bf16_f32 v124, v24, v25
    v_mfma_f32_16x16x32_bf16 a[116:119], v[76:79], v[164:167], a[116:119]
    v_exp_f32 v29, v29
    v_mfma_f32_16x16x32_bf16 a[84:87], v[68:71], v[164:167], a[84:87]
    ds_read_b64_tr_b16 v[180:181], v227 offset:24576
    v_add_f32 v239, v26, v239
    v_mfma_f32_16x16x32_bf16 a[84:87], v[64:67], v[160:163], a[84:87]
    v_exp_f32 v30, v30
    v_mfma_f32_16x16x32_bf16 a[52:55], v[56:59], v[160:163], a[52:55]
    ds_read_b64_tr_b16 v[182:183], v227 offset:28672
    v_add_f32 v239, v27, v239
    v_mfma_f32_16x16x32_bf16 a[52:55], v[60:63], v[164:167], a[52:55]
    v_exp_f32 v31, v31
    v_mfma_f32_16x16x32_bf16 a[20:23], v[52:55], v[164:167], a[20:23]
    v_exp_f32 v32, v32
    v_mfma_f32_16x16x32_bf16 a[20:23], v[48:51], v[160:163], a[20:23]
    v_exp_f32 v33, v33
    v_mfma_f32_16x16x32_bf16 v[248:251], v[240:243], v[56:59], v[248:251]
    v_exp_f32 v34, v34
    v_mfma_f32_16x16x32_bf16 v[248:251], v[240:243], v[60:63], v[248:251]
    s_waitcnt lgkmcnt(4)
    v_cvt_pk_bf16_f32 v125, v26, v27
    v_cvt_pk_bf16_f32 v94, v28, v29
    v_mfma_f32_16x16x32_bf16 a[24:27], v[48:51], v[168:171], a[24:27]
    v_exp_f32 v35, v35
    v_mfma_f32_16x16x32_bf16 a[24:27], v[52:55], v[172:175], a[24:27]
    s_waitcnt vmcnt(8) lgkmcnt(0)
    v_cvt_pk_bf16_f32 v95, v30, v31
    v_cvt_pk_bf16_f32 v102, v32, v33
    v_mfma_f32_16x16x32_bf16 a[56:59], v[60:63], v[172:175], a[56:59]
    s_barrier
    v_mfma_f32_16x16x32_bf16 a[56:59], v[56:59], v[168:171], a[56:59]
    v_exp_f32 v36, v36
    v_mfma_f32_16x16x32_bf16 a[88:91], v[64:67], v[168:171], a[88:91]
    ds_read_b128 v[152:155], v216 offset:32768
    v_cvt_pk_bf16_f32 v103, v34, v35
    v_mfma_f32_16x16x32_bf16 a[88:91], v[68:71], v[172:175], a[88:91]
    v_exp_f32 v37, v37
    v_mfma_f32_16x16x32_bf16 a[120:123], v[76:79], v[172:175], a[120:123]
    ds_read_b128 v[156:159], v217 offset:32768
    v_add_f32 v236, v36, v236
    v_mfma_f32_16x16x32_bf16 a[120:123], v[72:75], v[168:171], a[120:123]
    v_exp_f32 v38, v38
    v_mfma_f32_16x16x32_bf16 a[152:155], v[80:83], v[168:171], a[152:155]
    ds_read_b128 v[160:163], v218 offset:32768
    v_add_f32 v236, v37, v236
    v_mfma_f32_16x16x32_bf16 a[152:155], v[84:87], v[172:175], a[152:155]
    v_exp_f32 v39, v39
    v_mfma_f32_16x16x32_bf16 a[156:159], v[84:87], v[180:183], a[156:159]
    ds_read_b128 v[164:167], v219 offset:32768
    v_cvt_pk_bf16_f32 v110, v36, v37
    v_mfma_f32_16x16x32_bf16 a[156:159], v[80:83], v[176:179], a[156:159]
    v_exp_f32 v40, v40
    v_mfma_f32_16x16x32_bf16 a[124:127], v[72:75], v[176:179], a[124:127]
    v_exp_f32 v41, v41
    v_mfma_f32_16x16x32_bf16 a[124:127], v[76:79], v[180:183], a[124:127]
    v_add_f32 v236, v38, v236
    v_add_f32 v236, v39, v236
    v_mfma_f32_16x16x32_bf16 a[92:95], v[68:71], v[180:183], a[92:95]
    v_exp_f32 v42, v42
    v_mfma_f32_16x16x32_bf16 a[92:95], v[64:67], v[176:179], a[92:95]
    v_cvt_pk_bf16_f32 v111, v38, v39
    v_add_f32 v237, v40, v237
    v_mfma_f32_16x16x32_bf16 a[60:63], v[56:59], v[176:179], a[60:63]
    v_exp_f32 v43, v43
    v_mfma_f32_16x16x32_bf16 a[60:63], v[60:63], v[180:183], a[60:63]
    v_add_f32 v237, v41, v237
    v_cvt_pk_bf16_f32 v118, v40, v41
    v_mfma_f32_16x16x32_bf16 a[28:31], v[52:55], v[180:183], a[28:31]
    s_sub_u32 s25, s25, 1
    v_exp_f32 v44, v44
    v_mfma_f32_16x16x32_bf16 a[28:31], v[48:51], v[176:179], a[28:31]
    s_waitcnt lgkmcnt(2)
    v_add_f32 v237, v42, v237
    s_cbranch_scc1 L_tail1
    v_mfma_f32_16x16x32_bf16 v[8:11], v[152:155], a[192:195], v[128:131]
    v_exp_f32 v45, v45
    v_mfma_f32_16x16x32_bf16 v[8:11], v[156:159], a[196:199], v[8:11]
    s_waitcnt lgkmcnt(0)
    v_add_f32 v237, v43, v237
    v_cvt_pk_bf16_f32 v119, v42, v43
    v_mfma_f32_16x16x32_bf16 v[8:11], v[160:163], a[200:203], v[8:11]
    v_exp_f32 v46, v46
    v_mfma_f32_16x16x32_bf16 v[8:11], v[164:167], a[204:207], v[8:11]
    v_add_f32 v239, v44, v239
    v_add_f32 v239, v45, v239
    v_mfma_f32_16x16x32_bf16 v[12:15], v[164:167], a[220:223], v[132:135]
    ds_read_b128 v[168:171], v216 offset:36864
    v_cvt_pk_bf16_f32 v126, v44, v45
    v_mfma_f32_16x16x32_bf16 v[12:15], v[160:163], a[216:219], v[12:15]
    v_exp_f32 v47, v47
    v_mfma_f32_16x16x32_bf16 v[12:15], v[156:159], a[212:215], v[12:15]
    s_mov_b32 m0, s28
    ds_read_b128 v[172:175], v217 offset:36864
    v_add_f32 v239, v46, v239
    v_mfma_f32_16x16x32_bf16 v[12:15], v[152:155], a[208:211], v[12:15]
    buffer_load_dwordx4 v228, s[8:11], s26 offen offset:0 nt lds
    v_mfma_f32_16x16x32_bf16 v[16:19], v[152:155], a[224:227], v[136:139]
    ds_read_b128 v[176:179], v218 offset:36864
    v_add_f32 v239, v47, v239
    v_mfma_f32_16x16x32_bf16 v[16:19], v[156:159], a[228:231], v[16:19]
    v_exp_f32 v8, v8
    v_mfma_f32_16x16x32_bf16 v[16:19], v[160:163], a[232:235], v[16:19]
    ds_read_b128 v[180:183], v219 offset:36864
    v_cvt_pk_bf16_f32 v127, v46, v47
    v_mfma_f32_16x16x32_bf16 v[16:19], v[164:167], a[236:239], v[16:19]
    v_exp_f32 v9, v9
    v_mfma_f32_16x16x32_bf16 v[20:23], v[164:167], a[252:255], v[140:143]
    v_exp_f32 v10, v10
    v_mfma_f32_16x16x32_bf16 v[20:23], v[160:163], a[248:251], v[20:23]
    v_exp_f32 v11, v11
    v_mfma_f32_16x16x32_bf16 v[20:23], v[156:159], a[244:247], v[20:23]
    v_cvt_pk_bf16_f32 v48, v8, v9
    v_cvt_pk_bf16_f32 v49, v10, v11
    v_mfma_f32_16x16x32_bf16 v[20:23], v[152:155], a[240:243], v[20:23]
    v_exp_f32 v12, v12
    v_mfma_f32_16x16x32_bf16 v[24:27], v[152:155], v[184:187], v[144:147]
    v_mfma_f32_16x16x32_bf16 v[24:27], v[156:159], v[188:191], v[24:27]
    v_exp_f32 v13, v13
    v_mfma_f32_16x16x32_bf16 v[24:27], v[160:163], v[192:195], v[24:27]
    v_cvt_pk_bf16_f32 v56, v12, v13
    v_mfma_f32_16x16x32_bf16 v[24:27], v[164:167], v[196:199], v[24:27]
    s_waitcnt lgkmcnt(2)
    v_exp_f32 v14, v14
    v_mfma_f32_16x16x32_bf16 v[28:31], v[168:171], a[192:195], v[128:131]
    v_mfma_f32_16x16x32_bf16 v[28:31], v[172:175], a[196:199], v[28:31]
    s_waitcnt lgkmcnt(0)
    buffer_load_dwordx4 v229, s[8:11], s26 offen offset:1024 nt lds
    v_mfma_f32_16x16x32_bf16 v[28:31], v[176:179], a[200:203], v[28:31]
    v_exp_f32 v15, v15
    v_mfma_f32_16x16x32_bf16 v[28:31], v[180:183], a[204:207], v[28:31]
    v_exp_f32 v16, v16
    v_mfma_f32_16x16x32_bf16 v[32:35], v[180:183], a[220:223], v[132:135]
    ds_read_b64_tr_b16 v[152:153], v220 offset:49152
    v_cvt_pk_bf16_f32 v57, v14, v15
    v_mfma_f32_16x16x32_bf16 v[32:35], v[176:179], a[216:219], v[32:35]
    v_exp_f32 v17, v17
    v_mfma_f32_16x16x32_bf16 v[32:35], v[172:175], a[212:215], v[32:35]
    ds_read_b64_tr_b16 v[154:155], v220 offset:53248
    v_add_f32 v236, v16, v236
    v_mfma_f32_16x16x32_bf16 v[32:35], v[168:171], a[208:211], v[32:35]
    v_exp_f32 v18, v18
    v_mfma_f32_16x16x32_bf16 v[36:39], v[168:171], a[224:227], v[136:139]
    ds_read_b64_tr_b16 v[156:157], v220 offset:57344
    v_add_f32 v236, v17, v236
    v_mfma_f32_16x16x32_bf16 v[36:39], v[172:175], a[228:231], v[36:39]
    v_exp_f32 v19, v19
    v_mfma_f32_16x16x32_bf16 v[36:39], v[176:179], a[232:235], v[36:39]
    ds_read_b64_tr_b16 v[158:159], v220 offset:61440
    v_cvt_pk_bf16_f32 v64, v16, v17
    v_mfma_f32_16x16x32_bf16 v[36:39], v[180:183], a[236:239], v[36:39]
    v_exp_f32 v20, v20
    v_mfma_f32_16x16x32_bf16 v[40:43], v[180:183], a[252:255], v[140:143]
    v_add_f32 v236, v18, v236
    v_add_f32 v236, v19, v236
    v_mfma_f32_16x16x32_bf16 v[40:43], v[176:179], a[248:251], v[40:43]
    v_exp_f32 v21, v21
    v_mfma_f32_16x16x32_bf16 v[40:43], v[172:175], a[244:247], v[40:43]
    ds_read_b64_tr_b16 v[160:161], v221 offset:49152
    v_cvt_pk_bf16_f32 v65, v18, v19
    v_mfma_f32_16x16x32_bf16 v[40:43], v[168:171], a[240:243], v[40:43]
    v_exp_f32 v22, v22
    v_mfma_f32_16x16x32_bf16 v[44:47], v[168:171], v[184:187], v[144:147]
    ds_read_b64_tr_b16 v[162:163], v221 offset:53248
    v_add_f32 v237, v20, v237
    v_mfma_f32_16x16x32_bf16 v[44:47], v[172:175], v[188:191], v[44:47]
    buffer_load_dwordx4 v230, s[8:11], s26 offen offset:2048 nt lds
    v_mfma_f32_16x16x32_bf16 v[44:47], v[176:179], v[192:195], v[44:47]
    ds_read_b64_tr_b16 v[164:165], v221 offset:57344
    v_add_f32 v237, v21, v237
    v_mfma_f32_16x16x32_bf16 v[44:47], v[180:183], v[196:199], v[44:47]
    s_waitcnt lgkmcnt(3)
    v_exp_f32 v23, v23
    v_mfma_f32_16x16x32_bf16 a[0:3], v[88:91], v[152:155], a[0:3]
    ds_read_b64_tr_b16 v[166:167], v221 offset:61440
    v_cvt_pk_bf16_f32 v72, v20, v21
    v_mfma_f32_16x16x32_bf16 a[0:3], v[92:95], v[156:159], a[0:3]
    v_exp_f32 v24, v24
    v_mfma_f32_16x16x32_bf16 a[32:35], v[100:103], v[156:159], a[32:35]
    v_exp_f32 v25, v25
    v_mfma_f32_16x16x32_bf16 a[32:35], v[96:99], v[152:155], a[32:35]
    v_exp_f32 v26, v26
    v_mfma_f32_16x16x32_bf16 a[64:67], v[104:107], v[152:155], a[64:67]
    ds_read_b64_tr_b16 v[168:169], v222 offset:49152
    v_add_f32 v237, v22, v237
    v_mfma_f32_16x16x32_bf16 a[64:67], v[108:111], v[156:159], a[64:67]
    v_exp_f32 v27, v27
    v_mfma_f32_16x16x32_bf16 a[96:99], v[116:119], v[156:159], a[96:99]
    ds_read_b64_tr_b16 v[170:171], v222 offset:53248
    v_add_f32 v237, v23, v237
    v_mfma_f32_16x16x32_bf16 a[96:99], v[112:115], v[152:155], a[96:99]
    v_exp_f32 v28, v28
    v_mfma_f32_16x16x32_bf16 a[160:163], v[124:127], v[156:159], a[160:163]
    s_waitcnt lgkmcnt(2)
    ds_read_b64_tr_b16 v[172:173], v222 offset:57344
    v_cvt_pk_bf16_f32 v73, v22, v23
    v_mfma_f32_16x16x32_bf16 a[164:167], v[124:127], v[164:167], a[164:167]
    v_exp_f32 v29, v29
    v_mfma_f32_16x16x32_bf16 a[100:103], v[112:115], v[160:163], a[100:103]
    ds_read_b64_tr_b16 v[174:175], v222 offset:61440
    v_add_f32 v238, v24, v238
    v_mfma_f32_16x16x32_bf16 a[100:103], v[116:119], v[164:167], a[100:103]
    v_exp_f32 v30, v30
    v_xor_b32 v222, 0x10000, v222
    v_mfma_f32_16x16x32_bf16 a[68:71], v[108:111], v[164:167], a[68:71]
    buffer_load_dwordx4 v231, s[8:11], s26 offen offset:3072 nt lds
    v_mfma_f32_16x16x32_bf16 a[68:71], v[104:107], v[160:163], a[68:71]
    s_add_u32 s28, s28, 32768
    v_add_f32 v238, v25, v238
    v_cvt_pk_bf16_f32 v80, v24, v25
    v_mfma_f32_16x16x32_bf16 a[36:39], v[96:99], v[160:163], a[36:39]
    s_and_b32 s28, s28, 131071
    ds_read_b64_tr_b16 v[176:177], v223 offset:49152
    v_add_f32 v238, v26, v238
    v_mfma_f32_16x16x32_bf16 a[36:39], v[100:103], v[164:167], a[36:39]
    s_add_u32 s26, s26, 16384
    v_exp_f32 v31, v31
    v_mfma_f32_16x16x32_bf16 a[4:7], v[92:95], v[164:167], a[4:7]
    s_cmp_lt_u32 s26, 524288
    ds_read_b64_tr_b16 v[178:179], v223 offset:53248
    v_add_f32 v238, v27, v238
    v_mfma_f32_16x16x32_bf16 a[4:7], v[88:91], v[160:163], a[4:7]
    s_cselect_b32 s10, 524288, 0
    v_exp_f32 v32, v32
    v_mfma_f32_16x16x32_bf16 v[244:247], v[240:243], v[88:91], v[244:247]
    ds_read_b64_tr_b16 v[180:181], v223 offset:57344
    v_cvt_pk_bf16_f32 v81, v26, v27
    v_mfma_f32_16x16x32_bf16 v[244:247], v[240:243], v[92:95], v[244:247]
    s_waitcnt lgkmcnt(3)
    v_exp_f32 v33, v33
    v_mfma_f32_16x16x32_bf16 a[8:11], v[88:91], v[168:171], a[8:11]
    ds_read_b64_tr_b16 v[182:183], v223 offset:61440
    v_cvt_pk_bf16_f32 v50, v28, v29
    v_mfma_f32_16x16x32_bf16 a[8:11], v[92:95], v[172:175], a[8:11]
    v_exp_f32 v34, v34
    v_xor_b32 v223, 0x10000, v223
    v_mfma_f32_16x16x32_bf16 a[40:43], v[100:103], v[172:175], a[40:43]
    ds_read_b128 v[152:155], v216 offset:40960
    v_cvt_pk_bf16_f32 v51, v30, v31
    v_mfma_f32_16x16x32_bf16 a[40:43], v[96:99], v[168:171], a[40:43]
    v_exp_f32 v35, v35
    v_mfma_f32_16x16x32_bf16 a[72:75], v[104:107], v[168:171], a[72:75]
    ds_read_b128 v[156:159], v217 offset:40960
    v_cvt_pk_bf16_f32 v58, v32, v33
    v_mfma_f32_16x16x32_bf16 a[72:75], v[108:111], v[172:175], a[72:75]
    v_exp_f32 v36, v36
    v_mfma_f32_16x16x32_bf16 a[104:107], v[116:119], v[172:175], a[104:107]
    ds_read_b128 v[160:163], v218 offset:40960
    v_cvt_pk_bf16_f32 v59, v34, v35
    v_mfma_f32_16x16x32_bf16 a[104:107], v[112:115], v[168:171], a[104:107]
    s_mov_b32 m0, s29
    v_exp_f32 v37, v37
    v_mfma_f32_16x16x32_bf16 a[168:171], v[124:127], v[172:175], a[168:171]
    s_waitcnt lgkmcnt(3)
    ds_read_b128 v[164:167], v219 offset:40960
    v_add_f32 v236, v36, v236
    v_mfma_f32_16x16x32_bf16 a[172:175], v[124:127], v[180:183], a[172:175]
    buffer_load_dwordx4 v232, s[12:15], s27 offen offset:0 nt lds
    v_mfma_f32_16x16x32_bf16 a[108:111], v[112:115], v[176:179], a[108:111]
    v_exp_f32 v38, v38
    v_mfma_f32_16x16x32_bf16 a[108:111], v[116:119], v[180:183], a[108:111]
    v_exp_f32 v39, v39
    v_mfma_f32_16x16x32_bf16 a[76:79], v[108:111], v[180:183], a[76:79]
    v_exp_f32 v40, v40
    v_mfma_f32_16x16x32_bf16 a[76:79], v[104:107], v[176:179], a[76:79]
    v_add_f32 v236, v37, v236
    v_cvt_pk_bf16_f32 v66, v36, v37
    v_mfma_f32_16x16x32_bf16 a[44:47], v[96:99], v[176:179], a[44:47]
    v_exp_f32 v41, v41
    v_mfma_f32_16x16x32_bf16 a[44:47], v[100:103], v[180:183], a[44:47]
    v_add_f32 v236, v38, v236
    v_add_f32 v236, v39, v236
    v_mfma_f32_16x16x32_bf16 a[12:15], v[92:95], v[180:183], a[12:15]
    v_exp_f32 v42, v42
    v_mfma_f32_16x16x32_bf16 a[12:15], v[88:91], v[176:179], a[12:15]
    s_waitcnt lgkmcnt(2)
    v_cvt_pk_bf16_f32 v67, v38, v39
    v_add_f32 v237, v40, v237
    v_mfma_f32_16x16x32_bf16 v[8:11], v[152:155], a[192:195], v[128:131]
    v_exp_f32 v43, v43
    v_mfma_f32_16x16x32_bf16 v[8:11], v[156:159], a[196:199], v[8:11]
    s_waitcnt lgkmcnt(0)
    v_add_f32 v237, v41, v237
    v_cvt_pk_bf16_f32 v74, v40, v41
    v_mfma_f32_16x16x32_bf16 v[8:11], v[160:163], a[200:203], v[8:11]
    v_exp_f32 v44, v44
    v_mfma_f32_16x16x32_bf16 v[8:11], v[164:167], a[204:207], v[8:11]
    v_add_f32 v237, v42, v237
    v_add_f32 v237, v43, v237
    v_mfma_f32_16x16x32_bf16 v[12:15], v[164:167], a[220:223], v[132:135]
    ds_read_b128 v[168:171], v216 offset:45056
    v_cvt_pk_bf16_f32 v75, v42, v43
    v_mfma_f32_16x16x32_bf16 v[12:15], v[160:163], a[216:219], v[12:15]
    buffer_load_dwordx4 v233, s[12:15], s27 offen offset:1024 nt lds
    v_mfma_f32_16x16x32_bf16 v[12:15], v[156:159], a[212:215], v[12:15]
    ds_read_b128 v[172:175], v217 offset:45056
    v_add_f32 v238, v44, v238
    v_mfma_f32_16x16x32_bf16 v[12:15], v[152:155], a[208:211], v[12:15]
    v_exp_f32 v45, v45
    v_mfma_f32_16x16x32_bf16 v[16:19], v[152:155], a[224:227], v[136:139]
    ds_read_b128 v[176:179], v218 offset:45056
    v_add_f32 v238, v45, v238
    v_mfma_f32_16x16x32_bf16 v[16:19], v[156:159], a[228:231], v[16:19]
    v_exp_f32 v46, v46
    v_mfma_f32_16x16x32_bf16 v[16:19], v[160:163], a[232:235], v[16:19]
    ds_read_b128 v[180:183], v219 offset:45056
    v_cvt_pk_bf16_f32 v82, v44, v45
    v_mfma_f32_16x16x32_bf16 v[16:19], v[164:167], a[236:239], v[16:19]
    v_exp_f32 v47, v47
    v_mfma_f32_16x16x32_bf16 v[20:23], v[164:167], a[252:255], v[140:143]
    v_exp_f32 v8, v8
    v_mfma_f32_16x16x32_bf16 v[20:23], v[160:163], a[248:251], v[20:23]
    v_exp_f32 v9, v9
    v_mfma_f32_16x16x32_bf16 v[20:23], v[156:159], a[244:247], v[20:23]
    v_add_f32 v238, v46, v238
    v_add_f32 v238, v47, v238
    v_mfma_f32_16x16x32_bf16 v[20:23], v[152:155], a[240:243], v[20:23]
    v_exp_f32 v10, v10
    v_mfma_f32_16x16x32_bf16 v[24:27], v[152:155], v[184:187], v[144:147]
    v_cvt_pk_bf16_f32 v83, v46, v47
    v_cvt_pk_bf16_f32 v52, v8, v9
    v_mfma_f32_16x16x32_bf16 v[24:27], v[156:159], v[188:191], v[24:27]
    v_exp_f32 v11, v11
    v_mfma_f32_16x16x32_bf16 v[24:27], v[160:163], v[192:195], v[24:27]
    v_cvt_pk_bf16_f32 v53, v10, v11
    v_xor_b32 v217, 0x10000, v217
    v_mfma_f32_16x16x32_bf16 v[24:27], v[164:167], v[196:199], v[24:27]
    s_waitcnt lgkmcnt(2)
    v_exp_f32 v12, v12
    v_mfma_f32_16x16x32_bf16 v[28:31], v[168:171], a[192:195], v[128:131]
    v_xor_b32 v216, 0x10000, v216
    v_xor_b32 v218, 0x10000, v218
    v_mfma_f32_16x16x32_bf16 v[28:31], v[172:175], a[196:199], v[28:31]
    s_waitcnt lgkmcnt(0)
    buffer_load_dwordx4 v232, s[12:15], s27 offen offset:2048 nt lds
    v_mfma_f32_16x16x32_bf16 v[28:31], v[176:179], a[200:203], v[28:31]
    v_exp_f32 v13, v13
    v_mfma_f32_16x16x32_bf16 v[28:31], v[180:183], a[204:207], v[28:31]
    v_exp_f32 v14, v14
    v_mfma_f32_16x16x32_bf16 v[32:35], v[180:183], a[220:223], v[132:135]
    ds_read_b64_tr_b16 v[152:153], v224 offset:49152
    v_cvt_pk_bf16_f32 v60, v12, v13
    v_mfma_f32_16x16x32_bf16 v[32:35], v[176:179], a[216:219], v[32:35]
    v_exp_f32 v15, v15
    v_mfma_f32_16x16x32_bf16 v[32:35], v[172:175], a[212:215], v[32:35]
    ds_read_b64_tr_b16 v[154:155], v224 offset:53248
    v_cvt_pk_bf16_f32 v61, v14, v15
    v_mfma_f32_16x16x32_bf16 v[32:35], v[168:171], a[208:211], v[32:35]
    v_exp_f32 v16, v16
    v_mfma_f32_16x16x32_bf16 v[36:39], v[168:171], a[224:227], v[136:139]
    ds_read_b64_tr_b16 v[156:157], v224 offset:57344
    v_add_f32 v236, v16, v236
    v_mfma_f32_16x16x32_bf16 v[36:39], v[172:175], a[228:231], v[36:39]
    v_exp_f32 v17, v17
    v_mfma_f32_16x16x32_bf16 v[36:39], v[176:179], a[232:235], v[36:39]
    ds_read_b64_tr_b16 v[158:159], v224 offset:61440
    v_add_f32 v236, v17, v236
    v_mfma_f32_16x16x32_bf16 v[36:39], v[180:183], a[236:239], v[36:39]
    v_exp_f32 v18, v18
    v_xor_b32 v224, 0x10000, v224
    v_mfma_f32_16x16x32_bf16 v[40:43], v[180:183], a[252:255], v[140:143]
    v_cvt_pk_bf16_f32 v68, v16, v17
    v_add_f32 v236, v18, v236
    v_mfma_f32_16x16x32_bf16 v[40:43], v[176:179], a[248:251], v[40:43]
    v_exp_f32 v19, v19
    v_mfma_f32_16x16x32_bf16 v[40:43], v[172:175], a[244:247], v[40:43]
    ds_read_b64_tr_b16 v[160:161], v225 offset:49152
    v_add_f32 v236, v19, v236
    v_mfma_f32_16x16x32_bf16 v[40:43], v[168:171], a[240:243], v[40:43]
    v_exp_f32 v20, v20
    v_mfma_f32_16x16x32_bf16 v[44:47], v[168:171], v[184:187], v[144:147]
    ds_read_b64_tr_b16 v[162:163], v225 offset:53248
    v_cvt_pk_bf16_f32 v69, v18, v19
    v_mfma_f32_16x16x32_bf16 v[44:47], v[172:175], v[188:191], v[44:47]
    buffer_load_dwordx4 v233, s[12:15], s27 offen offset:3072 nt lds
    v_mfma_f32_16x16x32_bf16 v[44:47], v[176:179], v[192:195], v[44:47]
    s_add_u32 s29, s29, 32768
    ds_read_b64_tr_b16 v[164:165], v225 offset:57344
    v_add_f32 v237, v20, v237
    v_mfma_f32_16x16x32_bf16 v[44:47], v[180:183], v[196:199], v[44:47]
    s_waitcnt lgkmcnt(3)
    v_exp_f32 v21, v21
    v_mfma_f32_16x16x32_bf16 a[16:19], v[88:91], v[152:155], a[16:19]
    s_and_b32 s29, s29, 131071
    ds_read_b64_tr_b16 v[166:167], v225 offset:61440
    v_add_f32 v237, v21, v237
    v_mfma_f32_16x16x32_bf16 a[16:19], v[92:95], v[156:159], a[16:19]
    s_add_u32 s27, s27, 16384
    ds_read_b64_tr_b16 v[168:169], v226 offset:49152
    v_cvt_pk_bf16_f32 v76, v20, v21
    v_xor_b32 v225, 0x10000, v225
    v_mfma_f32_16x16x32_bf16 a[48:51], v[100:103], v[156:159], a[48:51]
    s_cmp_lt_u32 s27, 524288
    ds_read_b64_tr_b16 v[170:171], v226 offset:53248
    v_xor_b32 v219, 0x10000, v219
    v_mfma_f32_16x16x32_bf16 a[48:51], v[96:99], v[152:155], a[48:51]
    s_cselect_b32 s14, 524288, 0
    ds_read_b64_tr_b16 v[172:173], v226 offset:57344
    v_xor_b32 v220, 0x10000, v220
    v_mfma_f32_16x16x32_bf16 a[80:83], v[104:107], v[152:155], a[80:83]
    ds_read_b64_tr_b16 v[174:175], v226 offset:61440
    v_xor_b32 v221, 0x10000, v221
    v_mfma_f32_16x16x32_bf16 a[80:83], v[108:111], v[156:159], a[80:83]
    v_exp_f32 v22, v22
    v_xor_b32 v226, 0x10000, v226
    v_mfma_f32_16x16x32_bf16 a[112:115], v[116:119], v[156:159], a[112:115]
    ds_read_b64_tr_b16 v[176:177], v227 offset:49152
    v_add_f32 v237, v22, v237
    v_mfma_f32_16x16x32_bf16 a[112:115], v[112:115], v[152:155], a[112:115]
    v_exp_f32 v23, v23
    v_mfma_f32_16x16x32_bf16 a[176:179], v[124:127], v[156:159], a[176:179]
    s_waitcnt lgkmcnt(5)
    ds_read_b64_tr_b16 v[178:179], v227 offset:53248
    v_add_f32 v237, v23, v237
    v_mfma_f32_16x16x32_bf16 a[180:183], v[124:127], v[164:167], a[180:183]
    v_exp_f32 v24, v24
    v_mfma_f32_16x16x32_bf16 a[116:119], v[112:115], v[160:163], a[116:119]
    ds_read_b64_tr_b16 v[180:181], v227 offset:57344
    v_cvt_pk_bf16_f32 v77, v22, v23
    v_mfma_f32_16x16x32_bf16 a[116:119], v[116:119], v[164:167], a[116:119]
    v_exp_f32 v25, v25
    v_mfma_f32_16x16x32_bf16 a[84:87], v[108:111], v[164:167], a[84:87]
    ds_read_b64_tr_b16 v[182:183], v227 offset:61440
    v_add_f32 v238, v24, v238
    v_mfma_f32_16x16x32_bf16 a[84:87], v[104:107], v[160:163], a[84:87]
    v_exp_f32 v26, v26
    v_xor_b32 v227, 0x10000, v227
    v_mfma_f32_16x16x32_bf16 a[52:55], v[96:99], v[160:163], a[52:55]
    v_exp_f32 v27, v27
    v_mfma_f32_16x16x32_bf16 a[52:55], v[100:103], v[164:167], a[52:55]
    v_exp_f32 v28, v28
    v_mfma_f32_16x16x32_bf16 a[20:23], v[92:95], v[164:167], a[20:23]
    v_exp_f32 v29, v29
    v_mfma_f32_16x16x32_bf16 a[20:23], v[88:91], v[160:163], a[20:23]
    v_exp_f32 v30, v30
    v_mfma_f32_16x16x32_bf16 v[248:251], v[240:243], v[96:99], v[248:251]
    v_exp_f32 v31, v31
    v_mfma_f32_16x16x32_bf16 v[248:251], v[240:243], v[100:103], v[248:251]
    s_waitcnt vmcnt(8) lgkmcnt(0)
    v_add_f32 v238, v25, v238
    v_cvt_pk_bf16_f32 v84, v24, v25
    v_mfma_f32_16x16x32_bf16 a[24:27], v[88:91], v[168:171], a[24:27]
    s_barrier
    v_mfma_f32_16x16x32_bf16 a[24:27], v[92:95], v[172:175], a[24:27]
    v_exp_f32 v32, v32
    v_mfma_f32_16x16x32_bf16 a[56:59], v[100:103], v[172:175], a[56:59]
    ds_read_b128 v[152:155], v216 offset:0
    v_add_f32 v238, v26, v238
    v_mfma_f32_16x16x32_bf16 a[56:59], v[96:99], v[168:171], a[56:59]
    v_exp_f32 v33, v33
    v_mfma_f32_16x16x32_bf16 a[88:91], v[104:107], v[168:171], a[88:91]
    ds_read_b128 v[156:159], v217 offset:0
    v_add_f32 v238, v27, v238
    v_mfma_f32_16x16x32_bf16 a[88:91], v[108:111], v[172:175], a[88:91]
    v_exp_f32 v34, v34
    v_mfma_f32_16x16x32_bf16 a[120:123], v[116:119], v[172:175], a[120:123]
    ds_read_b128 v[160:163], v218 offset:0
    v_cvt_pk_bf16_f32 v85, v26, v27
    v_mfma_f32_16x16x32_bf16 a[120:123], v[112:115], v[168:171], a[120:123]
    v_exp_f32 v35, v35
    v_mfma_f32_16x16x32_bf16 a[184:187], v[124:127], v[172:175], a[184:187]
    ds_read_b128 v[164:167], v219 offset:0
    v_cvt_pk_bf16_f32 v54, v28, v29
    v_mfma_f32_16x16x32_bf16 a[188:191], v[124:127], v[180:183], a[188:191]
    v_exp_f32 v36, v36
    v_mfma_f32_16x16x32_bf16 a[124:127], v[112:115], v[176:179], a[124:127]
    v_exp_f32 v37, v37
    v_mfma_f32_16x16x32_bf16 a[124:127], v[116:119], v[180:183], a[124:127]
    v_cvt_pk_bf16_f32 v55, v30, v31
    v_cvt_pk_bf16_f32 v62, v32, v33
    v_mfma_f32_16x16x32_bf16 a[92:95], v[108:111], v[180:183], a[92:95]
    v_exp_f32 v38, v38
    v_mfma_f32_16x16x32_bf16 a[92:95], v[104:107], v[176:179], a[92:95]
    v_cvt_pk_bf16_f32 v63, v34, v35
    v_add_f32 v236, v36, v236
    v_mfma_f32_16x16x32_bf16 a[60:63], v[96:99], v[176:179], a[60:63]
    v_exp_f32 v39, v39
    v_mfma_f32_16x16x32_bf16 a[60:63], v[100:103], v[180:183], a[60:63]
    v_add_f32 v236, v37, v236
    v_cvt_pk_bf16_f32 v70, v36, v37
    v_mfma_f32_16x16x32_bf16 a[28:31], v[92:95], v[180:183], a[28:31]
    v_exp_f32 v40, v40
    v_mfma_f32_16x16x32_bf16 a[28:31], v[88:91], v[176:179], a[28:31]
    s_waitcnt lgkmcnt(2)
    s_branch L_loop1
.p2align 6
L_loop2:
    v_mfma_f32_16x16x32_bf16 v[8:11], v[152:155], a[192:195], v[128:131]
    v_exp_f32 v40, v40
    v_mfma_f32_16x16x32_bf16 v[8:11], v[156:159], a[196:199], v[8:11]
    s_waitcnt lgkmcnt(0)
    v_add_f32 v236, v39, v236
    v_cvt_pk_bf16_f32 v71, v38, v39
    v_mfma_f32_16x16x32_bf16 v[8:11], v[160:163], a[200:203], v[8:11]
    v_exp_f32 v41, v41
    v_mfma_f32_16x16x32_bf16 v[8:11], v[164:167], a[204:207], v[8:11]
    v_add_f32 v237, v40, v237
    v_add_f32 v237, v41, v237
    v_mfma_f32_16x16x32_bf16 v[12:15], v[164:167], a[220:223], v[132:135]
    ds_read_b128 v[168:171], v216 offset:4096
    v_cvt_pk_bf16_f32 v78, v40, v41
    v_mfma_f32_16x16x32_bf16 v[12:15], v[160:163], a[216:219], v[12:15]
    v_exp_f32 v42, v42
    v_mfma_f32_16x16x32_bf16 v[12:15], v[156:159], a[212:215], v[12:15]
    ds_read_b128 v[172:175], v217 offset:4096
    v_add_f32 v237, v42, v237
    v_mfma_f32_16x16x32_bf16 v[12:15], v[152:155], a[208:211], v[12:15]
    v_exp_f32 v43, v43
    v_mfma_f32_16x16x32_bf16 v[16:19], v[152:155], a[224:227], v[136:139]
    s_mov_b32 m0, s28
    ds_read_b128 v[176:179], v218 offset:4096
    v_add_f32 v237, v43, v237
    v_mfma_f32_16x16x32_bf16 v[16:19], v[156:159], a[228:231], v[16:19]
    buffer_load_dwordx4 v228, s[8:11], s26 offen offset:0 nt lds
    v_mfma_f32_16x16x32_bf16 v[16:19], v[160:163], a[232:235], v[16:19]
    ds_read_b128 v[180:183], v219 offset:4096
    v_cvt_pk_bf16_f32 v79, v42, v43
    v_mfma_f32_16x16x32_bf16 v[16:19], v[164:167], a[236:239], v[16:19]
    v_exp_f32 v8, v8
    v_mfma_f32_16x16x32_bf16 v[20:23], v[164:167], a[252:255], v[140:143]
    v_exp_f32 v9, v9
    v_mfma_f32_16x16x32_bf16 v[20:23], v[160:163], a[248:251], v[20:23]
    v_exp_f32 v10, v10
    v_mfma_f32_16x16x32_bf16 v[20:23], v[156:159], a[244:247], v[20:23]
    v_cvt_pk_bf16_f32 v88, v8, v9
    v_mfma_f32_16x16x32_bf16 v[20:23], v[152:155], a[240:243], v[20:23]
    v_exp_f32 v11, v11
    v_mfma_f32_16x16x32_bf16 v[24:27], v[152:155], v[184:187], v[144:147]
    v_cvt_pk_bf16_f32 v89, v10, v11
    v_mfma_f32_16x16x32_bf16 v[24:27], v[156:159], v[188:191], v[24:27]
    v_exp_f32 v12, v12
    v_mfma_f32_16x16x32_bf16 v[24:27], v[160:163], v[192:195], v[24:27]
    v_mfma_f32_16x16x32_bf16 v[24:27], v[164:167], v[196:199], v[24:27]
    s_waitcnt lgkmcnt(2)
    v_exp_f32 v13, v13
    v_mfma_f32_16x16x32_bf16 v[28:31], v[168:171], a[192:195], v[128:131]
    v_cvt_pk_bf16_f32 v96, v12, v13
    v_mfma_f32_16x16x32_bf16 v[28:31], v[172:175], a[196:199], v[28:31]
    s_waitcnt lgkmcnt(0)
    v_exp_f32 v14, v14
    v_mfma_f32_16x16x32_bf16 v[28:31], v[176:179], a[200:203], v[28:31]
    v_mfma_f32_16x16x32_bf16 v[28:31], v[180:183], a[204:207], v[28:31]
    v_exp_f32 v15, v15
    v_mfma_f32_16x16x32_bf16 v[32:35], v[180:183], a[220:223], v[132:135]
    ds_read_b64_tr_b16 v[152:153], v220 offset:16384
    v_cvt_pk_bf16_f32 v97, v14, v15
    v_mfma_f32_16x16x32_bf16 v[32:35], v[176:179], a[216:219], v[32:35]
    buffer_load_dwordx4 v229, s[8:11], s26 offen offset:1024 nt lds
    v_mfma_f32_16x16x32_bf16 v[32:35], v[172:175], a[212:215], v[32:35]
    ds_read_b64_tr_b16 v[154:155], v220 offset:20480
    v_mfma_f32_16x16x32_bf16 v[32:35], v[168:171], a[208:211], v[32:35]
    v_exp_f32 v16, v16
    v_mfma_f32_16x16x32_bf16 v[36:39], v[168:171], a[224:227], v[136:139]
    ds_read_b64_tr_b16 v[156:157], v220 offset:24576
    v_add_f32 v236, v16, v236
    v_mfma_f32_16x16x32_bf16 v[36:39], v[172:175], a[228:231], v[36:39]
    v_exp_f32 v17, v17
    v_mfma_f32_16x16x32_bf16 v[36:39], v[176:179], a[232:235], v[36:39]
    ds_read_b64_tr_b16 v[158:159], v220 offset:28672
    v_add_f32 v236, v17, v236
    v_mfma_f32_16x16x32_bf16 v[36:39], v[180:183], a[236:239], v[36:39]
    v_exp_f32 v18, v18
    v_mfma_f32_16x16x32_bf16 v[40:43], v[180:183], a[252:255], v[140:143]
    v_exp_f32 v19, v19
    v_mfma_f32_16x16x32_bf16 v[40:43], v[176:179], a[248:251], v[40:43]
    ds_read_b64_tr_b16 v[160:161], v221 offset:16384
    v_cvt_pk_bf16_f32 v104, v16, v17
    v_mfma_f32_16x16x32_bf16 v[40:43], v[172:175], a[244:247], v[40:43]
    v_exp_f32 v20, v20
    v_mfma_f32_16x16x32_bf16 v[40:43], v[168:171], a[240:243], v[40:43]
    ds_read_b64_tr_b16 v[162:163], v221 offset:20480
    v_add_f32 v236, v18, v236
    v_mfma_f32_16x16x32_bf16 v[44:47], v[168:171], v[184:187], v[144:147]
    v_exp_f32 v21, v21
    v_mfma_f32_16x16x32_bf16 v[44:47], v[172:175], v[188:191], v[44:47]
    ds_read_b64_tr_b16 v[164:165], v221 offset:24576
    v_add_f32 v236, v19, v236
    v_mfma_f32_16x16x32_bf16 v[44:47], v[176:179], v[192:195], v[44:47]
    v_exp_f32 v22, v22
    v_mfma_f32_16x16x32_bf16 v[44:47], v[180:183], v[196:199], v[44:47]
    s_waitcnt lgkmcnt(3)
    ds_read_b64_tr_b16 v[166:167], v221 offset:28672
    v_cvt_pk_bf16_f32 v105, v18, v19
    v_mfma_f32_16x16x32_bf16 a[0:3], v[48:51], v[152:155], a[0:3]
    buffer_load_dwordx4 v230, s[8:11], s26 offen offset:2048 nt lds
    v_mfma_f32_16x16x32_bf16 a[0:3], v[52:55], v[156:159], a[0:3]
    v_exp_f32 v23, v23
    v_mfma_f32_16x16x32_bf16 a[32:35], v[60:63], v[156:159], a[32:35]
    v_exp_f32 v24, v24
    v_mfma_f32_16x16x32_bf16 a[32:35], v[56:59], v[152:155], a[32:35]
    v_exp_f32 v25, v25
    v_mfma_f32_16x16x32_bf16 a[64:67], v[64:67], v[152:155], a[64:67]
    ds_read_b64_tr_b16 v[168:169], v222 offset:16384
    v_add_f32 v237, v20, v237
    v_mfma_f32_16x16x32_bf16 a[64:67], v[68:71], v[156:159], a[64:67]
    v_exp_f32 v26, v26
    v_mfma_f32_16x16x32_bf16 a[96:99], v[76:79], v[156:159], a[96:99]
    ds_read_b64_tr_b16 v[170:171], v222 offset:20480
    v_add_f32 v237, v21, v237
    v_mfma_f32_16x16x32_bf16 a[96:99], v[72:75], v[152:155], a[96:99]
    v_cvt_pk_bf16_f32 v112, v20, v21
    v_add_f32 v237, v22, v237
    v_mfma_f32_16x16x32_bf16 a[160:163], v[80:83], v[152:155], a[160:163]
    s_waitcnt lgkmcnt(2)
    ds_read_b64_tr_b16 v[172:173], v222 offset:24576
    v_add_f32 v237, v23, v237
    v_mfma_f32_16x16x32_bf16 a[164:167], v[80:83], v[160:163], a[164:167]
    v_exp_f32 v27, v27
    v_mfma_f32_16x16x32_bf16 a[100:103], v[72:75], v[160:163], a[100:103]
    ds_read_b64_tr_b16 v[174:175], v222 offset:28672
    v_cvt_pk_bf16_f32 v113, v22, v23
    v_mfma_f32_16x16x32_bf16 a[100:103], v[76:79], v[164:167], a[100:103]
    v_exp_f32 v28, v28
    v_mfma_f32_16x16x32_bf16 a[68:71], v[68:71], v[164:167], a[68:71]
    v_exp_f32 v29, v29
    v_mfma_f32_16x16x32_bf16 a[68:71], v[64:67], v[160:163], a[68:71]
    ds_read_b64_tr_b16 v[176:177], v223 offset:16384
    v_add_f32 v238, v24, v238
    v_mfma_f32_16x16x32_bf16 a[36:39], v[56:59], v[160:163], a[36:39]
    v_exp_f32 v30, v30
    v_mfma_f32_16x16x32_bf16 a[36:39], v[60:63], v[164:167], a[36:39]
    ds_read_b64_tr_b16 v[178:179], v223 offset:20480
    v_add_f32 v238, v25, v238
    v_mfma_f32_16x16x32_bf16 a[4:7], v[52:55], v[164:167], a[4:7]
    buffer_load_dwordx4 v231, s[8:11], s26 offen offset:3072 nt lds
    v_mfma_f32_16x16x32_bf16 a[4:7], v[48:51], v[160:163], a[4:7]
    s_add_u32 s28, s28, 32768
    ds_read_b64_tr_b16 v[180:181], v223 offset:24576
    v_cvt_pk_bf16_f32 v120, v24, v25
    v_mfma_f32_16x16x32_bf16 v[244:247], v[240:243], v[48:51], v[244:247]
    s_and_b32 s28, s28, 131071
    v_exp_f32 v31, v31
    v_mfma_f32_16x16x32_bf16 v[244:247], v[240:243], v[52:55], v[244:247]
    s_waitcnt lgkmcnt(3)
    ds_read_b64_tr_b16 v[182:183], v223 offset:28672
    v_add_f32 v238, v26, v238
    v_mfma_f32_16x16x32_bf16 a[8:11], v[48:51], v[168:171], a[8:11]
    s_add_u32 s26, s26, 16384
    v_exp_f32 v32, v32
    v_mfma_f32_16x16x32_bf16 a[8:11], v[52:55], v[172:175], a[8:11]
    s_cmp_lt_u32 s26, 524288
    v_exp_f32 v33, v33
    v_mfma_f32_16x16x32_bf16 a[40:43], v[60:63], v[172:175], a[40:43]
    s_cselect_b32 s10, 524288, 0
    ds_read_b128 v[152:155], v216 offset:8192
    v_add_f32 v238, v27, v238
    v_mfma_f32_16x16x32_bf16 a[40:43], v[56:59], v[168:171], a[40:43]
    v_exp_f32 v34, v34
    v_mfma_f32_16x16x32_bf16 a[72:75], v[64:67], v[168:171], a[72:75]
    ds_read_b128 v[156:159], v217 offset:8192
    v_cvt_pk_bf16_f32 v121, v26, v27
    v_mfma_f32_16x16x32_bf16 a[72:75], v[68:71], v[172:175], a[72:75]
    v_exp_f32 v35, v35
    v_mfma_f32_16x16x32_bf16 a[104:107], v[76:79], v[172:175], a[104:107]
    ds_read_b128 v[160:163], v218 offset:8192
    v_cvt_pk_bf16_f32 v90, v28, v29
    v_mfma_f32_16x16x32_bf16 a[104:107], v[72:75], v[168:171], a[104:107]
    v_exp_f32 v36, v36
    v_mfma_f32_16x16x32_bf16 a[168:171], v[80:83], v[168:171], a[168:171]
    s_waitcnt lgkmcnt(3)
    ds_read_b128 v[164:167], v219 offset:8192
    v_cvt_pk_bf16_f32 v91, v30, v31
    v_mfma_f32_16x16x32_bf16 a[172:175], v[80:83], v[176:179], a[172:175]
    v_exp_f32 v37, v37
    v_mfma_f32_16x16x32_bf16 a[108:111], v[72:75], v[176:179], a[108:111]
    s_mov_b32 m0, s29
    v_exp_f32 v38, v38
    v_mfma_f32_16x16x32_bf16 a[108:111], v[76:79], v[180:183], a[108:111]
    buffer_load_dwordx4 v232, s[12:15], s27 offen offset:0 nt lds
    v_mfma_f32_16x16x32_bf16 a[76:79], v[68:71], v[180:183], a[76:79]
    v_exp_f32 v39, v39
    v_mfma_f32_16x16x32_bf16 a[76:79], v[64:67], v[176:179], a[76:79]
    v_cvt_pk_bf16_f32 v98, v32, v33
    v_cvt_pk_bf16_f32 v99, v34, v35
    v_mfma_f32_16x16x32_bf16 a[44:47], v[56:59], v[176:179], a[44:47]
    v_exp_f32 v40, v40
    v_mfma_f32_16x16x32_bf16 a[44:47], v[60:63], v[180:183], a[44:47]
    v_add_f32 v236, v36, v236
    v_add_f32 v236, v37, v236
    v_mfma_f32_16x16x32_bf16 a[12:15], v[52:55], v[180:183], a[12:15]
    v_exp_f32 v41, v41
    v_mfma_f32_16x16x32_bf16 a[12:15], v[48:51], v[176:179], a[12:15]
    s_waitcnt lgkmcnt(2)
    v_cvt_pk_bf16_f32 v106, v36, v37
    v_add_f32 v236, v38, v236
    v_mfma_f32_16x16x32_bf16 v[8:11], v[152:155], a[192:195], v[128:131]
    v_exp_f32 v42, v42
    v_mfma_f32_16x16x32_bf16 v[8:11], v[156:159], a[196:199], v[8:11]
    s_waitcnt lgkmcnt(0)
    v_add_f32 v236, v39, v236
    v_cvt_pk_bf16_f32 v107, v38, v39
    v_mfma_f32_16x16x32_bf16 v[8:11], v[160:163], a[200:203], v[8:11]
    v_exp_f32 v43, v43
    v_mfma_f32_16x16x32_bf16 v[8:11], v[164:167], a[204:207], v[8:11]
    v_add_f32 v237, v40, v237
    v_add_f32 v237, v41, v237
    v_mfma_f32_16x16x32_bf16 v[12:15], v[164:167], a[220:223], v[132:135]
    ds_read_b128 v[168:171], v216 offset:12288
    v_cvt_pk_bf16_f32 v114, v40, v41
    v_mfma_f32_16x16x32_bf16 v[12:15], v[160:163], a[216:219], v[12:15]
    v_exp_f32 v44, v44
    v_mfma_f32_16x16x32_bf16 v[12:15], v[156:159], a[212:215], v[12:15]
    ds_read_b128 v[172:175], v217 offset:12288
    v_add_f32 v237, v42, v237
    v_mfma_f32_16x16x32_bf16 v[12:15], v[152:155], a[208:211], v[12:15]
    v_exp_f32 v45, v45
    v_mfma_f32_16x16x32_bf16 v[16:19], v[152:155], a[224:227], v[136:139]
    ds_read_b128 v[176:179], v218 offset:12288
    v_add_f32 v237, v43, v237
    v_mfma_f32_16x16x32_bf16 v[16:19], v[156:159], a[228:231], v[16:19]
    buffer_load_dwordx4 v233, s[12:15], s27 offen offset:1024 nt lds
    v_mfma_f32_16x16x32_bf16 v[16:19], v[160:163], a[232:235], v[16:19]
    ds_read_b128 v[180:183], v219 offset:12288
    v_cvt_pk_bf16_f32 v115, v42, v43
    v_mfma_f32_16x16x32_bf16 v[16:19], v[164:167], a[236:239], v[16:19]
    v_exp_f32 v46, v46
    v_mfma_f32_16x16x32_bf16 v[20:23], v[164:167], a[252:255], v[140:143]
    v_exp_f32 v47, v47
    v_mfma_f32_16x16x32_bf16 v[20:23], v[160:163], a[248:251], v[20:23]
    v_exp_f32 v8, v8
    v_mfma_f32_16x16x32_bf16 v[20:23], v[156:159], a[244:247], v[20:23]
    v_add_f32 v238, v44, v238
    v_add_f32 v238, v45, v238
    v_mfma_f32_16x16x32_bf16 v[20:23], v[152:155], a[240:243], v[20:23]
    v_exp_f32 v9, v9
    v_mfma_f32_16x16x32_bf16 v[24:27], v[152:155], v[184:187], v[144:147]
    v_cvt_pk_bf16_f32 v122, v44, v45
    v_add_f32 v238, v46, v238
    v_mfma_f32_16x16x32_bf16 v[24:27], v[156:159], v[188:191], v[24:27]
    v_exp_f32 v10, v10
    v_mfma_f32_16x16x32_bf16 v[24:27], v[160:163], v[192:195], v[24:27]
    v_add_f32 v238, v47, v238
    v_cvt_pk_bf16_f32 v123, v46, v47
    v_mfma_f32_16x16x32_bf16 v[24:27], v[164:167], v[196:199], v[24:27]
    s_waitcnt lgkmcnt(2)
    v_exp_f32 v11, v11
    v_mfma_f32_16x16x32_bf16 v[28:31], v[168:171], a[192:195], v[128:131]
    v_cvt_pk_bf16_f32 v92, v8, v9
    v_cvt_pk_bf16_f32 v93, v10, v11
    v_mfma_f32_16x16x32_bf16 v[28:31], v[172:175], a[196:199], v[28:31]
    s_waitcnt lgkmcnt(0)
    v_exp_f32 v12, v12
    v_mfma_f32_16x16x32_bf16 v[28:31], v[176:179], a[200:203], v[28:31]
    v_mfma_f32_16x16x32_bf16 v[28:31], v[180:183], a[204:207], v[28:31]
    v_exp_f32 v13, v13
    v_mfma_f32_16x16x32_bf16 v[32:35], v[180:183], a[220:223], v[132:135]
    ds_read_b64_tr_b16 v[152:153], v224 offset:16384
    v_cvt_pk_bf16_f32 v100, v12, v13
    v_mfma_f32_16x16x32_bf16 v[32:35], v[176:179], a[216:219], v[32:35]
    buffer_load_dwordx4 v232, s[12:15], s27 offen offset:2048 nt lds
    v_mfma_f32_16x16x32_bf16 v[32:35], v[172:175], a[212:215], v[32:35]
    ds_read_b64_tr_b16 v[154:155], v224 offset:20480
    v_mfma_f32_16x16x32_bf16 v[32:35], v[168:171], a[208:211], v[32:35]
    v_exp_f32 v14, v14
    v_mfma_f32_16x16x32_bf16 v[36:39], v[168:171], a[224:227], v[136:139]
    ds_read_b64_tr_b16 v[156:157], v224 offset:24576
    v_mfma_f32_16x16x32_bf16 v[36:39], v[172:175], a[228:231], v[36:39]
    v_exp_f32 v15, v15
    v_mfma_f32_16x16x32_bf16 v[36:39], v[176:179], a[232:235], v[36:39]
    ds_read_b64_tr_b16 v[158:159], v224 offset:28672
    v_cvt_pk_bf16_f32 v101, v14, v15
    v_mfma_f32_16x16x32_bf16 v[36:39], v[180:183], a[236:239], v[36:39]
    v_exp_f32 v16, v16
    v_mfma_f32_16x16x32_bf16 v[40:43], v[180:183], a[252:255], v[140:143]
    v_exp_f32 v17, v17
    v_mfma_f32_16x16x32_bf16 v[40:43], v[176:179], a[248:251], v[40:43]
    ds_read_b64_tr_b16 v[160:161], v225 offset:16384
    v_add_f32 v236, v16, v236
    v_mfma_f32_16x16x32_bf16 v[40:43], v[172:175], a[244:247], v[40:43]
    v_exp_f32 v18, v18
    v_mfma_f32_16x16x32_bf16 v[40:43], v[168:171], a[240:243], v[40:43]
    ds_read_b64_tr_b16 v[162:163], v225 offset:20480
    v_add_f32 v236, v17, v236
    v_mfma_f32_16x16x32_bf16 v[44:47], v[168:171], v[184:187], v[144:147]
    v_exp_f32 v19, v19
    v_mfma_f32_16x16x32_bf16 v[44:47], v[172:175], v[188:191], v[44:47]
    ds_read_b64_tr_b16 v[164:165], v225 offset:24576
    v_cvt_pk_bf16_f32 v108, v16, v17
    v_mfma_f32_16x16x32_bf16 v[44:47], v[176:179], v[192:195], v[44:47]
    v_exp_f32 v20, v20
    v_mfma_f32_16x16x32_bf16 v[44:47], v[180:183], v[196:199], v[44:47]
    s_waitcnt lgkmcnt(3)
    ds_read_b64_tr_b16 v[166:167], v225 offset:28672
    v_add_f32 v236, v18, v236
    v_mfma_f32_16x16x32_bf16 a[16:19], v[48:51], v[152:155], a[16:19]
    ds_read_b64_tr_b16 v[168:169], v226 offset:16384
    v_add_f32 v236, v19, v236
    v_mfma_f32_16x16x32_bf16 a[16:19], v[52:55], v[156:159], a[16:19]
    ds_read_b64_tr_b16 v[170:171], v226 offset:20480
    v_cvt_pk_bf16_f32 v109, v18, v19
    v_mfma_f32_16x16x32_bf16 a[48:51], v[60:63], v[156:159], a[48:51]
    ds_read_b64_tr_b16 v[172:173], v226 offset:24576
    v_add_f32 v237, v20, v237
    v_mfma_f32_16x16x32_bf16 a[48:51], v[56:59], v[152:155], a[48:51]
    buffer_load_dwordx4 v233, s[12:15], s27 offen offset:3072 nt lds
    v_mfma_f32_16x16x32_bf16 a[80:83], v[64:67], v[152:155], a[80:83]
    s_add_u32 s29, s29, 32768
    ds_read_b64_tr_b16 v[174:175], v226 offset:28672
    v_mfma_f32_16x16x32_bf16 a[80:83], v[68:71], v[156:159], a[80:83]
    s_and_b32 s29, s29, 131071
    v_exp_f32 v21, v21
    v_mfma_f32_16x16x32_bf16 a[112:115], v[76:79], v[156:159], a[112:115]
    s_add_u32 s27, s27, 16384
    ds_read_b64_tr_b16 v[176:177], v227 offset:16384
    v_add_f32 v237, v21, v237
    v_mfma_f32_16x16x32_bf16 a[112:115], v[72:75], v[152:155], a[112:115]
    s_cmp_lt_u32 s27, 524288
    v_exp_f32 v22, v22
    v_mfma_f32_16x16x32_bf16 a[176:179], v[80:83], v[152:155], a[176:179]
    s_waitcnt lgkmcnt(5)
    ds_read_b64_tr_b16 v[178:179], v227 offset:20480
    v_cvt_pk_bf16_f32 v116, v20, v21
    v_mfma_f32_16x16x32_bf16 a[180:183], v[80:83], v[160:163], a[180:183]
    s_cselect_b32 s14, 524288, 0
    v_exp_f32 v23, v23
    v_mfma_f32_16x16x32_bf16 a[116:119], v[72:75], v[160:163], a[116:119]
    ds_read_b64_tr_b16 v[180:181], v227 offset:24576
    v_add_f32 v237, v22, v237
    v_mfma_f32_16x16x32_bf16 a[116:119], v[76:79], v[164:167], a[116:119]
    v_exp_f32 v24, v24
    v_mfma_f32_16x16x32_bf16 a[84:87], v[68:71], v[164:167], a[84:87]
    ds_read_b64_tr_b16 v[182:183], v227 offset:28672
    v_add_f32 v237, v23, v237
    v_mfma_f32_16x16x32_bf16 a[84:87], v[64:67], v[160:163], a[84:87]
    v_exp_f32 v25, v25
    v_mfma_f32_16x16x32_bf16 a[52:55], v[56:59], v[160:163], a[52:55]
    v_exp_f32 v26, v26
    v_mfma_f32_16x16x32_bf16 a[52:55], v[60:63], v[164:167], a[52:55]
    v_exp_f32 v27, v27
    v_mfma_f32_16x16x32_bf16 a[20:23], v[52:55], v[164:167], a[20:23]
    v_exp_f32 v28, v28
    v_mfma_f32_16x16x32_bf16 a[20:23], v[48:51], v[160:163], a[20:23]
    v_exp_f32 v29, v29
    v_mfma_f32_16x16x32_bf16 v[248:251], v[240:243], v[56:59], v[248:251]
    v_exp_f32 v30, v30
    v_mfma_f32_16x16x32_bf16 v[248:251], v[240:243], v[60:63], v[248:251]
    s_waitcnt vmcnt(8) lgkmcnt(0)
    v_cvt_pk_bf16_f32 v117, v22, v23
    v_add_f32 v238, v24, v238
    v_mfma_f32_16x16x32_bf16 a[24:27], v[48:51], v[168:171], a[24:27]
    s_barrier
    v_mfma_f32_16x16x32_bf16 a[24:27], v[52:55], v[172:175], a[24:27]
    v_exp_f32 v31, v31
    v_mfma_f32_16x16x32_bf16 a[56:59], v[60:63], v[172:175], a[56:59]
    ds_read_b128 v[152:155], v216 offset:32768
    v_add_f32 v238, v25, v238
    v_mfma_f32_16x16x32_bf16 a[56:59], v[56:59], v[168:171], a[56:59]
    v_exp_f32 v32, v32
    v_mfma_f32_16x16x32_bf16 a[88:91], v[64:67], v[168:171], a[88:91]
    ds_read_b128 v[156:159], v217 offset:32768
    v_cvt_pk_bf16_f32 v124, v24, v25
    v_mfma_f32_16x16x32_bf16 a[88:91], v[68:71], v[172:175], a[88:91]
    v_exp_f32 v33, v33
    v_mfma_f32_16x16x32_bf16 a[120:123], v[76:79], v[172:175], a[120:123]
    ds_read_b128 v[160:163], v218 offset:32768
    v_add_f32 v238, v26, v238
    v_mfma_f32_16x16x32_bf16 a[120:123], v[72:75], v[168:171], a[120:123]
    v_exp_f32 v34, v34
    v_mfma_f32_16x16x32_bf16 a[184:187], v[80:83], v[168:171], a[184:187]
    ds_read_b128 v[164:167], v219 offset:32768
    v_add_f32 v238, v27, v238
    v_mfma_f32_16x16x32_bf16 a[188:191], v[80:83], v[176:179], a[188:191]
    v_exp_f32 v35, v35
    v_mfma_f32_16x16x32_bf16 a[124:127], v[72:75], v[176:179], a[124:127]
    v_exp_f32 v36, v36
    v_mfma_f32_16x16x32_bf16 a[124:127], v[76:79], v[180:183], a[124:127]
    v_cvt_pk_bf16_f32 v125, v26, v27
    v_cvt_pk_bf16_f32 v94, v28, v29
    v_mfma_f32_16x16x32_bf16 a[92:95], v[68:71], v[180:183], a[92:95]
    v_exp_f32 v37, v37
    v_mfma_f32_16x16x32_bf16 a[92:95], v[64:67], v[176:179], a[92:95]
    v_cvt_pk_bf16_f32 v95, v30, v31
    v_cvt_pk_bf16_f32 v102, v32, v33
    v_mfma_f32_16x16x32_bf16 a[60:63], v[56:59], v[176:179], a[60:63]
    v_exp_f32 v38, v38
    v_mfma_f32_16x16x32_bf16 a[60:63], v[60:63], v[180:183], a[60:63]
    v_cvt_pk_bf16_f32 v103, v34, v35
    v_add_f32 v236, v36, v236
    v_mfma_f32_16x16x32_bf16 a[28:31], v[52:55], v[180:183], a[28:31]
    s_sub_u32 s25, s25, 1
    v_exp_f32 v39, v39
    v_mfma_f32_16x16x32_bf16 a[28:31], v[48:51], v[176:179], a[28:31]
    s_waitcnt lgkmcnt(2)
    v_add_f32 v236, v37, v236
    s_cbranch_scc1 L_tail2
    v_mfma_f32_16x16x32_bf16 v[8:11], v[152:155], a[192:195], v[128:131]
    v_exp_f32 v40, v40
    v_mfma_f32_16x16x32_bf16 v[8:11], v[156:159], a[196:199], v[8:11]
    s_waitcnt lgkmcnt(0)
    v_cvt_pk_bf16_f32 v110, v36, v37
    v_add_f32 v236, v38, v236
    v_mfma_f32_16x16x32_bf16 v[8:11], v[160:163], a[200:203], v[8:11]
    v_exp_f32 v41, v41
    v_mfma_f32_16x16x32_bf16 v[8:11], v[164:167], a[204:207], v[8:11]
    v_add_f32 v236, v39, v236
    v_cvt_pk_bf16_f32 v111, v38, v39
    v_mfma_f32_16x16x32_bf16 v[12:15], v[164:167], a[220:223], v[132:135]
    ds_read_b128 v[168:171], v216 offset:36864
    v_add_f32 v237, v40, v237
    v_mfma_f32_16x16x32_bf16 v[12:15], v[160:163], a[216:219], v[12:15]
    v_exp_f32 v42, v42
    v_mfma_f32_16x16x32_bf16 v[12:15], v[156:159], a[212:215], v[12:15]
    ds_read_b128 v[172:175], v217 offset:36864
    v_add_f32 v237, v41, v237
    v_mfma_f32_16x16x32_bf16 v[12:15], v[152:155], a[208:211], v[12:15]
    v_exp_f32 v43, v43
    v_mfma_f32_16x16x32_bf16 v[16:19], v[152:155], a[224:227], v[136:139]
    s_mov_b32 m0, s28
    ds_read_b128 v[176:179], v218 offset:36864
    v_cvt_pk_bf16_f32 v118, v40, v41
    v_mfma_f32_16x16x32_bf16 v[16:19], v[156:159], a[228:231], v[16:19]
    buffer_load_dwordx4 v228, s[8:11], s26 offen offset:0 nt lds
    v_mfma_f32_16x16x32_bf16 v[16:19], v[160:163], a[232:235], v[16:19]
    ds_read_b128 v[180:183], v219 offset:36864
    v_add_f32 v237, v42, v237
    v_mfma_f32_16x16x32_bf16 v[16:19], v[164:167], a[236:239], v[16:19]
    v_exp_f32 v44, v44
    v_mfma_f32_16x16x32_bf16 v[20:23], v[164:167], a[252:255], v[140:143]
    v_exp_f32 v45, v45
    v_mfma_f32_16x16x32_bf16 v[20:23], v[160:163], a[248:251], v[20:23]
    v_exp_f32 v46, v46
    v_mfma_f32_16x16x32_bf16 v[20:23], v[156:159], a[244:247], v[20:23]
    v_add_f32 v237, v43, v237
    v_cvt_pk_bf16_f32 v119, v42, v43
    v_mfma_f32_16x16x32_bf16 v[20:23], v[152:155], a[240:243], v[20:23]
    v_exp_f32 v47, v47
    v_mfma_f32_16x16x32_bf16 v[24:27], v[152:155], v[200:203], v[148:151]
    v_add_f32 v238, v44, v238
    v_add_f32 v238, v45, v238
    v_mfma_f32_16x16x32_bf16 v[24:27], v[156:159], v[204:207], v[24:27]
    v_exp_f32 v8, v8
    v_mfma_f32_16x16x32_bf16 v[24:27], v[160:163], v[208:211], v[24:27]
    v_cvt_pk_bf16_f32 v126, v44, v45
    v_add_f32 v238, v46, v238
    v_mfma_f32_16x16x32_bf16 v[24:27], v[164:167], v[212:215], v[24:27]
    s_waitcnt lgkmcnt(2)
    v_exp_f32 v9, v9
    v_mfma_f32_16x16x32_bf16 v[28:31], v[168:171], a[192:195], v[128:131]
    v_add_f32 v238, v47, v238
    v_cvt_pk_bf16_f32 v127, v46, v47
    v_mfma_f32_16x16x32_bf16 v[28:31], v[172:175], a[196:199], v[28:31]
    s_waitcnt lgkmcnt(0)
    v_exp_f32 v10, v10
    v_mfma_f32_16x16x32_bf16 v[28:31], v[176:179], a[200:203], v[28:31]
    v_cvt_pk_bf16_f32 v48, v8, v9
    v_mfma_f32_16x16x32_bf16 v[28:31], v[180:183], a[204:207], v[28:31]
    v_exp_f32 v11, v11
    v_mfma_f32_16x16x32_bf16 v[32:35], v[180:183], a[220:223], v[132:135]
    ds_read_b64_tr_b16 v[152:153], v220 offset:49152
    v_cvt_pk_bf16_f32 v49, v10, v11
    v_mfma_f32_16x16x32_bf16 v[32:35], v[176:179], a[216:219], v[32:35]
    buffer_load_dwordx4 v229, s[8:11], s26 offen offset:1024 nt lds
    v_mfma_f32_16x16x32_bf16 v[32:35], v[172:175], a[212:215], v[32:35]
    ds_read_b64_tr_b16 v[154:155], v220 offset:53248
    v_mfma_f32_16x16x32_bf16 v[32:35], v[168:171], a[208:211], v[32:35]
    v_exp_f32 v12, v12
    v_mfma_f32_16x16x32_bf16 v[36:39], v[168:171], a[224:227], v[136:139]
    ds_read_b64_tr_b16 v[156:157], v220 offset:57344
    v_mfma_f32_16x16x32_bf16 v[36:39], v[172:175], a[228:231], v[36:39]
    v_exp_f32 v13, v13
    v_mfma_f32_16x16x32_bf16 v[36:39], v[176:179], a[232:235], v[36:39]
    ds_read_b64_tr_b16 v[158:159], v220 offset:61440
    v_cvt_pk_bf16_f32 v56, v12, v13
    v_mfma_f32_16x16x32_bf16 v[36:39], v[180:183], a[236:239], v[36:39]
    v_exp_f32 v14, v14
    v_mfma_f32_16x16x32_bf16 v[40:43], v[180:183], a[252:255], v[140:143]
    v_exp_f32 v15, v15
    v_mfma_f32_16x16x32_bf16 v[40:43], v[176:179], a[248:251], v[40:43]
    v_exp_f32 v16, v16
    v_mfma_f32_16x16x32_bf16 v[40:43], v[172:175], a[244:247], v[40:43]
    v_cvt_pk_bf16_f32 v57, v14, v15
    v_add_f32 v236, v16, v236
    v_mfma_f32_16x16x32_bf16 v[40:43], v[168:171], a[240:243], v[40:43]
    ds_read_b64_tr_b16 v[160:161], v221 offset:49152
    v_xor_b32 v220, 0x10000, v220
    v_mfma_f32_16x16x32_bf16 v[44:47], v[168:171], v[200:203], v[148:151]
    v_exp_f32 v17, v17
    v_mfma_f32_16x16x32_bf16 v[44:47], v[172:175], v[204:207], v[44:47]
    ds_read_b64_tr_b16 v[162:163], v221 offset:53248
    v_add_f32 v236, v17, v236
    v_mfma_f32_16x16x32_bf16 v[44:47], v[176:179], v[208:211], v[44:47]
    v_exp_f32 v18, v18
    v_mfma_f32_16x16x32_bf16 v[44:47], v[180:183], v[212:215], v[44:47]
    s_waitcnt lgkmcnt(2)
    ds_read_b64_tr_b16 v[164:165], v221 offset:57344
    v_cvt_pk_bf16_f32 v64, v16, v17
    v_mfma_f32_16x16x32_bf16 a[0:3], v[88:91], v[152:155], a[0:3]
    buffer_load_dwordx4 v230, s[8:11], s26 offen offset:2048 nt lds
    v_mfma_f32_16x16x32_bf16 a[0:3], v[92:95], v[156:159], a[0:3]
    ds_read_b64_tr_b16 v[166:167], v221 offset:61440
    v_add_f32 v236, v18, v236
    v_mfma_f32_16x16x32_bf16 a[32:35], v[100:103], v[156:159], a[32:35]
    v_exp_f32 v19, v19
    v_xor_b32 v221, 0x10000, v221
    v_mfma_f32_16x16x32_bf16 a[32:35], v[96:99], v[152:155], a[32:35]
    v_exp_f32 v20, v20
    v_mfma_f32_16x16x32_bf16 a[64:67], v[104:107], v[152:155], a[64:67]
    v_exp_f32 v21, v21
    v_mfma_f32_16x16x32_bf16 a[64:67], v[108:111], v[156:159], a[64:67]
    v_exp_f32 v22, v22
    v_mfma_f32_16x16x32_bf16 a[96:99], v[116:119], v[156:159], a[96:99]
    ds_read_b64_tr_b16 v[168:169], v222 offset:49152
    v_add_f32 v236, v19, v236
    v_mfma_f32_16x16x32_bf16 a[96:99], v[112:115], v[152:155], a[96:99]
    v_cvt_pk_bf16_f32 v65, v18, v19
    v_add_f32 v237, v20, v237
    v_mfma_f32_16x16x32_bf16 a[128:131], v[120:123], v[152:155], a[128:131]
    ds_read_b64_tr_b16 v[170:171], v222 offset:53248
    v_add_f32 v237, v21, v237
    v_mfma_f32_16x16x32_bf16 a[128:131], v[124:127], v[156:159], a[128:131]
    s_waitcnt lgkmcnt(2)
    v_exp_f32 v23, v23
    v_mfma_f32_16x16x32_bf16 a[132:135], v[124:127], v[164:167], a[132:135]
    ds_read_b64_tr_b16 v[172:173], v222 offset:57344
    v_cvt_pk_bf16_f32 v72, v20, v21
    v_mfma_f32_16x16x32_bf16 a[132:135], v[120:123], v[160:163], a[132:135]
    v_exp_f32 v24, v24
    v_mfma_f32_16x16x32_bf16 a[100:103], v[112:115], v[160:163], a[100:103]
    ds_read_b64_tr_b16 v[174:175], v222 offset:61440
    v_add_f32 v237, v22, v237
    v_mfma_f32_16x16x32_bf16 a[100:103], v[116:119], v[164:167], a[100:103]
    v_exp_f32 v25, v25
    v_xor_b32 v222, 0x10000, v222
    v_mfma_f32_16x16x32_bf16 a[68:71], v[108:111], v[164:167], a[68:71]
    v_exp_f32 v26, v26
    v_mfma_f32_16x16x32_bf16 a[68:71], v[104:107], v[160:163], a[68:71]
    buffer_load_dwordx4 v231, s[8:11], s26 offen offset:3072 nt lds
    v_mfma_f32_16x16x32_bf16 a[36:39], v[96:99], v[160:163], a[36:39]
    s_add_u32 s28, s28, 32768
    v_exp_f32 v27, v27
    v_mfma_f32_16x16x32_bf16 a[36:39], v[100:103], v[164:167], a[36:39]
    s_and_b32 s28, s28, 131071
    ds_read_b64_tr_b16 v[176:177], v223 offset:49152
    v_add_f32 v237, v23, v237
    v_mfma_f32_16x16x32_bf16 a[4:7], v[92:95], v[164:167], a[4:7]
    s_add_u32 s26, s26, 16384
    v_exp_f32 v28, v28
    v_mfma_f32_16x16x32_bf16 a[4:7], v[88:91], v[160:163], a[4:7]
    s_cmp_lt_u32 s26, 524288
    ds_read_b64_tr_b16 v[178:179], v223 offset:53248
    v_cvt_pk_bf16_f32 v73, v22, v23
    v_mfma_f32_16x16x32_bf16 v[244:247], v[240:243], v[88:91], v[244:247]
    s_cselect_b32 s10, 524288, 0
    v_exp_f32 v29, v29
    v_mfma_f32_16x16x32_bf16 v[244:247], v[240:243], v[92:95], v[244:247]
    s_waitcnt lgkmcnt(2)
    ds_read_b64_tr_b16 v[180:181], v223 offset:57344
    v_add_f32 v239, v24, v239
    v_mfma_f32_16x16x32_bf16 a[8:11], v[88:91], v[168:171], a[8:11]
    v_exp_f32 v30, v30
    v_mfma_f32_16x16x32_bf16 a[8:11], v[92:95], v[172:175], a[8:11]
    ds_read_b64_tr_b16 v[182:183], v223 offset:61440
    v_add_f32 v239, v25, v239
    v_mfma_f32_16x16x32_bf16 a[40:43], v[100:103], v[172:175], a[40:43]
    v_exp_f32 v31, v31
    v_xor_b32 v223, 0x10000, v223
    v_mfma_f32_16x16x32_bf16 a[40:43], v[96:99], v[168:171], a[40:43]
    v_cvt_pk_bf16_f32 v80, v24, v25
    v_add_f32 v239, v26, v239
    v_mfma_f32_16x16x32_bf16 a[72:75], v[104:107], v[168:171], a[72:75]
    ds_read_b128 v[152:155], v216 offset:40960
    v_add_f32 v239, v27, v239
    v_mfma_f32_16x16x32_bf16 a[72:75], v[108:111], v[172:175], a[72:75]
    v_exp_f32 v32, v32
    v_mfma_f32_16x16x32_bf16 a[104:107], v[116:119], v[172:175], a[104:107]
    ds_read_b128 v[156:159], v217 offset:40960
    v_cvt_pk_bf16_f32 v81, v26, v27
    v_mfma_f32_16x16x32_bf16 a[104:107], v[112:115], v[168:171], a[104:107]
    v_exp_f32 v33, v33
    v_mfma_f32_16x16x32_bf16 a[136:139], v[120:123], v[168:171], a[136:139]
    s_mov_b32 m0, s29
    ds_read_b128 v[160:163], v218 offset:40960
    v_cvt_pk_bf16_f32 v50, v28, v29
    v_mfma_f32_16x16x32_bf16 a[136:139], v[124:127], v[172:175], a[136:139]
    s_waitcnt lgkmcnt(3)
    buffer_load_dwordx4 v232, s[12:15], s27 offen offset:0 nt lds
    v_mfma_f32_16x16x32_bf16 a[140:143], v[124:127], v[180:183], a[140:143]
    ds_read_b128 v[164:167], v219 offset:40960
    v_cvt_pk_bf16_f32 v51, v30, v31
    v_mfma_f32_16x16x32_bf16 a[140:143], v[120:123], v[176:179], a[140:143]
    v_exp_f32 v34, v34
    v_mfma_f32_16x16x32_bf16 a[108:111], v[112:115], v[176:179], a[108:111]
    v_exp_f32 v35, v35
    v_mfma_f32_16x16x32_bf16 a[108:111], v[116:119], v[180:183], a[108:111]
    v_exp_f32 v36, v36
    v_mfma_f32_16x16x32_bf16 a[76:79], v[108:111], v[180:183], a[76:79]
    v_exp_f32 v37, v37
    v_mfma_f32_16x16x32_bf16 a[76:79], v[104:107], v[176:179], a[76:79]
    v_cvt_pk_bf16_f32 v58, v32, v33
    v_cvt_pk_bf16_f32 v59, v34, v35
    v_mfma_f32_16x16x32_bf16 a[44:47], v[96:99], v[176:179], a[44:47]
    v_exp_f32 v38, v38
    v_mfma_f32_16x16x32_bf16 a[44:47], v[100:103], v[180:183], a[44:47]
    v_add_f32 v236, v36, v236
    v_add_f32 v236, v37, v236
    v_mfma_f32_16x16x32_bf16 a[12:15], v[92:95], v[180:183], a[12:15]
    v_exp_f32 v39, v39
    v_mfma_f32_16x16x32_bf16 a[12:15], v[88:91], v[176:179], a[12:15]
    s_waitcnt lgkmcnt(2)
    v_cvt_pk_bf16_f32 v66, v36, v37
    v_add_f32 v236, v38, v236
    v_mfma_f32_16x16x32_bf16 v[8:11], v[152:155], a[192:195], v[128:131]
    ds_read_b128 v[168:171], v216 offset:45056
    v_add_f32 v236, v39, v236
    v_mfma_f32_16x16x32_bf16 v[8:11], v[156:159], a[196:199], v[8:11]
    s_waitcnt lgkmcnt(1)
    v_exp_f32 v40, v40
    v_mfma_f32_16x16x32_bf16 v[8:11], v[160:163], a[200:203], v[8:11]
    ds_read_b128 v[172:175], v217 offset:45056
    v_cvt_pk_bf16_f32 v67, v38, v39
    v_mfma_f32_16x16x32_bf16 v[8:11], v[164:167], a[204:207], v[8:11]
    v_exp_f32 v41, v41
    v_mfma_f32_16x16x32_bf16 v[12:15], v[164:167], a[220:223], v[132:135]
    ds_read_b128 v[176:179], v218 offset:45056
    v_add_f32 v237, v40, v237
    v_mfma_f32_16x16x32_bf16 v[12:15], v[160:163], a[216:219], v[12:15]
    buffer_load_dwordx4 v233, s[12:15], s27 offen offset:1024 nt lds
    v_mfma_f32_16x16x32_bf16 v[12:15], v[156:159], a[212:215], v[12:15]
    ds_read_b128 v[180:183], v219 offset:45056
    v_add_f32 v237, v41, v237
    v_mfma_f32_16x16x32_bf16 v[12:15], v[152:155], a[208:211], v[12:15]
    v_exp_f32 v42, v42
    v_mfma_f32_16x16x32_bf16 v[16:19], v[152:155], a[224:227], v[136:139]
    v_exp_f32 v43, v43
    v_mfma_f32_16x16x32_bf16 v[16:19], v[156:159], a[228:231], v[16:19]
    v_exp_f32 v44, v44
    v_mfma_f32_16x16x32_bf16 v[16:19], v[160:163], a[232:235], v[16:19]
    v_cvt_pk_bf16_f32 v74, v40, v41
    v_add_f32 v237, v42, v237
    v_mfma_f32_16x16x32_bf16 v[16:19], v[164:167], a[236:239], v[16:19]
    v_exp_f32 v45, v45
    v_mfma_f32_16x16x32_bf16 v[20:23], v[164:167], a[252:255], v[140:143]
    v_add_f32 v237, v43, v237
    v_cvt_pk_bf16_f32 v75, v42, v43
    v_mfma_f32_16x16x32_bf16 v[20:23], v[160:163], a[248:251], v[20:23]
    v_exp_f32 v46, v46
    v_mfma_f32_16x16x32_bf16 v[20:23], v[156:159], a[244:247], v[20:23]
    v_add_f32 v239, v44, v239
    v_add_f32 v239, v45, v239
    v_mfma_f32_16x16x32_bf16 v[20:23], v[152:155], a[240:243], v[20:23]
    s_waitcnt lgkmcnt(2)
    v_exp_f32 v47, v47
    v_mfma_f32_16x16x32_bf16 v[28:31], v[168:171], a[192:195], v[128:131]
    ds_read_b64_tr_b16 v[152:153], v224 offset:49152
    v_cvt_pk_bf16_f32 v82, v44, v45
    v_mfma_f32_16x16x32_bf16 v[28:31], v[172:175], a[196:199], v[28:31]
    s_waitcnt lgkmcnt(1)
    v_exp_f32 v8, v8
    v_mfma_f32_16x16x32_bf16 v[28:31], v[176:179], a[200:203], v[28:31]
    ds_read_b64_tr_b16 v[154:155], v224 offset:53248
    v_add_f32 v239, v46, v239
    v_mfma_f32_16x16x32_bf16 v[28:31], v[180:183], a[204:207], v[28:31]
    v_exp_f32 v9, v9
    v_mfma_f32_16x16x32_bf16 v[32:35], v[180:183], a[220:223], v[132:135]
    ds_read_b64_tr_b16 v[156:157], v224 offset:57344
    v_add_f32 v239, v47, v239
    v_mfma_f32_16x16x32_bf16 v[32:35], v[176:179], a[216:219], v[32:35]
    buffer_load_dwordx4 v232, s[12:15], s27 offen offset:2048 nt lds
    v_mfma_f32_16x16x32_bf16 v[32:35], v[172:175], a[212:215], v[32:35]
    ds_read_b64_tr_b16 v[158:159], v224 offset:61440
    v_cvt_pk_bf16_f32 v83, v46, v47
    v_mfma_f32_16x16x32_bf16 v[32:35], v[168:171], a[208:211], v[32:35]
    v_exp_f32 v10, v10
    v_xor_b32 v224, 0x10000, v224
    v_mfma_f32_16x16x32_bf16 v[36:39], v[168:171], a[224:227], v[136:139]
    v_exp_f32 v11, v11
    v_mfma_f32_16x16x32_bf16 v[36:39], v[172:175], a[228:231], v[36:39]
    v_exp_f32 v12, v12
    v_mfma_f32_16x16x32_bf16 v[36:39], v[176:179], a[232:235], v[36:39]
    v_cvt_pk_bf16_f32 v52, v8, v9
    v_cvt_pk_bf16_f32 v53, v10, v11
    v_mfma_f32_16x16x32_bf16 v[36:39], v[180:183], a[236:239], v[36:39]
    ds_read_b64_tr_b16 v[160:161], v225 offset:49152
    v_xor_b32 v216, 0x10000, v216
    v_mfma_f32_16x16x32_bf16 v[40:43], v[180:183], a[252:255], v[140:143]
    v_exp_f32 v13, v13
    v_mfma_f32_16x16x32_bf16 v[40:43], v[176:179], a[248:251], v[40:43]
    ds_read_b64_tr_b16 v[162:163], v225 offset:53248
    v_cvt_pk_bf16_f32 v60, v12, v13
    v_mfma_f32_16x16x32_bf16 v[40:43], v[172:175], a[244:247], v[40:43]
    v_exp_f32 v14, v14
    v_mfma_f32_16x16x32_bf16 v[40:43], v[168:171], a[240:243], v[40:43]
    s_waitcnt lgkmcnt(2)
    ds_read_b64_tr_b16 v[164:165], v225 offset:57344
    v_xor_b32 v217, 0x10000, v217
    v_mfma_f32_16x16x32_bf16 a[16:19], v[88:91], v[152:155], a[16:19]
    v_exp_f32 v15, v15
    v_mfma_f32_16x16x32_bf16 a[16:19], v[92:95], v[156:159], a[16:19]
    ds_read_b64_tr_b16 v[166:167], v225 offset:61440
    v_cvt_pk_bf16_f32 v61, v14, v15
    v_mfma_f32_16x16x32_bf16 a[48:51], v[100:103], v[156:159], a[48:51]
    ds_read_b64_tr_b16 v[168:169], v226 offset:49152
    v_xor_b32 v218, 0x10000, v218
    v_xor_b32 v225, 0x10000, v225
    v_mfma_f32_16x16x32_bf16 a[48:51], v[96:99], v[152:155], a[48:51]
    buffer_load_dwordx4 v233, s[12:15], s27 offen offset:3072 nt lds
    v_mfma_f32_16x16x32_bf16 a[80:83], v[104:107], v[152:155], a[80:83]
    s_add_u32 s29, s29, 32768
    ds_read_b64_tr_b16 v[170:171], v226 offset:53248
    v_xor_b32 v219, 0x10000, v219
    v_mfma_f32_16x16x32_bf16 a[80:83], v[108:111], v[156:159], a[80:83]
    s_and_b32 s29, s29, 131071
    v_exp_f32 v16, v16
    v_mfma_f32_16x16x32_bf16 a[112:115], v[116:119], v[156:159], a[112:115]
    s_add_u32 s27, s27, 16384
    ds_read_b64_tr_b16 v[172:173], v226 offset:57344
    v_add_f32 v236, v16, v236
    v_mfma_f32_16x16x32_bf16 a[112:115], v[112:115], v[152:155], a[112:115]
    s_cmp_lt_u32 s27, 524288
    v_exp_f32 v17, v17
    v_mfma_f32_16x16x32_bf16 a[144:147], v[120:123], v[152:155], a[144:147]
    s_cselect_b32 s14, 524288, 0
    ds_read_b64_tr_b16 v[174:175], v226 offset:61440
    v_add_f32 v236, v17, v236
    v_mfma_f32_16x16x32_bf16 a[144:147], v[124:127], v[156:159], a[144:147]
    s_waitcnt lgkmcnt(4)
    v_exp_f32 v18, v18
    v_xor_b32 v226, 0x10000, v226
    v_mfma_f32_16x16x32_bf16 a[148:151], v[124:127], v[164:167], a[148:151]
    ds_read_b64_tr_b16 v[176:177], v227 offset:49152
    v_cvt_pk_bf16_f32 v68, v16, v17
    v_mfma_f32_16x16x32_bf16 a[148:151], v[120:123], v[160:163], a[148:151]
    v_exp_f32 v19, v19
    v_mfma_f32_16x16x32_bf16 a[116:119], v[112:115], v[160:163], a[116:119]
    ds_read_b64_tr_b16 v[178:179], v227 offset:53248
    v_add_f32 v236, v18, v236
    v_mfma_f32_16x16x32_bf16 a[116:119], v[116:119], v[164:167], a[116:119]
    v_exp_f32 v20, v20
    v_mfma_f32_16x16x32_bf16 a[84:87], v[108:111], v[164:167], a[84:87]
    ds_read_b64_tr_b16 v[180:181], v227 offset:57344
    v_add_f32 v236, v19, v236
    v_mfma_f32_16x16x32_bf16 a[84:87], v[104:107], v[160:163], a[84:87]
    v_exp_f32 v21, v21
    v_mfma_f32_16x16x32_bf16 a[52:55], v[96:99], v[160:163], a[52:55]
    ds_read_b64_tr_b16 v[182:183], v227 offset:61440
    v_cvt_pk_bf16_f32 v69, v18, v19
    v_mfma_f32_16x16x32_bf16 a[52:55], v[100:103], v[164:167], a[52:55]
    v_exp_f32 v22, v22
    v_xor_b32 v227, 0x10000, v227
    v_mfma_f32_16x16x32_bf16 a[20:23], v[92:95], v[164:167], a[20:23]
    v_exp_f32 v23, v23
    v_mfma_f32_16x16x32_bf16 a[20:23], v[88:91], v[160:163], a[20:23]
    v_exp_f32 v28, v28
    v_mfma_f32_16x16x32_bf16 v[248:251], v[240:243], v[96:99], v[248:251]
    v_exp_f32 v29, v29
    v_mfma_f32_16x16x32_bf16 v[248:251], v[240:243], v[100:103], v[248:251]
    s_waitcnt lgkmcnt(4)
    v_add_f32 v237, v20, v237
    v_add_f32 v237, v21, v237
    v_mfma_f32_16x16x32_bf16 a[24:27], v[88:91], v[168:171], a[24:27]
    v_exp_f32 v30, v30
    v_mfma_f32_16x16x32_bf16 a[24:27], v[92:95], v[172:175], a[24:27]
    s_waitcnt vmcnt(8) lgkmcnt(0)
    v_cvt_pk_bf16_f32 v76, v20, v21
    v_add_f32 v237, v22, v237
    v_mfma_f32_16x16x32_bf16 a[56:59], v[100:103], v[172:175], a[56:59]
    s_barrier
    v_mfma_f32_16x16x32_bf16 a[56:59], v[96:99], v[168:171], a[56:59]
    v_exp_f32 v31, v31
    v_mfma_f32_16x16x32_bf16 a[88:91], v[104:107], v[168:171], a[88:91]
    ds_read_b128 v[152:155], v216 offset:0
    v_add_f32 v237, v23, v237
    v_mfma_f32_16x16x32_bf16 a[88:91], v[108:111], v[172:175], a[88:91]
    v_exp_f32 v32, v32
    v_mfma_f32_16x16x32_bf16 a[120:123], v[116:119], v[172:175], a[120:123]
    ds_read_b128 v[156:159], v217 offset:0
    v_cvt_pk_bf16_f32 v77, v22, v23
    v_mfma_f32_16x16x32_bf16 a[120:123], v[112:115], v[168:171], a[120:123]
    v_exp_f32 v33, v33
    v_mfma_f32_16x16x32_bf16 a[152:155], v[120:123], v[168:171], a[152:155]
    ds_read_b128 v[160:163], v218 offset:0
    v_cvt_pk_bf16_f32 v54, v28, v29
    v_mfma_f32_16x16x32_bf16 a[152:155], v[124:127], v[172:175], a[152:155]
    v_exp_f32 v34, v34
    v_mfma_f32_16x16x32_bf16 a[156:159], v[124:127], v[180:183], a[156:159]
    ds_read_b128 v[164:167], v219 offset:0
    v_cvt_pk_bf16_f32 v55, v30, v31
    v_mfma_f32_16x16x32_bf16 a[156:159], v[120:123], v[176:179], a[156:159]
    v_exp_f32 v35, v35
    v_mfma_f32_16x16x32_bf16 a[124:127], v[112:115], v[176:179], a[124:127]
    v_exp_f32 v36, v36
    v_mfma_f32_16x16x32_bf16 a[124:127], v[116:119], v[180:183], a[124:127]
    v_cvt_pk_bf16_f32 v62, v32, v33
    v_cvt_pk_bf16_f32 v63, v34, v35
    v_mfma_f32_16x16x32_bf16 a[92:95], v[108:111], v[180:183], a[92:95]
    v_exp_f32 v37, v37
    v_mfma_f32_16x16x32_bf16 a[92:95], v[104:107], v[176:179], a[92:95]
    v_add_f32 v236, v36, v236
    v_add_f32 v236, v37, v236
    v_mfma_f32_16x16x32_bf16 a[60:63], v[96:99], v[176:179], a[60:63]
    v_exp_f32 v38, v38
    v_mfma_f32_16x16x32_bf16 a[60:63], v[100:103], v[180:183], a[60:63]
    v_cvt_pk_bf16_f32 v70, v36, v37
    v_add_f32 v236, v38, v236
    v_mfma_f32_16x16x32_bf16 a[28:31], v[92:95], v[180:183], a[28:31]
    v_exp_f32 v39, v39
    v_mfma_f32_16x16x32_bf16 a[28:31], v[88:91], v[176:179], a[28:31]
    s_waitcnt lgkmcnt(2)
    s_branch L_loop2
.p2align 6
L_loop3:
    v_mfma_f32_16x16x32_bf16 v[8:11], v[152:155], a[192:195], v[128:131]
    v_exp_f32 v44, v44
    v_mfma_f32_16x16x32_bf16 v[8:11], v[156:159], a[196:199], v[8:11]
    s_waitcnt lgkmcnt(0)
    v_cvt_pk_bf16_f32 v78, v40, v41
    v_add_f32 v237, v42, v237
    v_mfma_f32_16x16x32_bf16 v[8:11], v[160:163], a[200:203], v[8:11]
    v_exp_f32 v45, v45
    v_mfma_f32_16x16x32_bf16 v[8:11], v[164:167], a[204:207], v[8:11]
    v_add_f32 v237, v43, v237
    v_cvt_pk_bf16_f32 v79, v42, v43
    v_mfma_f32_16x16x32_bf16 v[12:15], v[164:167], a[220:223], v[132:135]
    s_mov_b32 m0, s28
    ds_read_b128 v[168:171], v216 offset:4096
    v_add_f32 v239, v44, v239
    v_mfma_f32_16x16x32_bf16 v[12:15], v[160:163], a[216:219], v[12:15]
    buffer_load_dwordx4 v228, s[8:11], s26 offen offset:0 nt lds
    v_mfma_f32_16x16x32_bf16 v[12:15], v[156:159], a[212:215], v[12:15]
    ds_read_b128 v[172:175], v217 offset:4096
    v_add_f32 v239, v45, v239
    v_mfma_f32_16x16x32_bf16 v[12:15], v[152:155], a[208:211], v[12:15]
    v_exp_f32 v46, v46
    v_mfma_f32_16x16x32_bf16 v[16:19], v[152:155], a[224:227], v[136:139]
    ds_read_b128 v[176:179], v218 offset:4096
    v_cvt_pk_bf16_f32 v86, v44, v45
    v_mfma_f32_16x16x32_bf16 v[16:19], v[156:159], a[228:231], v[16:19]
    v_exp_f32 v47, v47
    v_mfma_f32_16x16x32_bf16 v[16:19], v[160:163], a[232:235], v[16:19]
    ds_read_b128 v[180:183], v219 offset:4096
    v_add_f32 v239, v46, v239
    v_mfma_f32_16x16x32_bf16 v[16:19], v[164:167], a[236:239], v[16:19]
    v_exp_f32 v8, v8
    v_mfma_f32_16x16x32_bf16 v[20:23], v[164:167], a[252:255], v[140:143]
    v_exp_f32 v9, v9
    v_mfma_f32_16x16x32_bf16 v[20:23], v[160:163], a[248:251], v[20:23]
    v_exp_f32 v10, v10
    v_mfma_f32_16x16x32_bf16 v[20:23], v[156:159], a[244:247], v[20:23]
    v_add_f32 v239, v47, v239
    v_cvt_pk_bf16_f32 v87, v46, v47
    v_mfma_f32_16x16x32_bf16 v[20:23], v[152:155], a[240:243], v[20:23]
    v_exp_f32 v11, v11
    v_mfma_f32_16x16x32_bf16 v[24:27], v[152:155], v[184:187], v[144:147]
    v_cvt_pk_bf16_f32 v88, v8, v9
    v_cvt_pk_bf16_f32 v89, v10, v11
    v_mfma_f32_16x16x32_bf16 v[24:27], v[156:159], v[188:191], v[24:27]
    v_exp_f32 v12, v12
    v_mfma_f32_16x16x32_bf16 v[24:27], v[160:163], v[192:195], v[24:27]
    v_mfma_f32_16x16x32_bf16 v[24:27], v[164:167], v[196:199], v[24:27]
    s_waitcnt lgkmcnt(2)
    buffer_load_dwordx4 v229, s[8:11], s26 offen offset:1024 nt lds
    v_mfma_f32_16x16x32_bf16 v[28:31], v[168:171], a[192:195], v[128:131]
    v_exp_f32 v13, v13
    v_mfma_f32_16x16x32_bf16 v[28:31], v[172:175], a[196:199], v[28:31]
    s_waitcnt lgkmcnt(0)
    v_exp_f32 v14, v14
    v_mfma_f32_16x16x32_bf16 v[28:31], v[176:179], a[200:203], v[28:31]
    v_cvt_pk_bf16_f32 v96, v12, v13
    v_mfma_f32_16x16x32_bf16 v[28:31], v[180:183], a[204:207], v[28:31]
    v_exp_f32 v15, v15
    v_mfma_f32_16x16x32_bf16 v[32:35], v[180:183], a[220:223], v[132:135]
    ds_read_b64_tr_b16 v[152:153], v220 offset:16384
    v_cvt_pk_bf16_f32 v97, v14, v15
    v_mfma_f32_16x16x32_bf16 v[32:35], v[176:179], a[216:219], v[32:35]
    v_exp_f32 v16, v16
    v_mfma_f32_16x16x32_bf16 v[32:35], v[172:175], a[212:215], v[32:35]
    ds_read_b64_tr_b16 v[154:155], v220 offset:20480
    v_add_f32 v236, v16, v236
    v_mfma_f32_16x16x32_bf16 v[32:35], v[168:171], a[208:211], v[32:35]
    v_exp_f32 v17, v17
    v_mfma_f32_16x16x32_bf16 v[36:39], v[168:171], a[224:227], v[136:139]
    ds_read_b64_tr_b16 v[156:157], v220 offset:24576
    v_add_f32 v236, v17, v236
    v_mfma_f32_16x16x32_bf16 v[36:39], v[172:175], a[228:231], v[36:39]
    v_exp_f32 v18, v18
    v_mfma_f32_16x16x32_bf16 v[36:39], v[176:179], a[232:235], v[36:39]
    ds_read_b64_tr_b16 v[158:159], v220 offset:28672
    v_cvt_pk_bf16_f32 v104, v16, v17
    v_mfma_f32_16x16x32_bf16 v[36:39], v[180:183], a[236:239], v[36:39]
    v_exp_f32 v19, v19
    v_mfma_f32_16x16x32_bf16 v[40:43], v[180:183], a[252:255], v[140:143]
    v_add_f32 v236, v18, v236
    v_add_f32 v236, v19, v236
    v_mfma_f32_16x16x32_bf16 v[40:43], v[176:179], a[248:251], v[40:43]
    v_exp_f32 v20, v20
    v_mfma_f32_16x16x32_bf16 v[40:43], v[172:175], a[244:247], v[40:43]
    ds_read_b64_tr_b16 v[160:161], v221 offset:16384
    v_cvt_pk_bf16_f32 v105, v18, v19
    v_mfma_f32_16x16x32_bf16 v[40:43], v[168:171], a[240:243], v[40:43]
    buffer_load_dwordx4 v230, s[8:11], s26 offen offset:2048 nt lds
    v_mfma_f32_16x16x32_bf16 v[44:47], v[168:171], v[184:187], v[144:147]
    ds_read_b64_tr_b16 v[162:163], v221 offset:20480
    v_add_f32 v237, v20, v237
    v_mfma_f32_16x16x32_bf16 v[44:47], v[172:175], v[188:191], v[44:47]
    v_exp_f32 v21, v21
    v_mfma_f32_16x16x32_bf16 v[44:47], v[176:179], v[192:195], v[44:47]
    ds_read_b64_tr_b16 v[164:165], v221 offset:24576
    v_add_f32 v237, v21, v237
    v_mfma_f32_16x16x32_bf16 v[44:47], v[180:183], v[196:199], v[44:47]
    s_waitcnt lgkmcnt(3)
    v_exp_f32 v22, v22
    v_mfma_f32_16x16x32_bf16 a[0:3], v[48:51], v[152:155], a[0:3]
    ds_read_b64_tr_b16 v[166:167], v221 offset:28672
    v_cvt_pk_bf16_f32 v112, v20, v21
    v_mfma_f32_16x16x32_bf16 a[0:3], v[52:55], v[156:159], a[0:3]
    v_exp_f32 v23, v23
    v_mfma_f32_16x16x32_bf16 a[32:35], v[60:63], v[156:159], a[32:35]
    v_exp_f32 v24, v24
    v_mfma_f32_16x16x32_bf16 a[32:35], v[56:59], v[152:155], a[32:35]
    v_exp_f32 v25, v25
    v_mfma_f32_16x16x32_bf16 a[64:67], v[64:67], v[152:155], a[64:67]
    ds_read_b64_tr_b16 v[168:169], v222 offset:16384
    v_add_f32 v237, v22, v237
    v_mfma_f32_16x16x32_bf16 a[64:67], v[68:71], v[156:159], a[64:67]
    v_exp_f32 v26, v26
    v_mfma_f32_16x16x32_bf16 a[96:99], v[76:79], v[156:159], a[96:99]
    ds_read_b64_tr_b16 v[170:171], v222 offset:20480
    v_add_f32 v237, v23, v237
    v_mfma_f32_16x16x32_bf16 a[96:99], v[72:75], v[152:155], a[96:99]
    v_cvt_pk_bf16_f32 v113, v22, v23
    v_add_f32 v238, v24, v238
    v_mfma_f32_16x16x32_bf16 a[160:163], v[84:87], v[156:159], a[160:163]
    s_waitcnt lgkmcnt(2)
    ds_read_b64_tr_b16 v[172:173], v222 offset:24576
    v_add_f32 v238, v25, v238
    v_mfma_f32_16x16x32_bf16 a[164:167], v[84:87], v[164:167], a[164:167]
    v_exp_f32 v27, v27
    v_mfma_f32_16x16x32_bf16 a[100:103], v[72:75], v[160:163], a[100:103]
    ds_read_b64_tr_b16 v[174:175], v222 offset:28672
    v_cvt_pk_bf16_f32 v120, v24, v25
    v_mfma_f32_16x16x32_bf16 a[100:103], v[76:79], v[164:167], a[100:103]
    buffer_load_dwordx4 v231, s[8:11], s26 offen offset:3072 nt lds
    v_mfma_f32_16x16x32_bf16 a[68:71], v[68:71], v[164:167], a[68:71]
    s_add_u32 s28, s28, 32768
    v_exp_f32 v28, v28
    v_mfma_f32_16x16x32_bf16 a[68:71], v[64:67], v[160:163], a[68:71]
    s_and_b32 s28, s28, 131071
    v_exp_f32 v29, v29
    v_mfma_f32_16x16x32_bf16 a[36:39], v[56:59], v[160:163], a[36:39]
    s_add_u32 s26, s26, 16384
    ds_read_b64_tr_b16 v[176:177], v223 offset:16384
    v_add_f32 v238, v26, v238
    v_mfma_f32_16x16x32_bf16 a[36:39], v[60:63], v[164:167], a[36:39]
    s_cmp_lt_u32 s26, 524288
    v_exp_f32 v30, v30
    v_mfma_f32_16x16x32_bf16 a[4:7], v[52:55], v[164:167], a[4:7]
    s_cselect_b32 s10, 524288, 0
    ds_read_b64_tr_b16 v[178:179], v223 offset:20480
    v_add_f32 v238, v27, v238
    v_mfma_f32_16x16x32_bf16 a[4:7], v[48:51], v[160:163], a[4:7]
    v_exp_f32 v31, v31
    v_mfma_f32_16x16x32_bf16 v[244:247], v[240:243], v[48:51], v[244:247]
    ds_read_b64_tr_b16 v[180:181], v223 offset:24576
    v_cvt_pk_bf16_f32 v121, v26, v27
    v_mfma_f32_16x16x32_bf16 v[244:247], v[240:243], v[52:55], v[244:247]
    s_waitcnt lgkmcnt(3)
    v_exp_f32 v32, v32
    v_mfma_f32_16x16x32_bf16 a[8:11], v[48:51], v[168:171], a[8:11]
    ds_read_b64_tr_b16 v[182:183], v223 offset:28672
    v_cvt_pk_bf16_f32 v90, v28, v29
    v_mfma_f32_16x16x32_bf16 a[8:11], v[52:55], v[172:175], a[8:11]
    v_exp_f32 v33, v33
    v_mfma_f32_16x16x32_bf16 a[40:43], v[60:63], v[172:175], a[40:43]
    ds_read_b128 v[152:155], v216 offset:8192
    v_cvt_pk_bf16_f32 v91, v30, v31
    v_mfma_f32_16x16x32_bf16 a[40:43], v[56:59], v[168:171], a[40:43]
    v_exp_f32 v34, v34
    v_mfma_f32_16x16x32_bf16 a[72:75], v[64:67], v[168:171], a[72:75]
    ds_read_b128 v[156:159], v217 offset:8192
    v_cvt_pk_bf16_f32 v98, v32, v33
    v_mfma_f32_16x16x32_bf16 a[72:75], v[68:71], v[172:175], a[72:75]
    v_exp_f32 v35, v35
    v_mfma_f32_16x16x32_bf16 a[104:107], v[76:79], v[172:175], a[104:107]
    s_mov_b32 m0, s29
    ds_read_b128 v[160:163], v218 offset:8192
    v_cvt_pk_bf16_f32 v99, v34, v35
    v_mfma_f32_16x16x32_bf16 a[104:107], v[72:75], v[168:171], a[104:107]
    buffer_load_dwordx4 v232, s[12:15], s27 offen offset:0 nt lds
    v_mfma_f32_16x16x32_bf16 a[168:171], v[84:87], v[172:175], a[168:171]
    s_waitcnt lgkmcnt(3)
    ds_read_b128 v[164:167], v219 offset:8192
    v_mfma_f32_16x16x32_bf16 a[172:175], v[84:87], v[180:183], a[172:175]
    v_exp_f32 v36, v36
    v_mfma_f32_16x16x32_bf16 a[108:111], v[72:75], v[176:179], a[108:111]
    v_exp_f32 v37, v37
    v_mfma_f32_16x16x32_bf16 a[108:111], v[76:79], v[180:183], a[108:111]
    v_exp_f32 v38, v38
    v_mfma_f32_16x16x32_bf16 a[76:79], v[68:71], v[180:183], a[76:79]
    v_exp_f32 v39, v39
    v_mfma_f32_16x16x32_bf16 a[76:79], v[64:67], v[176:179], a[76:79]
    v_add_f32 v236, v36, v236
    v_add_f32 v236, v37, v236
    v_mfma_f32_16x16x32_bf16 a[44:47], v[56:59], v[176:179], a[44:47]
    v_exp_f32 v40, v40
    v_mfma_f32_16x16x32_bf16 a[44:47], v[60:63], v[180:183], a[44:47]
    v_cvt_pk_bf16_f32 v106, v36, v37
    v_add_f32 v236, v38, v236
    v_mfma_f32_16x16x32_bf16 a[12:15], v[52:55], v[180:183], a[12:15]
    v_exp_f32 v41, v41
    v_mfma_f32_16x16x32_bf16 a[12:15], v[48:51], v[176:179], a[12:15]
    s_waitcnt lgkmcnt(2)
    v_add_f32 v236, v39, v236
    v_cvt_pk_bf16_f32 v107, v38, v39
    v_mfma_f32_16x16x32_bf16 v[8:11], v[152:155], a[192:195], v[128:131]
    v_exp_f32 v42, v42
    v_mfma_f32_16x16x32_bf16 v[8:11], v[156:159], a[196:199], v[8:11]
    s_waitcnt lgkmcnt(0)
    v_add_f32 v237, v40, v237
    v_add_f32 v237, v41, v237
    v_mfma_f32_16x16x32_bf16 v[8:11], v[160:163], a[200:203], v[8:11]
    v_exp_f32 v43, v43
    v_mfma_f32_16x16x32_bf16 v[8:11], v[164:167], a[204:207], v[8:11]
    buffer_load_dwordx4 v233, s[12:15], s27 offen offset:1024 nt lds
    v_mfma_f32_16x16x32_bf16 v[12:15], v[164:167], a[220:223], v[132:135]
    ds_read_b128 v[168:171], v216 offset:12288
    v_cvt_pk_bf16_f32 v114, v40, v41
    v_mfma_f32_16x16x32_bf16 v[12:15], v[160:163], a[216:219], v[12:15]
    v_exp_f32 v44, v44
    v_mfma_f32_16x16x32_bf16 v[12:15], v[156:159], a[212:215], v[12:15]
    ds_read_b128 v[172:175], v217 offset:12288
    v_add_f32 v237, v42, v237
    v_mfma_f32_16x16x32_bf16 v[12:15], v[152:155], a[208:211], v[12:15]
    v_exp_f32 v45, v45
    v_mfma_f32_16x16x32_bf16 v[16:19], v[152:155], a[224:227], v[136:139]
    ds_read_b128 v[176:179], v218 offset:12288
    v_add_f32 v237, v43, v237
    v_mfma_f32_16x16x32_bf16 v[16:19], v[156:159], a[228:231], v[16:19]
    v_exp_f32 v46, v46
    v_mfma_f32_16x16x32_bf16 v[16:19], v[160:163], a[232:235], v[16:19]
    ds_read_b128 v[180:183], v219 offset:12288
    v_cvt_pk_bf16_f32 v115, v42, v43
    v_mfma_f32_16x16x32_bf16 v[16:19], v[164:167], a[236:239], v[16:19]
    v_exp_f32 v47, v47
    v_mfma_f32_16x16x32_bf16 v[20:23], v[164:167], a[252:255], v[140:143]
    v_add_f32 v238, v44, v238
    v_add_f32 v238, v45, v238
    v_mfma_f32_16x16x32_bf16 v[20:23], v[160:163], a[248:251], v[20:23]
    v_exp_f32 v8, v8
    v_mfma_f32_16x16x32_bf16 v[20:23], v[156:159], a[244:247], v[20:23]
    v_cvt_pk_bf16_f32 v122, v44, v45
    v_add_f32 v238, v46, v238
    v_mfma_f32_16x16x32_bf16 v[20:23], v[152:155], a[240:243], v[20:23]
    v_exp_f32 v9, v9
    v_mfma_f32_16x16x32_bf16 v[24:27], v[152:155], v[184:187], v[144:147]
    v_add_f32 v238, v47, v238
    v_cvt_pk_bf16_f32 v123, v46, v47
    v_mfma_f32_16x16x32_bf16 v[24:27], v[156:159], v[188:191], v[24:27]
    v_exp_f32 v10, v10
    v_mfma_f32_16x16x32_bf16 v[24:27], v[160:163], v[192:195], v[24:27]
    v_cvt_pk_bf16_f32 v92, v8, v9
    v_mfma_f32_16x16x32_bf16 v[24:27], v[164:167], v[196:199], v[24:27]
    s_waitcnt lgkmcnt(2)
    buffer_load_dwordx4 v232, s[12:15], s27 offen offset:2048 nt lds
    v_mfma_f32_16x16x32_bf16 v[28:31], v[168:171], a[192:195], v[128:131]
    v_exp_f32 v11, v11
    v_mfma_f32_16x16x32_bf16 v[28:31], v[172:175], a[196:199], v[28:31]
    s_waitcnt lgkmcnt(0)
    v_exp_f32 v12, v12
    v_mfma_f32_16x16x32_bf16 v[28:31], v[176:179], a[200:203], v[28:31]
    v_cvt_pk_bf16_f32 v93, v10, v11
    v_mfma_f32_16x16x32_bf16 v[28:31], v[180:183], a[204:207], v[28:31]
    v_exp_f32 v13, v13
    v_mfma_f32_16x16x32_bf16 v[32:35], v[180:183], a[220:223], v[132:135]
    ds_read_b64_tr_b16 v[152:153], v224 offset:16384
    v_cvt_pk_bf16_f32 v100, v12, v13
    v_mfma_f32_16x16x32_bf16 v[32:35], v[176:179], a[216:219], v[32:35]
    v_exp_f32 v14, v14
    v_mfma_f32_16x16x32_bf16 v[32:35], v[172:175], a[212:215], v[32:35]
    ds_read_b64_tr_b16 v[154:155], v224 offset:20480
    v_mfma_f32_16x16x32_bf16 v[32:35], v[168:171], a[208:211], v[32:35]
    v_exp_f32 v15, v15
    v_mfma_f32_16x16x32_bf16 v[36:39], v[168:171], a[224:227], v[136:139]
    ds_read_b64_tr_b16 v[156:157], v224 offset:24576
    v_cvt_pk_bf16_f32 v101, v14, v15
    v_mfma_f32_16x16x32_bf16 v[36:39], v[172:175], a[228:231], v[36:39]
    v_exp_f32 v16, v16
    v_mfma_f32_16x16x32_bf16 v[36:39], v[176:179], a[232:235], v[36:39]
    ds_read_b64_tr_b16 v[158:159], v224 offset:28672
    v_add_f32 v236, v16, v236
    v_mfma_f32_16x16x32_bf16 v[36:39], v[180:183], a[236:239], v[36:39]
    v_exp_f32 v17, v17
    v_mfma_f32_16x16x32_bf16 v[40:43], v[180:183], a[252:255], v[140:143]
    v_add_f32 v236, v17, v236
    v_cvt_pk_bf16_f32 v108, v16, v17
    v_mfma_f32_16x16x32_bf16 v[40:43], v[176:179], a[248:251], v[40:43]
    v_exp_f32 v18, v18
    v_mfma_f32_16x16x32_bf16 v[40:43], v[172:175], a[244:247], v[40:43]
    ds_read_b64_tr_b16 v[160:161], v225 offset:16384
    v_add_f32 v236, v18, v236
    v_mfma_f32_16x16x32_bf16 v[40:43], v[168:171], a[240:243], v[40:43]
    buffer_load_dwordx4 v233, s[12:15], s27 offen offset:3072 nt lds
    v_mfma_f32_16x16x32_bf16 v[44:47], v[168:171], v[184:187], v[144:147]
    s_add_u32 s29, s29, 32768
    ds_read_b64_tr_b16 v[162:163], v225 offset:20480
    v_mfma_f32_16x16x32_bf16 v[44:47], v[172:175], v[188:191], v[44:47]
    s_and_b32 s29, s29, 131071
    v_exp_f32 v19, v19
    v_mfma_f32_16x16x32_bf16 v[44:47], v[176:179], v[192:195], v[44:47]
    s_add_u32 s27, s27, 16384
    ds_read_b64_tr_b16 v[164:165], v225 offset:24576
    v_add_f32 v236, v19, v236
    v_mfma_f32_16x16x32_bf16 v[44:47], v[180:183], v[196:199], v[44:47]
    s_waitcnt lgkmcnt(3)
    v_exp_f32 v20, v20
    v_mfma_f32_16x16x32_bf16 a[16:19], v[48:51], v[152:155], a[16:19]
    s_cmp_lt_u32 s27, 524288
    ds_read_b64_tr_b16 v[166:167], v225 offset:28672
    v_cvt_pk_bf16_f32 v109, v18, v19
    v_mfma_f32_16x16x32_bf16 a[16:19], v[52:55], v[156:159], a[16:19]
    s_cselect_b32 s14, 524288, 0
    ds_read_b64_tr_b16 v[168:169], v226 offset:16384
    v_add_f32 v237, v20, v237
    v_mfma_f32_16x16x32_bf16 a[48:51], v[60:63], v[156:159], a[48:51]
    ds_read_b64_tr_b16 v[170:171], v226 offset:20480
    v_mfma_f32_16x16x32_bf16 a[48:51], v[56:59], v[152:155], a[48:51]
    ds_read_b64_tr_b16 v[172:173], v226 offset:24576
    v_mfma_f32_16x16x32_bf16 a[80:83], v[64:67], v[152:155], a[80:83]
    ds_read_b64_tr_b16 v[174:175], v226 offset:28672
    v_mfma_f32_16x16x32_bf16 a[80:83], v[68:71], v[156:159], a[80:83]
    v_exp_f32 v21, v21
    v_mfma_f32_16x16x32_bf16 a[112:115], v[76:79], v[156:159], a[112:115]
    ds_read_b64_tr_b16 v[176:177], v227 offset:16384
    v_add_f32 v237, v21, v237
    v_mfma_f32_16x16x32_bf16 a[112:115], v[72:75], v[152:155], a[112:115]
    v_exp_f32 v22, v22
    v_mfma_f32_16x16x32_bf16 a[176:179], v[84:87], v[156:159], a[176:179]
    s_waitcnt lgkmcnt(5)
    ds_read_b64_tr_b16 v[178:179], v227 offset:20480
    v_cvt_pk_bf16_f32 v116, v20, v21
    v_mfma_f32_16x16x32_bf16 a[180:183], v[84:87], v[164:167], a[180:183]
    v_exp_f32 v23, v23
    v_mfma_f32_16x16x32_bf16 a[116:119], v[72:75], v[160:163], a[116:119]
    ds_read_b64_tr_b16 v[180:181], v227 offset:24576
    v_add_f32 v237, v22, v237
    v_mfma_f32_16x16x32_bf16 a[116:119], v[76:79], v[164:167], a[116:119]
    v_exp_f32 v24, v24
    v_mfma_f32_16x16x32_bf16 a[84:87], v[68:71], v[164:167], a[84:87]
    ds_read_b64_tr_b16 v[182:183], v227 offset:28672
    v_add_f32 v237, v23, v237
    v_mfma_f32_16x16x32_bf16 a[84:87], v[64:67], v[160:163], a[84:87]
    v_exp_f32 v25, v25
    v_mfma_f32_16x16x32_bf16 a[52:55], v[56:59], v[160:163], a[52:55]
    v_exp_f32 v26, v26
    v_mfma_f32_16x16x32_bf16 a[52:55], v[60:63], v[164:167], a[52:55]
    v_exp_f32 v27, v27
    v_mfma_f32_16x16x32_bf16 a[20:23], v[52:55], v[164:167], a[20:23]
    v_exp_f32 v28, v28
    v_mfma_f32_16x16x32_bf16 a[20:23], v[48:51], v[160:163], a[20:23]
    v_exp_f32 v29, v29
    v_mfma_f32_16x16x32_bf16 v[248:251], v[240:243], v[56:59], v[248:251]
    v_exp_f32 v30, v30
    v_mfma_f32_16x16x32_bf16 v[248:251], v[240:243], v[60:63], v[248:251]
    s_waitcnt vmcnt(8) lgkmcnt(0)
    v_cvt_pk_bf16_f32 v117, v22, v23
    v_add_f32 v238, v24, v238
    v_mfma_f32_16x16x32_bf16 a[24:27], v[48:51], v[168:171], a[24:27]
    s_barrier
    v_mfma_f32_16x16x32_bf16 a[24:27], v[52:55], v[172:175], a[24:27]
    v_exp_f32 v31, v31
    v_mfma_f32_16x16x32_bf16 a[56:59], v[60:63], v[172:175], a[56:59]
    ds_read_b128 v[152:155], v216 offset:32768
    v_add_f32 v238, v25, v238
    v_mfma_f32_16x16x32_bf16 a[56:59], v[56:59], v[168:171], a[56:59]
    v_exp_f32 v32, v32
    v_mfma_f32_16x16x32_bf16 a[88:91], v[64:67], v[168:171], a[88:91]
    ds_read_b128 v[156:159], v217 offset:32768
    v_cvt_pk_bf16_f32 v124, v24, v25
    v_mfma_f32_16x16x32_bf16 a[88:91], v[68:71], v[172:175], a[88:91]
    v_exp_f32 v33, v33
    v_mfma_f32_16x16x32_bf16 a[120:123], v[76:79], v[172:175], a[120:123]
    ds_read_b128 v[160:163], v218 offset:32768
    v_add_f32 v238, v26, v238
    v_mfma_f32_16x16x32_bf16 a[120:123], v[72:75], v[168:171], a[120:123]
    v_exp_f32 v34, v34
    v_mfma_f32_16x16x32_bf16 a[184:187], v[84:87], v[172:175], a[184:187]
    ds_read_b128 v[164:167], v219 offset:32768
    v_add_f32 v238, v27, v238
    v_mfma_f32_16x16x32_bf16 a[188:191], v[84:87], v[180:183], a[188:191]
    v_exp_f32 v35, v35
    v_mfma_f32_16x16x32_bf16 a[124:127], v[72:75], v[176:179], a[124:127]
    v_exp_f32 v36, v36
    v_mfma_f32_16x16x32_bf16 a[124:127], v[76:79], v[180:183], a[124:127]
    v_cvt_pk_bf16_f32 v125, v26, v27
    v_cvt_pk_bf16_f32 v94, v28, v29
    v_mfma_f32_16x16x32_bf16 a[92:95], v[68:71], v[180:183], a[92:95]
    v_exp_f32 v37, v37
    v_mfma_f32_16x16x32_bf16 a[92:95], v[64:67], v[176:179], a[92:95]
    v_cvt_pk_bf16_f32 v95, v30, v31
    v_cvt_pk_bf16_f32 v102, v32, v33
    v_mfma_f32_16x16x32_bf16 a[60:63], v[56:59], v[176:179], a[60:63]
    v_exp_f32 v38, v38
    v_mfma_f32_16x16x32_bf16 a[60:63], v[60:63], v[180:183], a[60:63]
    v_cvt_pk_bf16_f32 v103, v34, v35
    v_add_f32 v236, v36, v236
    v_mfma_f32_16x16x32_bf16 a[28:31], v[52:55], v[180:183], a[28:31]
    s_sub_u32 s25, s25, 1
    v_exp_f32 v39, v39
    v_mfma_f32_16x16x32_bf16 a[28:31], v[48:51], v[176:179], a[28:31]
    s_waitcnt lgkmcnt(2)
    v_add_f32 v236, v37, v236
    s_cbranch_scc1 L_tail3
    v_mfma_f32_16x16x32_bf16 v[8:11], v[152:155], a[192:195], v[128:131]
    ds_read_b128 v[168:171], v216 offset:36864
    v_cvt_pk_bf16_f32 v110, v36, v37
    v_mfma_f32_16x16x32_bf16 v[8:11], v[156:159], a[196:199], v[8:11]
    s_waitcnt lgkmcnt(1)
    v_exp_f32 v40, v40
    v_mfma_f32_16x16x32_bf16 v[8:11], v[160:163], a[200:203], v[8:11]
    ds_read_b128 v[172:175], v217 offset:36864
    v_add_f32 v236, v38, v236
    v_mfma_f32_16x16x32_bf16 v[8:11], v[164:167], a[204:207], v[8:11]
    v_exp_f32 v41, v41
    v_mfma_f32_16x16x32_bf16 v[12:15], v[164:167], a[220:223], v[132:135]
    s_mov_b32 m0, s28
    ds_read_b128 v[176:179], v218 offset:36864
    v_add_f32 v236, v39, v236
    v_mfma_f32_16x16x32_bf16 v[12:15], v[160:163], a[216:219], v[12:15]
    buffer_load_dwordx4 v228, s[8:11], s26 offen offset:0 nt lds
    v_mfma_f32_16x16x32_bf16 v[12:15], v[156:159], a[212:215], v[12:15]
    ds_read_b128 v[180:183], v219 offset:36864
    v_cvt_pk_bf16_f32 v111, v38, v39
    v_mfma_f32_16x16x32_bf16 v[12:15], v[152:155], a[208:211], v[12:15]
    v_exp_f32 v42, v42
    v_mfma_f32_16x16x32_bf16 v[16:19], v[152:155], a[224:227], v[136:139]
    v_exp_f32 v43, v43
    v_mfma_f32_16x16x32_bf16 v[16:19], v[156:159], a[228:231], v[16:19]
    v_exp_f32 v44, v44
    v_mfma_f32_16x16x32_bf16 v[16:19], v[160:163], a[232:235], v[16:19]
    v_add_f32 v237, v40, v237
    v_add_f32 v237, v41, v237
    v_mfma_f32_16x16x32_bf16 v[16:19], v[164:167], a[236:239], v[16:19]
    v_exp_f32 v45, v45
    v_mfma_f32_16x16x32_bf16 v[20:23], v[164:167], a[252:255], v[140:143]
    v_cvt_pk_bf16_f32 v118, v40, v41
    v_add_f32 v237, v42, v237
    v_mfma_f32_16x16x32_bf16 v[20:23], v[160:163], a[248:251], v[20:23]
    v_exp_f32 v46, v46
    v_mfma_f32_16x16x32_bf16 v[20:23], v[156:159], a[244:247], v[20:23]
    v_add_f32 v237, v43, v237
    v_cvt_pk_bf16_f32 v119, v42, v43
    v_mfma_f32_16x16x32_bf16 v[20:23], v[152:155], a[240:243], v[20:23]
    s_waitcnt lgkmcnt(2)
    v_exp_f32 v47, v47
    v_mfma_f32_16x16x32_bf16 v[28:31], v[168:171], a[192:195], v[128:131]
    ds_read_b64_tr_b16 v[152:153], v220 offset:49152
    v_add_f32 v238, v44, v238
    v_mfma_f32_16x16x32_bf16 v[28:31], v[172:175], a[196:199], v[28:31]
    s_waitcnt lgkmcnt(1)
    v_exp_f32 v8, v8
    v_mfma_f32_16x16x32_bf16 v[28:31], v[176:179], a[200:203], v[28:31]
    ds_read_b64_tr_b16 v[154:155], v220 offset:53248
    v_add_f32 v238, v45, v238
    v_mfma_f32_16x16x32_bf16 v[28:31], v[180:183], a[204:207], v[28:31]
    buffer_load_dwordx4 v229, s[8:11], s26 offen offset:1024 nt lds
    v_mfma_f32_16x16x32_bf16 v[32:35], v[180:183], a[220:223], v[132:135]
    ds_read_b64_tr_b16 v[156:157], v220 offset:57344
    v_cvt_pk_bf16_f32 v126, v44, v45
    v_mfma_f32_16x16x32_bf16 v[32:35], v[176:179], a[216:219], v[32:35]
    v_exp_f32 v9, v9
    v_mfma_f32_16x16x32_bf16 v[32:35], v[172:175], a[212:215], v[32:35]
    ds_read_b64_tr_b16 v[158:159], v220 offset:61440
    v_add_f32 v238, v46, v238
    v_mfma_f32_16x16x32_bf16 v[32:35], v[168:171], a[208:211], v[32:35]
    v_exp_f32 v10, v10
    v_mfma_f32_16x16x32_bf16 v[36:39], v[168:171], a[224:227], v[136:139]
    v_exp_f32 v11, v11
    v_mfma_f32_16x16x32_bf16 v[36:39], v[172:175], a[228:231], v[36:39]
    v_exp_f32 v12, v12
    v_mfma_f32_16x16x32_bf16 v[36:39], v[176:179], a[232:235], v[36:39]
    v_add_f32 v238, v47, v238
    v_cvt_pk_bf16_f32 v127, v46, v47
    v_mfma_f32_16x16x32_bf16 v[36:39], v[180:183], a[236:239], v[36:39]
    ds_read_b64_tr_b16 v[160:161], v221 offset:49152
    v_cvt_pk_bf16_f32 v48, v8, v9
    v_mfma_f32_16x16x32_bf16 v[40:43], v[180:183], a[252:255], v[140:143]
    v_exp_f32 v13, v13
    v_mfma_f32_16x16x32_bf16 v[40:43], v[176:179], a[248:251], v[40:43]
    ds_read_b64_tr_b16 v[162:163], v221 offset:53248
    v_cvt_pk_bf16_f32 v49, v10, v11
    v_mfma_f32_16x16x32_bf16 v[40:43], v[172:175], a[244:247], v[40:43]
    v_exp_f32 v14, v14
    v_mfma_f32_16x16x32_bf16 v[40:43], v[168:171], a[240:243], v[40:43]
    s_waitcnt lgkmcnt(2)
    ds_read_b64_tr_b16 v[164:165], v221 offset:57344
    v_cvt_pk_bf16_f32 v56, v12, v13
    v_mfma_f32_16x16x32_bf16 a[0:3], v[88:91], v[152:155], a[0:3]
    v_exp_f32 v15, v15
    v_mfma_f32_16x16x32_bf16 a[0:3], v[92:95], v[156:159], a[0:3]
    ds_read_b64_tr_b16 v[166:167], v221 offset:61440
    v_cvt_pk_bf16_f32 v57, v14, v15
    v_mfma_f32_16x16x32_bf16 a[32:35], v[100:103], v[156:159], a[32:35]
    v_exp_f32 v16, v16
    v_mfma_f32_16x16x32_bf16 a[32:35], v[96:99], v[152:155], a[32:35]
    buffer_load_dwordx4 v230, s[8:11], s26 offen offset:2048 nt lds
    v_mfma_f32_16x16x32_bf16 a[64:67], v[104:107], v[152:155], a[64:67]
    v_exp_f32 v17, v17
    v_mfma_f32_16x16x32_bf16 a[64:67], v[108:111], v[156:159], a[64:67]
    v_exp_f32 v18, v18
    v_mfma_f32_16x16x32_bf16 a[96:99], v[116:119], v[156:159], a[96:99]
    ds_read_b64_tr_b16 v[168:169], v222 offset:49152
    v_add_f32 v236, v16, v236
    v_mfma_f32_16x16x32_bf16 a[96:99], v[112:115], v[152:155], a[96:99]
    v_exp_f32 v19, v19
    v_mfma_f32_16x16x32_bf16 a[128:131], v[120:123], v[152:155], a[128:131]
    ds_read_b64_tr_b16 v[170:171], v222 offset:53248
    v_add_f32 v236, v17, v236
    v_mfma_f32_16x16x32_bf16 a[128:131], v[124:127], v[156:159], a[128:131]
    s_waitcnt lgkmcnt(2)
    v_exp_f32 v20, v20
    v_mfma_f32_16x16x32_bf16 a[132:135], v[124:127], v[164:167], a[132:135]
    ds_read_b64_tr_b16 v[172:173], v222 offset:57344
    v_cvt_pk_bf16_f32 v64, v16, v17
    v_mfma_f32_16x16x32_bf16 a[132:135], v[120:123], v[160:163], a[132:135]
    v_exp_f32 v21, v21
    v_mfma_f32_16x16x32_bf16 a[100:103], v[112:115], v[160:163], a[100:103]
    ds_read_b64_tr_b16 v[174:175], v222 offset:61440
    v_add_f32 v236, v18, v236
    v_mfma_f32_16x16x32_bf16 a[100:103], v[116:119], v[164:167], a[100:103]
    v_exp_f32 v22, v22
    v_mfma_f32_16x16x32_bf16 a[68:71], v[108:111], v[164:167], a[68:71]
    v_add_f32 v236, v19, v236
    v_cvt_pk_bf16_f32 v65, v18, v19
    v_mfma_f32_16x16x32_bf16 a[68:71], v[104:107], v[160:163], a[68:71]
    v_add_f32 v237, v20, v237
    v_add_f32 v237, v21, v237
    v_mfma_f32_16x16x32_bf16 a[36:39], v[96:99], v[160:163], a[36:39]
    v_exp_f32 v23, v23
    v_mfma_f32_16x16x32_bf16 a[36:39], v[100:103], v[164:167], a[36:39]
    ds_read_b64_tr_b16 v[176:177], v223 offset:49152
    v_cvt_pk_bf16_f32 v72, v20, v21
    v_mfma_f32_16x16x32_bf16 a[4:7], v[92:95], v[164:167], a[4:7]
    buffer_load_dwordx4 v231, s[8:11], s26 offen offset:3072 nt lds
    v_mfma_f32_16x16x32_bf16 a[4:7], v[88:91], v[160:163], a[4:7]
    s_add_u32 s28, s28, 32768
    ds_read_b64_tr_b16 v[178:179], v223 offset:53248
    v_add_f32 v237, v22, v237
    v_mfma_f32_16x16x32_bf16 v[244:247], v[240:243], v[88:91], v[244:247]
    s_and_b32 s28, s28, 131071
    v_exp_f32 v28, v28
    v_mfma_f32_16x16x32_bf16 v[244:247], v[240:243], v[92:95], v[244:247]
    s_waitcnt lgkmcnt(2)
    ds_read_b64_tr_b16 v[180:181], v223 offset:57344
    v_add_f32 v237, v23, v237
    v_mfma_f32_16x16x32_bf16 a[8:11], v[88:91], v[168:171], a[8:11]
    s_add_u32 s26, s26, 16384
    v_exp_f32 v29, v29
    v_mfma_f32_16x16x32_bf16 a[8:11], v[92:95], v[172:175], a[8:11]
    s_cmp_lt_u32 s26, 524288
    ds_read_b64_tr_b16 v[182:183], v223 offset:61440
    v_cvt_pk_bf16_f32 v73, v22, v23
    v_mfma_f32_16x16x32_bf16 a[40:43], v[100:103], v[172:175], a[40:43]
    s_cselect_b32 s10, 524288, 0
    v_exp_f32 v30, v30
    v_mfma_f32_16x16x32_bf16 a[40:43], v[96:99], v[168:171], a[40:43]
    v_exp_f32 v31, v31
    v_mfma_f32_16x16x32_bf16 a[72:75], v[104:107], v[168:171], a[72:75]
    ds_read_b128 v[152:155], v216 offset:40960
    v_cvt_pk_bf16_f32 v50, v28, v29
    v_mfma_f32_16x16x32_bf16 a[72:75], v[108:111], v[172:175], a[72:75]
    v_exp_f32 v32, v32
    v_mfma_f32_16x16x32_bf16 a[104:107], v[116:119], v[172:175], a[104:107]
    ds_read_b128 v[156:159], v217 offset:40960
    v_cvt_pk_bf16_f32 v51, v30, v31
    v_mfma_f32_16x16x32_bf16 a[104:107], v[112:115], v[168:171], a[104:107]
    v_exp_f32 v33, v33
    v_mfma_f32_16x16x32_bf16 a[136:139], v[120:123], v[168:171], a[136:139]
    ds_read_b128 v[160:163], v218 offset:40960
    v_cvt_pk_bf16_f32 v58, v32, v33
    v_mfma_f32_16x16x32_bf16 a[136:139], v[124:127], v[172:175], a[136:139]
    s_waitcnt lgkmcnt(3)
    v_exp_f32 v34, v34
    v_mfma_f32_16x16x32_bf16 a[140:143], v[124:127], v[180:183], a[140:143]
    ds_read_b128 v[164:167], v219 offset:40960
    v_xor_b32 v220, 0x10000, v220
    v_mfma_f32_16x16x32_bf16 a[140:143], v[120:123], v[176:179], a[140:143]
    s_mov_b32 m0, s29
    v_exp_f32 v35, v35
    v_mfma_f32_16x16x32_bf16 a[108:111], v[112:115], v[176:179], a[108:111]
    buffer_load_dwordx4 v232, s[12:15], s27 offen offset:0 nt lds
    v_mfma_f32_16x16x32_bf16 a[108:111], v[116:119], v[180:183], a[108:111]
    v_exp_f32 v36, v36
    v_mfma_f32_16x16x32_bf16 a[76:79], v[108:111], v[180:183], a[76:79]
    v_exp_f32 v37, v37
    v_mfma_f32_16x16x32_bf16 a[76:79], v[104:107], v[176:179], a[76:79]
    v_cvt_pk_bf16_f32 v59, v34, v35
    v_add_f32 v236, v36, v236
    v_mfma_f32_16x16x32_bf16 a[44:47], v[96:99], v[176:179], a[44:47]
    v_exp_f32 v38, v38
    v_mfma_f32_16x16x32_bf16 a[44:47], v[100:103], v[180:183], a[44:47]
    v_add_f32 v236, v37, v236
    v_cvt_pk_bf16_f32 v66, v36, v37
    v_mfma_f32_16x16x32_bf16 a[12:15], v[92:95], v[180:183], a[12:15]
    v_exp_f32 v39, v39
    v_mfma_f32_16x16x32_bf16 a[12:15], v[88:91], v[176:179], a[12:15]
    s_waitcnt lgkmcnt(2)
    v_add_f32 v236, v38, v236
    v_add_f32 v236, v39, v236
    v_mfma_f32_16x16x32_bf16 v[8:11], v[152:155], a[192:195], v[128:131]
    v_exp_f32 v40, v40
    v_mfma_f32_16x16x32_bf16 v[8:11], v[156:159], a[196:199], v[8:11]
    s_waitcnt lgkmcnt(0)
    v_cvt_pk_bf16_f32 v67, v38, v39
    v_add_f32 v237, v40, v237
    v_mfma_f32_16x16x32_bf16 v[8:11], v[160:163], a[200:203], v[8:11]
    v_exp_f32 v41, v41
    v_mfma_f32_16x16x32_bf16 v[8:11], v[164:167], a[204:207], v[8:11]
    v_add_f32 v237, v41, v237
    v_cvt_pk_bf16_f32 v74, v40, v41
    v_mfma_f32_16x16x32_bf16 v[12:15], v[164:167], a[220:223], v[132:135]
    ds_read_b128 v[168:171], v216 offset:45056
    v_xor_b32 v221, 0x10000, v221
    v_mfma_f32_16x16x32_bf16 v[12:15], v[160:163], a[216:219], v[12:15]
    v_exp_f32 v42, v42
    v_mfma_f32_16x16x32_bf16 v[12:15], v[156:159], a[212:215], v[12:15]
    ds_read_b128 v[172:175], v217 offset:45056
    v_add_f32 v237, v42, v237
    v_mfma_f32_16x16x32_bf16 v[12:15], v[152:155], a[208:211], v[12:15]
    buffer_load_dwordx4 v233, s[12:15], s27 offen offset:1024 nt lds
    v_mfma_f32_16x16x32_bf16 v[16:19], v[152:155], a[224:227], v[136:139]
    ds_read_b128 v[176:179], v218 offset:45056
    v_xor_b32 v222, 0x10000, v222
    v_mfma_f32_16x16x32_bf16 v[16:19], v[156:159], a[228:231], v[16:19]
    v_exp_f32 v43, v43
    v_mfma_f32_16x16x32_bf16 v[16:19], v[160:163], a[232:235], v[16:19]
    ds_read_b128 v[180:183], v219 offset:45056
    v_add_f32 v237, v43, v237
    v_mfma_f32_16x16x32_bf16 v[16:19], v[164:167], a[236:239], v[16:19]
    v_exp_f32 v8, v8
    v_mfma_f32_16x16x32_bf16 v[20:23], v[164:167], a[252:255], v[140:143]
    v_exp_f32 v9, v9
    v_mfma_f32_16x16x32_bf16 v[20:23], v[160:163], a[248:251], v[20:23]
    v_exp_f32 v10, v10
    v_mfma_f32_16x16x32_bf16 v[20:23], v[156:159], a[244:247], v[20:23]
    v_cvt_pk_bf16_f32 v75, v42, v43
    v_cvt_pk_bf16_f32 v52, v8, v9
    v_mfma_f32_16x16x32_bf16 v[20:23], v[152:155], a[240:243], v[20:23]
    v_exp_f32 v11, v11
    v_mfma_f32_16x16x32_bf16 v[24:27], v[152:155], v[200:203], v[148:151]
    v_cvt_pk_bf16_f32 v53, v10, v11
    v_xor_b32 v218, 0x10000, v218
    v_mfma_f32_16x16x32_bf16 v[24:27], v[156:159], v[204:207], v[24:27]
    v_exp_f32 v12, v12
    v_mfma_f32_16x16x32_bf16 v[24:27], v[160:163], v[208:211], v[24:27]
    v_xor_b32 v216, 0x10000, v216
    v_xor_b32 v219, 0x10000, v219
    v_mfma_f32_16x16x32_bf16 v[24:27], v[164:167], v[212:215], v[24:27]
    s_waitcnt lgkmcnt(2)
    v_exp_f32 v13, v13
    v_mfma_f32_16x16x32_bf16 v[28:31], v[168:171], a[192:195], v[128:131]
    v_cvt_pk_bf16_f32 v60, v12, v13
    v_xor_b32 v223, 0x10000, v223
    v_mfma_f32_16x16x32_bf16 v[28:31], v[172:175], a[196:199], v[28:31]
    s_waitcnt lgkmcnt(0)
    v_exp_f32 v14, v14
    v_mfma_f32_16x16x32_bf16 v[28:31], v[176:179], a[200:203], v[28:31]
    v_xor_b32 v217, 0x10000, v217
    v_mfma_f32_16x16x32_bf16 v[28:31], v[180:183], a[204:207], v[28:31]
    buffer_load_dwordx4 v232, s[12:15], s27 offen offset:2048 nt lds
    v_mfma_f32_16x16x32_bf16 v[32:35], v[180:183], a[220:223], v[132:135]
    ds_read_b64_tr_b16 v[152:153], v224 offset:49152
    v_mfma_f32_16x16x32_bf16 v[32:35], v[176:179], a[216:219], v[32:35]
    v_exp_f32 v15, v15
    v_mfma_f32_16x16x32_bf16 v[32:35], v[172:175], a[212:215], v[32:35]
    ds_read_b64_tr_b16 v[154:155], v224 offset:53248
    v_cvt_pk_bf16_f32 v61, v14, v15
    v_mfma_f32_16x16x32_bf16 v[32:35], v[168:171], a[208:211], v[32:35]
    v_exp_f32 v16, v16
    v_mfma_f32_16x16x32_bf16 v[36:39], v[168:171], a[224:227], v[136:139]
    ds_read_b64_tr_b16 v[156:157], v224 offset:57344
    v_add_f32 v236, v16, v236
    v_mfma_f32_16x16x32_bf16 v[36:39], v[172:175], a[228:231], v[36:39]
    v_exp_f32 v17, v17
    v_mfma_f32_16x16x32_bf16 v[36:39], v[176:179], a[232:235], v[36:39]
    ds_read_b64_tr_b16 v[158:159], v224 offset:61440
    v_add_f32 v236, v17, v236
    v_mfma_f32_16x16x32_bf16 v[36:39], v[180:183], a[236:239], v[36:39]
    v_exp_f32 v18, v18
    v_xor_b32 v224, 0x10000, v224
    v_mfma_f32_16x16x32_bf16 v[40:43], v[180:183], a[252:255], v[140:143]
    v_exp_f32 v19, v19
    v_mfma_f32_16x16x32_bf16 v[40:43], v[176:179], a[248:251], v[40:43]
    v_exp_f32 v20, v20
    v_mfma_f32_16x16x32_bf16 v[40:43], v[172:175], a[244:247], v[40:43]
    v_cvt_pk_bf16_f32 v68, v16, v17
    v_add_f32 v236, v18, v236
    v_mfma_f32_16x16x32_bf16 v[40:43], v[168:171], a[240:243], v[40:43]
    ds_read_b64_tr_b16 v[160:161], v225 offset:49152
    v_add_f32 v236, v19, v236
    v_mfma_f32_16x16x32_bf16 v[44:47], v[168:171], v[200:203], v[148:151]
    v_exp_f32 v21, v21
    v_mfma_f32_16x16x32_bf16 v[44:47], v[172:175], v[204:207], v[44:47]
    ds_read_b64_tr_b16 v[162:163], v225 offset:53248
    v_cvt_pk_bf16_f32 v69, v18, v19
    v_mfma_f32_16x16x32_bf16 v[44:47], v[176:179], v[208:211], v[44:47]
    buffer_load_dwordx4 v233, s[12:15], s27 offen offset:3072 nt lds
    v_mfma_f32_16x16x32_bf16 v[44:47], v[180:183], v[212:215], v[44:47]
    s_waitcnt lgkmcnt(2)
    ds_read_b64_tr_b16 v[164:165], v225 offset:57344
    v_add_f32 v237, v20, v237
    v_mfma_f32_16x16x32_bf16 a[16:19], v[88:91], v[152:155], a[16:19]
    s_add_u32 s29, s29, 32768
    v_exp_f32 v22, v22
    v_mfma_f32_16x16x32_bf16 a[16:19], v[92:95], v[156:159], a[16:19]
    s_and_b32 s29, s29, 131071
    ds_read_b64_tr_b16 v[166:167], v225 offset:61440
    v_add_f32 v237, v21, v237
    v_mfma_f32_16x16x32_bf16 a[48:51], v[100:103], v[156:159], a[48:51]
    s_add_u32 s27, s27, 16384
    ds_read_b64_tr_b16 v[168:169], v226 offset:49152
    v_cvt_pk_bf16_f32 v76, v20, v21
    v_xor_b32 v225, 0x10000, v225
    v_mfma_f32_16x16x32_bf16 a[48:51], v[96:99], v[152:155], a[48:51]
    s_cmp_lt_u32 s27, 524288
    v_exp_f32 v23, v23
    v_mfma_f32_16x16x32_bf16 a[80:83], v[104:107], v[152:155], a[80:83]
    s_cselect_b32 s14, 524288, 0
    ds_read_b64_tr_b16 v[170:171], v226 offset:53248
    v_add_f32 v237, v22, v237
    v_mfma_f32_16x16x32_bf16 a[80:83], v[108:111], v[156:159], a[80:83]
    v_exp_f32 v24, v24
    v_mfma_f32_16x16x32_bf16 a[112:115], v[116:119], v[156:159], a[112:115]
    ds_read_b64_tr_b16 v[172:173], v226 offset:57344
    v_add_f32 v237, v23, v237
    v_mfma_f32_16x16x32_bf16 a[112:115], v[112:115], v[152:155], a[112:115]
    v_exp_f32 v25, v25
    v_mfma_f32_16x16x32_bf16 a[144:147], v[120:123], v[152:155], a[144:147]
    ds_read_b64_tr_b16 v[174:175], v226 offset:61440
    v_cvt_pk_bf16_f32 v77, v22, v23
    v_mfma_f32_16x16x32_bf16 a[144:147], v[124:127], v[156:159], a[144:147]
    s_waitcnt lgkmcnt(4)
    v_exp_f32 v26, v26
    v_xor_b32 v226, 0x10000, v226
    v_mfma_f32_16x16x32_bf16 a[148:151], v[124:127], v[164:167], a[148:151]
    ds_read_b64_tr_b16 v[176:177], v227 offset:49152
    v_add_f32 v239, v24, v239
    v_mfma_f32_16x16x32_bf16 a[148:151], v[120:123], v[160:163], a[148:151]
    v_exp_f32 v27, v27
    v_mfma_f32_16x16x32_bf16 a[116:119], v[112:115], v[160:163], a[116:119]
    ds_read_b64_tr_b16 v[178:179], v227 offset:53248
    v_add_f32 v239, v25, v239
    v_mfma_f32_16x16x32_bf16 a[116:119], v[116:119], v[164:167], a[116:119]
    v_exp_f32 v28, v28
    v_mfma_f32_16x16x32_bf16 a[84:87], v[108:111], v[164:167], a[84:87]
    ds_read_b64_tr_b16 v[180:181], v227 offset:57344
    v_cvt_pk_bf16_f32 v84, v24, v25
    v_mfma_f32_16x16x32_bf16 a[84:87], v[104:107], v[160:163], a[84:87]
    v_exp_f32 v29, v29
    v_mfma_f32_16x16x32_bf16 a[52:55], v[96:99], v[160:163], a[52:55]
    ds_read_b64_tr_b16 v[182:183], v227 offset:61440
    v_add_f32 v239, v26, v239
    v_mfma_f32_16x16x32_bf16 a[52:55], v[100:103], v[164:167], a[52:55]
    v_exp_f32 v30, v30
    v_xor_b32 v227, 0x10000, v227
    v_mfma_f32_16x16x32_bf16 a[20:23], v[92:95], v[164:167], a[20:23]
    v_exp_f32 v31, v31
    v_mfma_f32_16x16x32_bf16 a[20:23], v[88:91], v[160:163], a[20:23]
    v_exp_f32 v32, v32
    v_mfma_f32_16x16x32_bf16 v[248:251], v[240:243], v[96:99], v[248:251]
    v_exp_f32 v33, v33
    v_mfma_f32_16x16x32_bf16 v[248:251], v[240:243], v[100:103], v[248:251]
    s_waitcnt lgkmcnt(4)
    v_add_f32 v239, v27, v239
    v_cvt_pk_bf16_f32 v85, v26, v27
    v_mfma_f32_16x16x32_bf16 a[24:27], v[88:91], v[168:171], a[24:27]
    v_exp_f32 v34, v34
    v_mfma_f32_16x16x32_bf16 a[24:27], v[92:95], v[172:175], a[24:27]
    s_waitcnt vmcnt(8) lgkmcnt(0)
    v_cvt_pk_bf16_f32 v54, v28, v29
    v_cvt_pk_bf16_f32 v55, v30, v31
    v_mfma_f32_16x16x32_bf16 a[56:59], v[100:103], v[172:175], a[56:59]
    s_barrier
    v_mfma_f32_16x16x32_bf16 a[56:59], v[96:99], v[168:171], a[56:59]
    v_exp_f32 v35, v35
    v_mfma_f32_16x16x32_bf16 a[88:91], v[104:107], v[168:171], a[88:91]
    ds_read_b128 v[152:155], v216 offset:0
    v_cvt_pk_bf16_f32 v62, v32, v33
    v_mfma_f32_16x16x32_bf16 a[88:91], v[108:111], v[172:175], a[88:91]
    v_exp_f32 v36, v36
    v_mfma_f32_16x16x32_bf16 a[120:123], v[116:119], v[172:175], a[120:123]
    ds_read_b128 v[156:159], v217 offset:0
    v_cvt_pk_bf16_f32 v63, v34, v35
    v_mfma_f32_16x16x32_bf16 a[120:123], v[112:115], v[168:171], a[120:123]
    v_exp_f32 v37, v37
    v_mfma_f32_16x16x32_bf16 a[152:155], v[120:123], v[168:171], a[152:155]
    ds_read_b128 v[160:163], v218 offset:0
    v_add_f32 v236, v36, v236
    v_mfma_f32_16x16x32_bf16 a[152:155], v[124:127], v[172:175], a[152:155]
    v_exp_f32 v38, v38
    v_mfma_f32_16x16x32_bf16 a[156:159], v[124:127], v[180:183], a[156:159]
    ds_read_b128 v[164:167], v219 offset:0
    v_add_f32 v236, v37, v236
    v_mfma_f32_16x16x32_bf16 a[156:159], v[120:123], v[176:179], a[156:159]
    v_exp_f32 v39, v39
    v_mfma_f32_16x16x32_bf16 a[124:127], v[112:115], v[176:179], a[124:127]
    v_exp_f32 v40, v40
    v_mfma_f32_16x16x32_bf16 a[124:127], v[116:119], v[180:183], a[124:127]
    v_cvt_pk_bf16_f32 v70, v36, v37
    v_add_f32 v236, v38, v236
    v_mfma_f32_16x16x32_bf16 a[92:95], v[108:111], v[180:183], a[92:95]
    v_exp_f32 v41, v41
    v_mfma_f32_16x16x32_bf16 a[92:95], v[104:107], v[176:179], a[92:95]
    v_add_f32 v236, v39, v236
    v_cvt_pk_bf16_f32 v71, v38, v39
    v_mfma_f32_16x16x32_bf16 a[60:63], v[96:99], v[176:179], a[60:63]
    v_exp_f32 v42, v42
    v_mfma_f32_16x16x32_bf16 a[60:63], v[100:103], v[180:183], a[60:63]
    v_add_f32 v237, v40, v237
    v_add_f32 v237, v41, v237
    v_mfma_f32_16x16x32_bf16 a[28:31], v[92:95], v[180:183], a[28:31]
    v_exp_f32 v43, v43
    v_mfma_f32_16x16x32_bf16 a[28:31], v[88:91], v[176:179], a[28:31]
    s_waitcnt lgkmcnt(2)
    s_branch L_loop3
L_codeend:
.section .rodata,"a"
.p2align 6
.amdhsa_kernel standalone__mha_softmax__near_ridge_kernel
  .amdhsa_next_free_vgpr 512
  .amdhsa_next_free_sgpr 102
  .amdhsa_accum_offset 256
  .amdhsa_group_segment_fixed_size 0
  .amdhsa_kernarg_size 48
  .amdhsa_user_sgpr_count 2
  .amdhsa_user_sgpr_kernarg_segment_ptr 1
  .amdhsa_system_sgpr_workgroup_id_x 1
.end_amdhsa_kernel
```
